```python
import torch

def _softmax(x, axis=-1):
    return torch.softmax(x, dim=axis)

def _gelu(x):
    return torch.nn.functional.gelu(x, approximate='tanh')

def _silu(x):
    return torch.nn.functional.silu(x)

def _sigmoid(x):
    return torch.sigmoid(x)

def _layernorm(x, axis=-1, eps=1e-05):
    m = x.mean(dim=axis, keepdim=True)
    v = x.var(dim=axis, keepdim=True, unbiased=False)
    return (x - m) / torch.sqrt(v + eps)

def _scatter_add(tgt, idx, src, axis=0):
    return tgt.clone().index_add_(axis, idx, src)

def _segment_sum(src, seg, n):
    out = torch.zeros((n,) + src.shape[1:], dtype=src.dtype)
    return out.index_add_(0, seg, src)

def _pad(x, pw):
    flat = tuple((v for pair in reversed(pw) for v in pair))
    return torch.nn.functional.pad(x, flat)
kernel_name = 'recurrent_scan__sliding_block__mixer_gmlp__prompt'

def setup_inputs():

    _w = lambda a: (lambda t: t.to(torch.bfloat16) if t.is_floating_point() else t)(torch.as_tensor(a))

    def _A_setup():
        B, S, D = (1, 2048, 576)
        return {'x': _w((lambda *s: torch.randn(*s, dtype=torch.bfloat16) * 0.05)(B, S, D)), 'wqkv': _w((lambda *s: torch.randn(*s, dtype=torch.bfloat16) * 0.05)(D, 3 * D)), 'wo': _w((lambda *s: torch.randn(*s, dtype=torch.bfloat16) * 0.05)(D, D))}
    _A_in = _A_setup()

    def _B_setup():
        B, S, D, F = (1, 2048, 576, 4608)
        Fh = F // 2
        return {'x': _w((lambda *s: torch.randn(*s, dtype=torch.bfloat16) * 0.05)(B, S, D)), 'w_in': _w((lambda *s: torch.randn(*s, dtype=torch.bfloat16) * 0.4)(D, 2 * Fh)), 'w_sp': _w(0.01 * (lambda *s: torch.randn(*s, dtype=torch.bfloat16) * 0.4)(S, S)), 'b_sp': _w(1.0 + 0.01 * (lambda *s: torch.randn(*s, dtype=torch.bfloat16) * 0.05)(S)), 'w_out': _w((lambda *s: torch.randn(*s, dtype=torch.bfloat16) * 0.05)(Fh, D))}
    _B_in = _B_setup()
    return {'A_x': _A_in['x'], 'A_wqkv': _A_in['wqkv'], 'A_wo': _A_in['wo'], 'B_x': _B_in['x'], 'B_w_in': _B_in['w_in'], 'B_w_sp': _B_in['w_sp'], 'B_b_sp': _B_in['b_sp'], 'B_w_out': _B_in['w_out']}

def reference(A_x, A_wqkv, A_wo, B_x, B_w_in, B_w_sp, B_b_sp, B_w_out):

    def _A_ref(x, wqkv, wo):
        B, S, D = x.shape
        H = 32
        Dh = D // H
        W = 256
        qkv = (lambda x, *d: x.permute(*d))((x @ wqkv).reshape(B, S, 3, H, Dh), 2, 0, 3, 1, 4)
        q, k, v = (qkv[0], qkv[1], qkv[2])
        scores = torch.einsum('bhqd,bhkd->bhqk', q, k) * Dh ** (-0.5)
        idx = torch.arange(S)
        mask = (idx[:, None] - idx[None, :] >= 0) & (idx[:, None] - idx[None, :] < W)
        scores = torch.where(mask[None, None], scores, -1000000000.0)
        p = _softmax(scores, axis=-1)
        o = torch.einsum('bhqk,bhkd->bhqd', p, v)
        return (lambda x, *d: x.permute(*d))(o, 0, 2, 1, 3).reshape(B, S, D) @ wo

    def _B_ref(x, w_in, w_sp, b_sp, w_out):
        B, S, D = x.shape
        F = w_in.shape[-1]
        Fh = F // 2
        z = _gelu(torch.einsum('bsd,df->bsf', x, w_in))
        z1 = z[..., :Fh].clone()
        z2 = _layernorm(z[..., Fh:], axis=-1)
        g = torch.einsum('ts,bsf->btf', w_sp, z2) + b_sp[None, :, None]
        return torch.einsum('bsf,fd->bsd', z1 * g, w_out)
    x = A_x
    xn = _layernorm(x, axis=-1)
    s = _A_ref(xn, A_wqkv, A_wo)
    g = _silu(_B_ref(xn, B_w_in, B_w_sp, B_b_sp, B_w_out))
    return x + s * g
```

```asm
; @launch grid=(256,1,1) block=(512,1,1) lds=163840
.amdgcn_target "amdgcn-amd-amdhsa--gfx950"
.text
.globl recurrent_scan__sliding_block__mixer_gmlp__prompt_kernel
.p2align 8
.type recurrent_scan__sliding_block__mixer_gmlp__prompt_kernel,@function
recurrent_scan__sliding_block__mixer_gmlp__prompt_kernel:
s_cmp_ge_u32 s2, 256
s_cbranch_scc1 L_end
s_load_dwordx16 s[40:55], s[0:1], 0
s_load_dwordx2 s[24:25], s[0:1], 64
s_load_dwordx2 s[20:21], s[0:1], 80
v_lshrrev_b32 v1, 6, v0
v_and_b32 v2, 63, v0
s_and_b32 s61, s2, 7
s_lshr_b32 s62, s2, 3
v_readfirstlane_b32 s64, v1
s_mov_b32 s3, 0
s_and_b32 s56, s61, 1
s_lshl_b32 s56, s56, 3
s_and_b32 s63, s62, 7
s_add_u32 s56, s56, s63
s_lshr_b32 s57, s61, 1
s_lshl_b32 s57, s57, 2
s_lshr_b32 s63, s62, 3
s_add_u32 s57, s57, s63
s_and_b32 s58, s64, 3
s_mov_b32 s6, 2359296
s_mov_b32 s7, 0x20000
s_cmp_lt_u32 s64, 4
s_cbranch_scc1 L_mfma
s_setprio 3
s_mov_b32 s68, s61
v_lshrrev_b32 v3, 4, v2
v_and_b32 v4, 7, v2
v_xor_b32 v4, v4, v3
v_lshlrev_b32 v4, 4, v4
v_lshrrev_b32 v5, 5, v2
v_bfe_u32 v3, v2, 3, 2
v_lshl_add_u32 v3, v5, 3, v3
s_lshl_b32 s62, s56, 7
s_lshl_b32 s63, s58, 5
s_add_u32 s62, s62, s63
v_add_u32 v3, s62, v3
v_mul_u32_u24 v3, 1152, v3
v_add_u32 v19, v3, v4
v_xor_b32 v4, 64, v4
v_add_u32 v3, v3, v4
v_add_u32 v20, 17408, v3
v_add_u32 v21, 2560, v19
v_add_u32 v22, 19968, v3
s_lshr_b32 s62, s58, 1
s_lshl_b32 s62, s62, 3
s_and_b32 s63, s58, 1
s_add_u32 s62, s62, s63
s_mul_i32 s62, s62, 36864
s_mov_b32 s63, 8928
s_mov_b32 s64, 36864
v_mul_u32_u24 v3, 3641, v2
v_lshlrev_b32 v6, 4, v2
v_add_u32 v6, s62, v6
v_add_u32 v4, 0, v3
v_lshrrev_b32 v5, 16, v4
v_lshrrev_b32 v4, 18, v4
v_mad_u32_u24 v5, v5, s63, v6
v_mad_u32_u24 v10, v4, s64, v5
v_add_u32 v4, 116512, v3
v_lshrrev_b32 v5, 16, v4
v_lshrrev_b32 v4, 18, v4
v_mad_u32_u24 v5, v5, s63, v6
v_mad_u32_u24 v11, v4, s64, v5
v_add_u32 v4, 349536, v3
v_lshrrev_b32 v5, 16, v4
v_lshrrev_b32 v4, 18, v4
v_mad_u32_u24 v5, v5, s63, v6
v_mad_u32_u24 v12, v4, s64, v5
v_add_u32 v4, 582560, v3
v_lshrrev_b32 v5, 16, v4
v_lshrrev_b32 v4, 18, v4
v_mad_u32_u24 v5, v5, s63, v6
v_mad_u32_u24 v13, v4, s64, v5
v_add_u32 v4, 815584, v3
v_lshrrev_b32 v5, 16, v4
v_lshrrev_b32 v4, 18, v4
v_mad_u32_u24 v5, v5, s63, v6
v_mad_u32_u24 v14, v4, s64, v5
s_mul_i32 s76, s57, 288
s_add_u32 s75, s76, 4608
s_mul_i32 s72, s58, 4608
s_mov_b32 s14, 5308416
s_mov_b32 s15, 0x20000
s_lshl_b32 s74, s58, 12
s_waitcnt lgkmcnt(0)
s_mov_b64 s[4:5], s[40:41]
s_mov_b64 s[12:13], s[48:49]
s_lshl_b32 s70, s68, 7
s_add_u32 m0, s74, 0
s_nop 0
buffer_load_dwordx4 v19, s[4:7], s70 offen offset:0 lds
buffer_load_dwordx4 v20, s[4:7], s70 offen offset:1024 lds
buffer_load_dwordx4 v21, s[4:7], s70 offen offset:2048 lds
buffer_load_dwordx4 v22, s[4:7], s70 offen offset:3072 lds
s_mul_i32 s69, s68, 589824
s_add_u32 s69, s69, s75
s_add_u32 m0, s72, 16384
s_mov_b32 exec_hi, 0
buffer_load_dwordx4 v10, s[12:15], s69 offen lds
s_mov_b32 exec_hi, -1
buffer_load_dwordx4 v11, s[12:15], s69 offen offset:512 lds
buffer_load_dwordx4 v12, s[12:15], s69 offen offset:1536 lds
buffer_load_dwordx4 v13, s[12:15], s69 offen offset:2560 lds
buffer_load_dwordx4 v14, s[12:15], s69 offen offset:3584 lds
s_add_u32 s68, s68, 1
s_cmp_eq_u32 s68, 9
s_cselect_b32 s68, 0, s68
s_mov_b32 s60, 0
s_mov_b32 s59, 0
s_cmp_lg_u32 s58, 0
s_cbranch_scc1 L_noe
s_mov_b32 s60, 0
s_add_u32 s66, s20, 44212224
s_addc_u32 s67, s21, 0
s_load_dword s59, s[66:67], 0
L_noe:
s_mul_i32 s77, s57, 112
s_min_u32 s77, s77, 1616
s_lshl_b32 s77, s77, 1
s_mul_i32 s73, s58, 3584
s_mov_b64 s[8:9], s[42:43]
s_mov_b32 s10, 1990656
s_mov_b32 s11, 0x20000
s_mov_b64 s[16:17], s[50:51]
s_mov_b32 s18, 8388608
s_mov_b32 s19, 0x20000
s_mov_b32 s22, 44564480
s_mov_b32 s23, 0x20000
s_mov_b32 s26, 2359296
s_mov_b32 s27, 0x20000
s_mov_b64 s[28:29], s[54:55]
s_mov_b32 s30, 2654208
s_mov_b32 s31, 0x20000
s_mov_b64 s[32:33], s[44:45]
s_mov_b32 s34, 663552
s_mov_b32 s35, 0x20000
s_mov_b64 s[36:37], s[52:53]
s_mov_b32 s38, 4096
s_mov_b32 s39, 0x20000
v_lshrrev_b32 v3, 3, v2
v_bfe_u32 v4, v2, 4, 2
v_lshlrev_b32 v4, 1, v4
v_and_b32 v5, 7, v2
v_xor_b32 v4, v4, v5
v_lshlrev_b32 v4, 4, v4
s_lshl_b32 s62, s58, 3
v_add_u32 v3, s62, v3
v_mul_u32_u24 v28, 9216, v3
v_add_u32 v28, v28, v4
v_mul_u32_u24 v29, 3456, v3
v_add_u32 v29, v29, v4
v_lshlrev_b32 v25, 2, v2
s_mul_i32 s65, s58, 9216
s_add_u32 s65, s65, 104448
v_lshlrev_b32 v8, 4, v2
v_add_u32 v7, s65, v8
v_lshlrev_b32 v31, 3, v2
v_bfe_u32 v3, v2, 3, 2
v_xor_b32 v3, s58, v3
v_lshlrev_b32 v3, 5, v3
v_and_b32 v4, 3, v2
v_lshl_add_u32 v3, v4, 3, v3
v_lshrrev_b32 v4, 2, v2
v_lshl_add_u32 v30, v4, 7, v3
v_mov_b32 v248, 0x3f803f80
v_mov_b32 v249, 0x3f803f80
v_mov_b32 v250, 0x3f803f80
v_mov_b32 v251, 0x3f803f80
s_lshl_b32 s70, s68, 7
s_add_u32 m0, s74, 34816
s_nop 0
buffer_load_dwordx4 v19, s[4:7], s70 offen offset:0 lds
buffer_load_dwordx4 v20, s[4:7], s70 offen offset:1024 lds
buffer_load_dwordx4 v21, s[4:7], s70 offen offset:2048 lds
buffer_load_dwordx4 v22, s[4:7], s70 offen offset:3072 lds
s_mul_i32 s69, s68, 589824
s_add_u32 s69, s69, s75
s_add_u32 m0, s72, 51200
s_mov_b32 exec_hi, 0
buffer_load_dwordx4 v10, s[12:15], s69 offen lds
s_mov_b32 exec_hi, -1
buffer_load_dwordx4 v11, s[12:15], s69 offen offset:512 lds
buffer_load_dwordx4 v12, s[12:15], s69 offen offset:1536 lds
buffer_load_dwordx4 v13, s[12:15], s69 offen offset:2560 lds
buffer_load_dwordx4 v14, s[12:15], s69 offen offset:3584 lds
s_add_u32 s68, s68, 1
s_cmp_eq_u32 s68, 9
s_cselect_b32 s68, 0, s68
s_branch L_h2
L_mfma:
s_setprio 1
s_getpc_b64 s[76:77]
L_pc:
s_sub_u32 s76, s76, L_pc-recurrent_scan__sliding_block__mixer_gmlp__prompt_kernel
s_subb_u32 s77, s77, 0
s_mov_b32 s78, L_codeend-recurrent_scan__sliding_block__mixer_gmlp__prompt_kernel
s_mov_b32 s79, 0x20000
s_lshr_b32 s62, s2, 3
s_lshl_b32 s62, s62, 2
s_add_u32 s62, s62, s58
s_lshl_b32 s62, s62, 7
v_lshlrev_b32 v3, 14, v2
s_mov_b64 exec, 255
buffer_load_dword v67, v3, s[76:79], s62 offen
s_mov_b64 exec, -1
s_lshl_b32 s62, s56, 7
s_lshl_b32 s63, s57, 3
s_add_u32 s62, s62, s63
s_lshl_b32 s63, s58, 1
s_add_u32 s62, s62, s63
s_mul_i32 s74, s62, 1152
v_lshrrev_b32 v16, 5, v2
v_mul_u32_u24 v17, 1152, v16
v_and_b32 v18, 31, v2
v_lshl_add_u32 v17, v18, 4, v17
v_mov_b32 v28, 0
v_mov_b32 v29, 0
v_mov_b32 v30, 0
v_mov_b32 v31, 0
v_mov_b32 v32, 0
v_mov_b32 v33, 0
v_mov_b32 v34, 0
v_mov_b32 v35, 0
s_mov_b32 s76, 0x3f803f80
s_mov_b32 s78, 0xff
s_mov_b32 s79, 0xff
s_waitcnt lgkmcnt(0)
s_mov_b64 s[4:5], s[40:41]
buffer_load_dwordx4 v[20:23], v17, s[4:7], s74 offen
buffer_load_dwordx4 v[24:27], v17, s[4:7], s74 offen offset:512
s_mov_b64 exec, s[78:79]
buffer_load_dwordx4 v[28:31], v17, s[4:7], s74 offen offset:1024
s_mov_b64 exec, -1
s_mov_b32 s22, 44564480
s_mov_b32 s23, 0x20000
s_mov_b32 s60, 0
v_mov_b32 v149, 163456
s_mov_b64 s[36:37], s[52:53]
s_mov_b32 s38, 4096
s_mov_b32 s39, 0x20000
s_lshr_b32 s63, s62, 5
s_lshl_b32 s63, s63, 9
s_lshr_b32 s64, s58, 1
s_lshl_b32 s64, s64, 8
s_add_u32 s63, s63, s64
s_and_b32 s64, s57, 3
s_lshl_b32 s64, s64, 6
s_add_u32 s63, s63, s64
s_and_b32 s64, s58, 1
s_lshl_b32 s64, s64, 5
s_add_u32 s63, s63, s64
s_add_u32 s75, s63, 44310528
v_lshlrev_b32 v16, 4, v16
v_lshrrev_b32 v13, 2, v2
v_and_b32 v12, 3, v2
v_mul_u32_u24 v3, 288, v13
v_lshl_add_u32 v3, v12, 3, v3
v_add_u32 v4, 57344, v3
v_add_u32 v5, 114688, v3
v_mul_u32_u24 v6, 224, v13
v_lshl_add_u32 v6, v12, 3, v6
v_add_u32 v7, 57344, v6
s_mul_i32 s65, s58, 9216
s_add_u32 s65, s65, 104448
v_lshlrev_b32 v0, 4, v2
v_add_u32 v0, s65, v0
v_and_b32 v10, 15, v2
v_lshrrev_b32 v11, 4, v2
v_bfe_u32 v12, v2, 1, 3
v_xor_b32 v11, v11, v12
v_lshlrev_b32 v11, 4, v11
v_lshl_add_u32 v10, v10, 7, v11
s_lshl_b32 s62, s58, 12
v_add_u32 v10, s62, v10
s_mul_i32 s68, s58, 1664
s_add_u32 s68, s68, 153728
s_lshl_b32 s70, s56, 2
s_add_u32 s70, s70, s58
s_lshl_b32 s69, s70, 4
s_add_u32 s69, s69, s57
s_lshl_b32 s69, s69, 9
s_add_u32 s69, s69, 34250752
s_mov_b32 s72, 0xbdd2d3e8
s_mov_b32 s73, 0xbdd2d3e8
s_bfe_u32 s62, s2, 65541
s_lshl_b32 s62, s62, 2
s_add_u32 s62, s62, s58
s_mov_b32 s3, 1
s_mov_b64 exec, 0
s_cmp_eq_u32 s62, 0
s_cbranch_scc1 Lpad4860
s_cmp_eq_u32 s62, 1
s_cbranch_scc1 Lpad5145
s_cmp_eq_u32 s62, 2
s_cbranch_scc1 Lpad5358
s_cmp_eq_u32 s62, 3
s_cbranch_scc1 Lpad5641
s_cmp_eq_u32 s62, 4
s_cbranch_scc1 Lpad5866
s_cmp_eq_u32 s62, 5
s_cbranch_scc1 Lpad6165
s_cmp_eq_u32 s62, 6
s_cbranch_scc1 Lpad457
s_branch Lpad812
Lback4:
s_cmp_eq_u32 s3, 1
s_mov_b32 s3, 0
s_mov_b64 exec, -1
s_waitcnt vmcnt(0)
v_dot2c_f32_bf16 v32, s76, v20
v_dot2c_f32_bf16 v33, v20, v20
v_dot2c_f32_bf16 v34, s76, v21
v_dot2c_f32_bf16 v35, v21, v21
v_dot2c_f32_bf16 v32, s76, v22
v_dot2c_f32_bf16 v33, v22, v22
v_dot2c_f32_bf16 v34, s76, v23
v_dot2c_f32_bf16 v35, v23, v23
v_dot2c_f32_bf16 v32, s76, v24
v_dot2c_f32_bf16 v33, v24, v24
v_dot2c_f32_bf16 v34, s76, v25
v_dot2c_f32_bf16 v35, v25, v25
v_dot2c_f32_bf16 v32, s76, v26
v_dot2c_f32_bf16 v33, v26, v26
v_dot2c_f32_bf16 v34, s76, v27
v_dot2c_f32_bf16 v35, v27, v27
v_dot2c_f32_bf16 v32, s76, v28
v_dot2c_f32_bf16 v33, v28, v28
v_dot2c_f32_bf16 v34, s76, v29
v_dot2c_f32_bf16 v35, v29, v29
v_dot2c_f32_bf16 v32, s76, v30
v_dot2c_f32_bf16 v33, v30, v30
v_dot2c_f32_bf16 v34, s76, v31
v_dot2c_f32_bf16 v35, v31, v31
s_nop 1
v_add_f32 v32, v32, v34
v_add_f32 v33, v33, v35
s_nop 0
v_add_f32_dpp v32, v32, v32 quad_perm:[1,0,3,2] row_mask:0xf bank_mask:0xf
v_add_f32_dpp v33, v33, v33 quad_perm:[1,0,3,2] row_mask:0xf bank_mask:0xf
s_nop 0
v_add_f32_dpp v32, v32, v32 quad_perm:[2,3,0,1] row_mask:0xf bank_mask:0xf
v_add_f32_dpp v33, v33, v33 quad_perm:[2,3,0,1] row_mask:0xf bank_mask:0xf
s_nop 0
v_add_f32_dpp v32, v32, v32 row_ror:4 row_mask:0xf bank_mask:0xf
v_add_f32_dpp v33, v33, v33 row_ror:4 row_mask:0xf bank_mask:0xf
s_nop 0
v_add_f32_dpp v32, v32, v32 row_ror:8 row_mask:0xf bank_mask:0xf
v_add_f32_dpp v33, v33, v33 row_ror:8 row_mask:0xf bank_mask:0xf
v_mov_b32 v34, v32
v_mov_b32 v35, v33
s_nop 0
v_permlane16_swap_b32 v32, v34
v_permlane16_swap_b32 v33, v35
v_add_f32 v32, v32, v34
v_add_f32 v33, v33, v35
v_mul_f32 v32, 0x3ae38e39, v32
v_mul_f32 v33, 0x3ae38e39, v33
v_fma_f32 v33, -v32, v32, v33
v_max_f32 v33, 0, v33
v_cvt_pk_bf16_f32 v33, v33, v33
v_and_b32 v33, 0xffff0000, v33
v_add_f32 v33, 0x3727c5ac, v33
v_cvt_pk_bf16_f32 v33, v33, v33
v_and_b32 v33, 0xffff0000, v33
v_sqrt_f32 v33, v33
v_cvt_pk_bf16_f32 v146, -v32, -v32
v_cvt_pk_bf16_f32 v33, v33, v33
v_and_b32 v33, 0xffff0000, v33
v_rcp_f32 v144, v33
v_mov_b32 v148, v16
s_mov_b32 s78, 1
s_mov_b32 s79, 1
s_branch L_mfma2
L_h2:
s_waitcnt vmcnt(9)
s_barrier
s_lshl_b32 s70, s68, 7
s_add_u32 m0, s74, 69632
s_nop 0
buffer_load_dwordx4 v19, s[4:7], s70 offen offset:0 lds
buffer_load_dwordx4 v20, s[4:7], s70 offen offset:1024 lds
buffer_load_dwordx4 v21, s[4:7], s70 offen offset:2048 lds
buffer_load_dwordx4 v22, s[4:7], s70 offen offset:3072 lds
s_mul_i32 s69, s68, 589824
s_add_u32 s69, s69, s75
s_add_u32 m0, s72, 86016
s_mov_b32 exec_hi, 0
buffer_load_dwordx4 v10, s[12:15], s69 offen lds
s_mov_b32 exec_hi, -1
buffer_load_dwordx4 v11, s[12:15], s69 offen offset:512 lds
buffer_load_dwordx4 v12, s[12:15], s69 offen offset:1536 lds
buffer_load_dwordx4 v13, s[12:15], s69 offen offset:2560 lds
buffer_load_dwordx4 v14, s[12:15], s69 offen offset:3584 lds
s_add_u32 s68, s68, 1
s_cmp_eq_u32 s68, 9
s_cselect_b32 s68, 0, s68
s_mul_i32 s50, s2, 10923
s_lshr_b32 s50, s50, 16
s_mul_i32 s51, s50, 6
s_sub_u32 s51, s2, s51
s_mul_i32 s52, s51, 884736
s_lshl_b32 s62, s50, 7
s_add_u32 s52, s52, s62
s_add_u32 s52, s52, 4608
s_mul_i32 s53, s51, 18432
s_lshl_b32 s62, s50, 9
s_add_u32 s53, s53, s62
s_lshl_b32 s62, s58, 7
s_add_u32 s53, s53, s62
s_add_u32 s53, s53, 44343296
s_cmp_lt_u32 s2, 216
s_cselect_b32 s52, s52, 0x40000000
s_cselect_b32 s53, s53, 0x40000000
s_lshl_b32 s54, s58, 10
s_add_u32 m0, s54, 139264
s_nop 0
buffer_load_dwordx4 v28, s[12:15], s52 offen lds
s_add_u32 s52, s52, 294912
s_add_u32 m0, s54, 143360
s_nop 0
buffer_load_dwordx4 v28, s[12:15], s52 offen lds
s_add_u32 s52, s52, 294912
s_add_u32 m0, s54, 147456
s_nop 0
buffer_load_dwordx4 v28, s[12:15], s52 offen lds
s_add_u32 s52, s52, 294912
LH_L0:
s_waitcnt vmcnt(12) lgkmcnt(0)
s_mul_i32 s59, s59, 0x9E3779B1
s_add_u32 s59, s59, 0x7F4A7C15
s_cmp_eq_u32 s58, 0
s_cselect_b32 s62, 0, 4
s_add_u32 s62, s62, 163456
v_mov_b32 v3, s62
v_mov_b32 v4, s59
ds_write_b32 v3, v4
s_waitcnt lgkmcnt(0)
s_barrier
v_mov_b32 v3, 163456
ds_read_b32 v4, v3
s_lshl_b32 s70, s68, 7
s_add_u32 m0, s74, 104448
s_nop 0
buffer_load_dwordx4 v19, s[4:7], s70 offen offset:0 lds
buffer_load_dwordx4 v20, s[4:7], s70 offen offset:1024 lds
buffer_load_dwordx4 v21, s[4:7], s70 offen offset:2048 lds
buffer_load_dwordx4 v22, s[4:7], s70 offen offset:3072 lds
s_mul_i32 s69, s68, 589824
s_add_u32 s69, s69, s75
s_add_u32 m0, s72, 120832
s_mov_b32 exec_hi, 0
buffer_load_dwordx4 v10, s[12:15], s69 offen lds
s_mov_b32 exec_hi, -1
buffer_load_dwordx4 v11, s[12:15], s69 offen offset:512 lds
buffer_load_dwordx4 v12, s[12:15], s69 offen offset:1536 lds
buffer_load_dwordx4 v13, s[12:15], s69 offen offset:2560 lds
Lpad457:
s_cbranch_execz Lpad543
buffer_load_dwordx4 v14, s[12:15], s69 offen offset:3584 lds
s_add_u32 s68, s68, 1
s_cmp_eq_u32 s68, 9
s_cselect_b32 s68, 0, s68
s_waitcnt lgkmcnt(0)
v_readfirstlane_b32 s59, v4
LH_L1:
s_waitcnt vmcnt(9)
s_barrier
s_lshl_b32 s70, s68, 7
s_add_u32 m0, s74, 0
s_nop 0
buffer_load_dwordx4 v19, s[4:7], s70 offen offset:0 lds
buffer_load_dwordx4 v20, s[4:7], s70 offen offset:1024 lds
buffer_load_dwordx4 v21, s[4:7], s70 offen offset:2048 lds
buffer_load_dwordx4 v22, s[4:7], s70 offen offset:3072 lds
s_mul_i32 s69, s68, 589824
s_add_u32 s69, s69, s75
s_add_u32 m0, s72, 16384
s_mov_b32 exec_hi, 0
buffer_load_dwordx4 v10, s[12:15], s69 offen lds
s_mov_b32 exec_hi, -1
buffer_load_dwordx4 v11, s[12:15], s69 offen offset:512 lds
buffer_load_dwordx4 v12, s[12:15], s69 offen offset:1536 lds
buffer_load_dwordx4 v13, s[12:15], s69 offen offset:2560 lds
buffer_load_dwordx4 v14, s[12:15], s69 offen offset:3584 lds
s_add_u32 s68, s68, 1
s_cmp_eq_u32 s68, 9
s_cselect_b32 s68, 0, s68
v_add_u32 v3, 139264, v30
ds_read_b64_tr_b16 v[172:173], v3 offset:0
ds_read_b64_tr_b16 v[174:175], v3 offset:2048
ds_read_b64_tr_b16 v[176:177], v3 offset:4096
ds_read_b64_tr_b16 v[178:179], v3 offset:6144
ds_read_b64_tr_b16 v[180:181], v3 offset:8192
ds_read_b64_tr_b16 v[182:183], v3 offset:10240
s_waitcnt lgkmcnt(4)
v_mfma_f32_16x16x32_bf16 v[152:155], v[248:251], v[172:175], 0
s_waitcnt lgkmcnt(2)
v_mfma_f32_16x16x32_bf16 v[152:155], v[248:251], v[176:179], v[152:155]
s_waitcnt lgkmcnt(0)
v_mfma_f32_16x16x32_bf16 v[152:155], v[248:251], v[180:183], v[152:155]
s_nop 7
v_mov_b32 v153, s59
s_mov_b64 exec, 0xffff
buffer_store_dwordx2 v[152:153], v31, s[20:23], s53 offen sc1
s_mov_b64 exec, -1
LH_L2:
s_waitcnt vmcnt(10)
s_barrier
s_lshl_b32 s70, s68, 7
s_add_u32 m0, s74, 34816
s_nop 0
buffer_load_dwordx4 v19, s[4:7], s70 offen offset:0 lds
s_lshr_b32 s62, s58, 1
s_lshl_b32 s62, s62, 3
s_and_b32 s63, s58, 1
buffer_load_dwordx4 v20, s[4:7], s70 offen offset:1024 lds
s_add_u32 s62, s62, s63
s_mul_i32 s62, s62, 13824
buffer_load_dwordx4 v21, s[4:7], s70 offen offset:2048 lds
s_mov_b32 s63, 3232
s_mov_b32 s64, 13824
v_mul_u32_u24 v3, 4682, v2
buffer_load_dwordx4 v22, s[4:7], s70 offen offset:3072 lds
v_lshlrev_b32 v6, 4, v2
v_add_u32 v6, s62, v6
v_add_u32 v4, 0, v3
s_mul_i32 s69, s68, 589824
s_add_u32 s69, s69, s75
s_add_u32 m0, s72, 51200
s_mov_b32 exec_hi, 0
buffer_load_dwordx4 v10, s[12:15], s69 offen lds
s_mov_b32 exec_hi, -1
v_lshrrev_b32 v5, 16, v4
v_lshrrev_b32 v4, 18, v4
v_mad_u32_u24 v5, v5, s63, v6
buffer_load_dwordx4 v11, s[12:15], s69 offen offset:512 lds
v_mad_u32_u24 v15, v4, s64, v5
v_add_u32 v4, 149824, v3
buffer_load_dwordx4 v12, s[12:15], s69 offen offset:1536 lds
v_lshrrev_b32 v5, 16, v4
v_lshrrev_b32 v4, 18, v4
v_mad_u32_u24 v5, v5, s63, v6
buffer_load_dwordx4 v13, s[12:15], s69 offen offset:2560 lds
v_mad_u32_u24 v16, v4, s64, v5
Lpad543:
s_cbranch_execz Lpad636
v_add_u32 v4, 449472, v3
v_lshrrev_b32 v5, 16, v4
buffer_load_dwordx4 v14, s[12:15], s69 offen offset:3584 lds
s_add_u32 s68, s68, 1
s_cmp_eq_u32 s68, 9
s_cselect_b32 s68, 0, s68
v_lshrrev_b32 v4, 18, v4
v_mad_u32_u24 v5, v5, s63, v6
v_mad_u32_u24 v17, v4, s64, v5
v_add_u32 v4, 749120, v3
v_lshrrev_b32 v5, 16, v4
v_lshrrev_b32 v4, 18, v4
v_mad_u32_u24 v5, v5, s63, v6
v_mad_u32_u24 v18, v4, s64, v5
s_lshl_b32 s44, s2, 2
s_add_u32 s44, s44, s58
s_lshr_b32 s45, s44, 3
s_lshl_b32 s49, s2, 2
s_add_u32 s49, s49, 44306432
s_cmp_eq_u32 s58, 0
s_cselect_b32 s49, s49, 0x40000000
s_mul_i32 s46, s45, 3641
s_lshr_b32 s46, s46, 16
s_mul_i32 s47, s46, 18
s_sub_u32 s47, s45, s47
s_lshr_b32 s62, s47, 2
s_mul_i32 s62, s62, 144
s_and_b32 s63, s47, 3
s_lshl_b32 s63, s63, 5
s_add_u32 s62, s62, s63
s_sub_u32 s63, s47, 16
s_mul_i32 s63, s63, 288
s_add_u32 s65, s63, 16
s_add_u32 s63, s63, 128
s_mul_i32 s52, s47, 36
s_cmp_lt_u32 s47, 16
s_cselect_b32 s62, s62, s63
s_cselect_b32 s64, 16, 144
s_cselect_b32 s48, 4, 4
s_cselect_b32 s50, 8, 8
s_cselect_b32 s63, s52, s65
s_cselect_b32 s65, 20, 36
s_cselect_b32 s51, 4, 72
s_cselect_b32 s52, 8, 144
LH_L3:
s_waitcnt vmcnt(10)
s_barrier
s_lshl_b32 s70, s68, 7
s_add_u32 m0, s74, 69632
s_nop 0
buffer_load_dwordx4 v19, s[4:7], s70 offen offset:0 lds
s_mul_i32 s45, s46, 576
s_add_u32 s62, s62, s45
buffer_load_dwordx4 v20, s[4:7], s70 offen offset:1024 lds
s_cmp_lt_u32 s46, 4
s_cselect_b32 s62, s62, s63
s_cselect_b32 s64, s64, s65
s_cselect_b32 s48, s48, s51
s_cselect_b32 s50, s50, s52
s_cselect_b32 s40, s28, s32
s_cselect_b32 s41, s29, s33
s_cselect_b32 s42, s30, s34
s_mov_b32 s43, 0x20000
s_mul_i32 s62, s62, 1152
buffer_load_dwordx4 v21, s[4:7], s70 offen offset:2048 lds
s_bfe_u32 s63, s44, 0x20001
s_mul_i32 s65, s63, 288
buffer_load_dwordx4 v22, s[4:7], s70 offen offset:3072 lds
s_add_u32 s62, s62, s65
s_and_b32 s65, s44, 1
s_lshl_b32 s65, s65, 7
s_mul_i32 s69, s68, 589824
s_add_u32 s69, s69, s75
s_add_u32 m0, s72, 86016
s_mov_b32 exec_hi, 0
buffer_load_dwordx4 v10, s[12:15], s69 offen lds
s_mov_b32 exec_hi, -1
s_add_u32 s62, s62, s65
s_lshl_b32 s46, s46, 2
buffer_load_dwordx4 v11, s[12:15], s69 offen offset:512 lds
s_add_u32 s46, s46, s63
s_mul_i32 s46, s46, 18
buffer_load_dwordx4 v12, s[12:15], s69 offen offset:1536 lds
s_add_u32 s46, s46, s47
s_mul_i32 s46, s46, 9216
buffer_load_dwordx4 v13, s[12:15], s69 offen offset:2560 lds
s_lshl_b32 s65, s65, 5
s_add_u32 s46, s46, s65
buffer_load_dwordx4 v14, s[12:15], s69 offen offset:3584 lds
s_add_u32 s68, s68, 1
s_cmp_eq_u32 s68, 9
s_cselect_b32 s68, 0, s68
s_add_u32 s46, s46, 30932992
Lpad636:
s_cbranch_execz Lpad722
s_add_u32 s47, s46, 4096
s_cmp_eq_u32 s65, 0
s_cselect_b32 s47, 0x40000000, s47
s_cmp_lt_u32 s44, 720
s_cselect_b32 s62, s62, 0x40000000
s_cselect_b32 s46, s46, 0x40000000
s_cselect_b32 s47, s47, 0x40000000
s_mul_i32 s45, s58, 9216
s_add_u32 s45, s45, 104448
v_add_u32 v100, 0, v2
v_mul_u32_u24 v101, 6554, v100
v_lshrrev_b32 v101, 16, v101
v_mul_u32_u24 v102, 10, v101
v_sub_u32 v102, v100, v102
v_lshrrev_b32 v103, 4, v101
v_mul_u32_u24 v103, s64, v103
v_bfe_u32 v104, v101, 2, 1
v_mad_u32_u24 v103, v104, s48, v103
v_bfe_u32 v104, v101, 3, 1
v_mad_u32_u24 v103, v104, s50, v103
v_and_b32 v101, 3, v101
v_add_u32 v103, v103, v101
v_mul_u32_u24 v103, 1152, v103
v_lshl_add_u32 v128, v102, 4, v103
v_add_u32 v100, 64, v2
LH_L4:
s_waitcnt vmcnt(9)
s_barrier
s_lshl_b32 s70, s68, 7
s_add_u32 m0, s74, 104448
s_nop 0
buffer_load_dwordx4 v19, s[4:7], s70 offen offset:0 lds
v_mul_u32_u24 v101, 6554, v100
v_lshrrev_b32 v101, 16, v101
v_mul_u32_u24 v102, 10, v101
buffer_load_dwordx4 v20, s[4:7], s70 offen offset:1024 lds
v_sub_u32 v102, v100, v102
v_lshrrev_b32 v103, 4, v101
v_mul_u32_u24 v103, s64, v103
buffer_load_dwordx4 v21, s[4:7], s70 offen offset:2048 lds
v_bfe_u32 v104, v101, 2, 1
v_mad_u32_u24 v103, v104, s48, v103
buffer_load_dwordx4 v22, s[4:7], s70 offen offset:3072 lds
v_bfe_u32 v104, v101, 3, 1
v_mad_u32_u24 v103, v104, s50, v103
v_and_b32 v101, 3, v101
s_mul_i32 s69, s68, 589824
s_add_u32 s69, s69, s75
s_add_u32 m0, s72, 120832
s_mov_b32 exec_hi, 0
buffer_load_dwordx4 v10, s[12:15], s69 offen lds
s_mov_b32 exec_hi, -1
v_add_u32 v103, v103, v101
v_mul_u32_u24 v103, 1152, v103
v_lshl_add_u32 v129, v102, 4, v103
buffer_load_dwordx4 v11, s[12:15], s69 offen offset:512 lds
v_add_u32 v100, 128, v2
v_mul_u32_u24 v101, 6554, v100
v_lshrrev_b32 v101, 16, v101
buffer_load_dwordx4 v12, s[12:15], s69 offen offset:1536 lds
v_mul_u32_u24 v102, 10, v101
v_sub_u32 v102, v100, v102
v_lshrrev_b32 v103, 4, v101
buffer_load_dwordx4 v13, s[12:15], s69 offen offset:2560 lds
v_mul_u32_u24 v103, s64, v103
v_bfe_u32 v104, v101, 2, 1
v_mad_u32_u24 v103, v104, s48, v103
buffer_load_dwordx4 v14, s[12:15], s69 offen offset:3584 lds
s_add_u32 s68, s68, 1
s_cmp_eq_u32 s68, 9
s_cselect_b32 s68, 0, s68
v_bfe_u32 v104, v101, 3, 1
v_mad_u32_u24 v103, v104, s50, v103
v_and_b32 v101, 3, v101
v_add_u32 v103, v103, v101
v_mul_u32_u24 v103, 1152, v103
v_lshl_add_u32 v130, v102, 4, v103
v_add_u32 v100, 192, v2
v_mul_u32_u24 v101, 6554, v100
v_lshrrev_b32 v101, 16, v101
v_mul_u32_u24 v102, 10, v101
v_sub_u32 v102, v100, v102
v_lshrrev_b32 v103, 4, v101
v_mul_u32_u24 v103, s64, v103
v_bfe_u32 v104, v101, 2, 1
v_mad_u32_u24 v103, v104, s48, v103
Lpad722:
s_cbranch_execz Lback4
v_bfe_u32 v104, v101, 3, 1
v_mad_u32_u24 v103, v104, s50, v103
v_and_b32 v101, 3, v101
v_add_u32 v103, v103, v101
v_mul_u32_u24 v103, 1152, v103
v_lshl_add_u32 v131, v102, 4, v103
v_add_u32 v100, 256, v2
v_mul_u32_u24 v101, 6554, v100
v_lshrrev_b32 v101, 16, v101
v_mul_u32_u24 v102, 10, v101
v_sub_u32 v102, v100, v102
v_lshrrev_b32 v103, 4, v101
v_mul_u32_u24 v103, s64, v103
LH_L5:
s_waitcnt vmcnt(9)
s_barrier
s_lshl_b32 s70, s68, 7
s_add_u32 m0, s74, 0
s_nop 0
buffer_load_dwordx4 v19, s[4:7], s70 offen offset:0 lds
v_bfe_u32 v104, v101, 2, 1
v_mad_u32_u24 v103, v104, s48, v103
v_bfe_u32 v104, v101, 3, 1
buffer_load_dwordx4 v20, s[4:7], s70 offen offset:1024 lds
v_mad_u32_u24 v103, v104, s50, v103
v_and_b32 v101, 3, v101
v_add_u32 v103, v103, v101
buffer_load_dwordx4 v21, s[4:7], s70 offen offset:2048 lds
v_mul_u32_u24 v103, 1152, v103
v_lshl_add_u32 v132, v102, 4, v103
s_mov_b32 s44, s62
buffer_load_dwordx4 v22, s[4:7], s70 offen offset:3072 lds
v_lshrrev_b32 v100, 2, v2
v_mul_u32_u24 v100, 160, v100
v_add_u32 v100, s45, v100
s_mul_i32 s69, s68, 589824
s_add_u32 s69, s69, s75
s_add_u32 m0, s72, 16384
s_mov_b32 exec_hi, 0
buffer_load_dwordx4 v10, s[12:15], s69 offen lds
s_mov_b32 exec_hi, -1
v_and_b32 v101, 3, v2
v_lshl_add_u32 v102, v101, 3, v100
buffer_load_dwordx4 v11, s[12:15], s69 offen offset:512 lds
v_lshl_add_u32 v101, v101, 4, v100
v_lshrrev_b32 v3, 4, v2
v_and_b32 v4, 7, v2
buffer_load_dwordx4 v12, s[12:15], s69 offen offset:1536 lds
v_xor_b32 v4, v4, v3
v_lshlrev_b32 v4, 4, v4
v_lshrrev_b32 v5, 5, v2
buffer_load_dwordx4 v13, s[12:15], s69 offen offset:2560 lds
v_bfe_u32 v3, v2, 3, 2
v_lshl_add_u32 v3, v5, 3, v3
s_lshl_b32 s62, s56, 7
buffer_load_dwordx4 v14, s[12:15], s69 offen offset:3584 lds
s_add_u32 s68, s68, 1
s_cmp_eq_u32 s68, 9
s_cselect_b32 s68, 0, s68
s_lshl_b32 s63, s58, 5
s_add_u32 s62, s62, s63
v_add_u32 v3, s62, v3
v_mul_u32_u24 v3, 4096, v3
v_add_u32 v252, v3, v4
v_xor_b32 v4, 64, v4
v_add_u32 v3, v3, v4
v_add_u32 v253, 64512, v3
v_add_u32 v254, 14336, v252
v_add_u32 v255, 78848, v3
s_mul_i32 s62, s57, 589824
s_add_u32 s62, s62, s72
s_add_u32 s62, s62, 2621440
v_add_u32 v23, s62, v8
s_lshl_b32 s78, s61, 9
s_mul_i32 s79, s78, 144
s_lshl_b32 s84, s56, 2
s_add_u32 s84, s84, s58
v_lshrrev_b32 v5, 4, v2
v_cmp_eq_u32 vcc, 0, v5
s_nop 1
v_cndmask_b32 v240, 0, -1, vcc
v_and_b32 v244, 15, v2
v_lshlrev_b32 v233, 14, v5
v_lshl_add_u32 v233, v244, 4, v233
v_and_b32 v3, 7, v2
v_bfe_u32 v4, v2, 3, 1
v_lshl_add_u32 v241, v3, 1, v4
v_lshlrev_b32 v241, 3, v241
v_lshl_add_u32 v236, v5, 14, v241
LH_L6:
Lpad812:
s_cbranch_execz Lpad894
s_waitcnt vmcnt(9)
s_barrier
s_mul_i32 s62, s58, 36
v_min_u32 v26, 35, v2
v_add_u32 v26, s62, v26
v_lshlrev_b32 v26, 3, v26
s_mul_i32 s62, s57, 1152
s_add_u32 s62, s62, 44343296
v_add_u32 v27, s62, v26
v_add_u32 v26, 150528, v26
v_add_u32 v200, 0, v27
v_add_u32 v201, 18432, v27
v_add_u32 v202, 36864, v27
v_add_u32 v203, 55296, v27
v_add_u32 v204, 73728, v27
v_add_u32 v205, 92160, v27
s_lshl_b32 s55, s84, 9
s_add_u32 s55, s55, 44310528
v_and_b32 v27, 255, v8
buffer_load_dwordx2 v[176:177], v200, s[20:23], 0 offen sc1
buffer_load_dwordx2 v[178:179], v201, s[20:23], 0 offen sc1
buffer_load_dwordx2 v[180:181], v202, s[20:23], 0 offen sc1
buffer_load_dwordx2 v[182:183], v203, s[20:23], 0 offen sc1
buffer_load_dwordx2 v[184:185], v204, s[20:23], 0 offen sc1
buffer_load_dwordx2 v[186:187], v205, s[20:23], 0 offen sc1
buffer_load_dwordx4 v[188:191], v27, s[20:23], s55 offen offset:0 sc1
buffer_load_dwordx4 v[192:195], v27, s[20:23], s55 offen offset:256 sc1
s_mul_i32 s69, s68, 221184
s_add_u32 s69, s69, s77
s_add_u32 m0, s73, 38912
s_mov_b32 exec_hi, 0
buffer_load_dwordx4 v15, s[8:11], s69 offen lds
s_mov_b32 exec_hi, -1
buffer_load_dwordx4 v16, s[8:11], s69 offen offset:512 lds
buffer_load_dwordx4 v17, s[8:11], s69 offen offset:1536 lds
buffer_load_dwordx4 v18, s[8:11], s69 offen offset:2560 lds
s_add_u32 s68, s68, 1
s_cmp_eq_u32 s68, 9
s_cselect_b32 s68, 0, s68
LH_L7:
s_waitcnt vmcnt(12)
s_barrier
s_waitcnt vmcnt(4)
Lp5:
v_xor_b32 v177, s59, v177
v_bitop3_b32 v177, s59, v179, v177 bitop3:0xbe
v_bitop3_b32 v177, s59, v181, v177 bitop3:0xbe
v_bitop3_b32 v177, s59, v183, v177 bitop3:0xbe
v_bitop3_b32 v177, s59, v185, v177 bitop3:0xbe
v_bitop3_b32 v177, s59, v187, v177 bitop3:0xbe
v_bitop3_b32 v177, s59, v189, v177 bitop3:0xbe
v_bitop3_b32 v177, s59, v191, v177 bitop3:0xbe
v_bitop3_b32 v177, s59, v193, v177 bitop3:0xbe
v_bitop3_b32 v177, s59, v195, v177 bitop3:0xbe
v_cmp_ne_u32 vcc, 0, v177
s_cbranch_vccz Lq6
buffer_load_dwordx2 v[176:177], v200, s[20:23], 0 offen sc1
buffer_load_dwordx2 v[178:179], v201, s[20:23], 0 offen sc1
buffer_load_dwordx2 v[180:181], v202, s[20:23], 0 offen sc1
buffer_load_dwordx2 v[182:183], v203, s[20:23], 0 offen sc1
buffer_load_dwordx2 v[184:185], v204, s[20:23], 0 offen sc1
buffer_load_dwordx2 v[186:187], v205, s[20:23], 0 offen sc1
buffer_load_dwordx4 v[188:191], v27, s[20:23], s55 offen offset:0 sc1
buffer_load_dwordx4 v[192:195], v27, s[20:23], s55 offen offset:256 sc1
s_waitcnt vmcnt(0)
s_add_u32 s60, s60, 1
s_cmp_lt_u32 s60, 131072
s_cbranch_scc1 Lp5
Lq6:
v_add_f32 v176, v176, v178
v_add_f32 v176, v176, v180
v_add_f32 v176, v176, v182
v_add_f32 v176, v176, v184
v_add_f32 v176, v176, v186
v_cvt_pk_bf16_f32 v177, v176, v176
v_and_b32 v177, 0xffff0000, v177
v_sub_f32 v177, v176, v177
v_cvt_pk_bf16_f32 v176, v176, v177
v_mov_b32 v177, 0
ds_write_b64 v26, v[176:177]
s_mul_i32 s62, s58, 1664
s_add_u32 s62, s62, 153728
Lpad894:
s_cbranch_execz Lpad991
v_add_u32 v3, s62, v8
v_add_u32 v4, s62, v31
v_and_b32 v5, 63, v25
v_add_u32 v5, s62, v5
ds_write_b32 v5, v188 offset:1536
ds_write_b32 v5, v192 offset:1600
v_and_b32 v196, v240, v194
v_and_b32 v197, v240, v194
v_mov_b32 v198, v188
v_mov_b32 v199, v192
v_and_b32 v190, v240, v190
v_mov_b32 v191, v190
ds_write_b128 v3, v[196:199]
ds_write_b64 v4, v[190:191] offset:1024
LH_L8:
s_waitcnt lgkmcnt(0)
s_barrier
s_mul_i32 s69, s68, 221184
s_add_u32 s69, s69, s77
s_add_u32 m0, s73, 55296
s_mov_b32 exec_hi, 0
buffer_load_dwordx4 v15, s[8:11], s69 offen lds
s_mov_b32 exec_hi, -1
buffer_load_dwordx4 v16, s[8:11], s69 offen offset:512 lds
buffer_load_dwordx4 v17, s[8:11], s69 offen offset:1536 lds
buffer_load_dwordx4 v18, s[8:11], s69 offen offset:2560 lds
s_add_u32 s68, s68, 1
s_cmp_eq_u32 s68, 9
s_cselect_b32 s68, 0, s68
s_mul_i32 s69, s68, 221184
s_add_u32 s69, s69, s77
s_add_u32 m0, s73, 73728
s_mov_b32 exec_hi, 0
buffer_load_dwordx4 v15, s[8:11], s69 offen lds
s_mov_b32 exec_hi, -1
buffer_load_dwordx4 v16, s[8:11], s69 offen offset:512 lds
buffer_load_dwordx4 v17, s[8:11], s69 offen offset:1536 lds
buffer_load_dwordx4 v18, s[8:11], s69 offen offset:2560 lds
s_add_u32 s68, s68, 1
s_cmp_eq_u32 s68, 9
s_cselect_b32 s68, 0, s68
s_lshl_b32 s62, s2, 15
s_lshl_b32 s63, s58, 13
s_add_u32 s85, s62, s63
v_lshlrev_b32 v24, 7, v2
LH_C0:
s_barrier
s_mul_i32 s50, s2, 21846
s_lshr_b32 s50, s50, 16
s_mul_i32 s51, s50, 3
s_sub_u32 s51, s2, s51
s_mul_i32 s53, s51, 32256
s_lshl_b32 s62, s50, 9
s_add_u32 s53, s53, s62
s_lshl_b32 s62, s58, 7
s_add_u32 s53, s53, s62
s_add_u32 s53, s53, 44453888
s_sub_u32 s62, s50, 27
s_mov_b32 s63, 110592
s_cmp_lt_u32 s50, 27
s_cselect_b32 s50, s50, s62
s_cselect_b32 s55, s63, 294912
s_cselect_b64 vcc, -1, 0
s_cselect_b32 s0, s8, s12
s_cselect_b32 s1, s9, s13
s_cselect_b32 s64, s10, s14
s_mul_i32 s52, s51, 6
s_mul_i32 s52, s52, s55
s_lshl_b32 s62, s50, 7
s_add_u32 s52, s52, s62
v_cndmask_b32 v28, v28, v29, vcc
s_cmp_lt_u32 s2, 189
s_cselect_b32 s52, s52, 0x40000000
s_cselect_b32 s53, s53, 0x40000000
s_mov_b32 s36, s0
s_mov_b32 s37, s1
s_mov_b32 s38, s64
s_lshl_b32 s54, s58, 10
s_add_u32 m0, s54, 0
s_nop 0
buffer_load_dwordx4 v28, s[36:39], s52 offen lds
s_add_u32 s52, s52, s55
s_add_u32 m0, s54, 4096
s_nop 0
buffer_load_dwordx4 v28, s[36:39], s52 offen lds
s_add_u32 s52, s52, s55
s_add_u32 m0, s54, 8192
s_nop 0
buffer_load_dwordx4 v28, s[36:39], s52 offen lds
s_add_u32 s52, s52, s55
s_add_u32 m0, s54, 12288
s_nop 0
buffer_load_dwordx4 v28, s[36:39], s52 offen lds
s_add_u32 s52, s52, s55
s_add_u32 m0, s54, 16384
s_nop 0
buffer_load_dwordx4 v28, s[36:39], s52 offen lds
Lpad991:
s_cbranch_execz Lback4
s_add_u32 s52, s52, s55
s_add_u32 m0, s54, 20480
s_nop 0
buffer_load_dwordx4 v28, s[36:39], s52 offen lds
s_add_u32 s52, s52, s55
s_mul_i32 s69, s68, 221184
s_add_u32 s69, s69, s77
s_add_u32 m0, s73, 90112
s_mov_b32 exec_hi, 0
buffer_load_dwordx4 v15, s[8:11], s69 offen lds
s_mov_b32 exec_hi, -1
buffer_load_dwordx4 v16, s[8:11], s69 offen offset:512 lds
buffer_load_dwordx4 v17, s[8:11], s69 offen offset:1536 lds
buffer_load_dwordx4 v18, s[8:11], s69 offen offset:2560 lds
s_add_u32 s68, s68, 1
s_cmp_eq_u32 s68, 9
s_cselect_b32 s68, 0, s68
buffer_load_dword v72, v24, s[16:19], s85 offen
s_bfe_u32 s62, s2, 65541
s_lshl_b32 s62, s62, 2
s_add_u32 s62, s62, s58
s_mov_b32 s3, 1
s_mov_b64 exec, 0
s_cmp_eq_u32 s62, 0
s_cbranch_scc1 Lpad6388
s_cmp_eq_u32 s62, 1
s_cbranch_scc1 Lpad6956
s_cmp_eq_u32 s62, 2
s_cbranch_scc1 Lpad7544
s_cmp_eq_u32 s62, 3
s_cbranch_scc1 Lpad8058
s_cmp_eq_u32 s62, 4
s_cbranch_scc1 Lpad8644
s_cmp_eq_u32 s62, 5
s_cbranch_scc1 Lpad1497
s_cmp_eq_u32 s62, 6
s_cbranch_scc1 Lpad2084
s_branch Lpad2707
Lback0:
s_cmp_eq_u32 s3, 1
s_mov_b32 s3, 0
s_mov_b64 exec, -1
LH_E:
s_waitcnt vmcnt(5)
s_barrier
ds_read_b128 v[32:35], v7 offset:0
ds_read_b128 v[36:39], v7 offset:1024
ds_read_b128 v[40:43], v7 offset:2048
ds_read_b128 v[44:47], v7 offset:3072
ds_read_b128 v[48:51], v7 offset:4096
ds_read_b128 v[52:55], v7 offset:5120
ds_read_b128 v[56:59], v7 offset:6144
ds_read_b128 v[60:63], v7 offset:7168
ds_read_b128 v[64:67], v7 offset:8192
s_mul_i32 s69, s68, 221184
s_add_u32 s69, s69, s77
s_add_u32 m0, s73, 24576
s_mov_b32 exec_hi, 0
buffer_load_dwordx4 v15, s[8:11], s69 offen lds
s_mov_b32 exec_hi, -1
ds_read_b64_tr_b16 v[172:173], v30 offset:0
ds_read_b64_tr_b16 v[174:175], v30 offset:2048
ds_read_b64_tr_b16 v[176:177], v30 offset:4096
buffer_load_dwordx4 v16, s[8:11], s69 offen offset:512 lds
ds_read_b64_tr_b16 v[178:179], v30 offset:6144
ds_read_b64_tr_b16 v[180:181], v30 offset:8192
ds_read_b64_tr_b16 v[182:183], v30 offset:10240
buffer_load_dwordx4 v17, s[8:11], s69 offen offset:1536 lds
ds_read_b64_tr_b16 v[184:185], v30 offset:12288
ds_read_b64_tr_b16 v[186:187], v30 offset:14336
ds_read_b64_tr_b16 v[188:189], v30 offset:16384
ds_read_b64_tr_b16 v[190:191], v30 offset:18432
buffer_load_dwordx4 v18, s[8:11], s69 offen offset:2560 lds
s_add_u32 s68, s68, 1
s_cmp_eq_u32 s68, 9
s_cselect_b32 s68, 0, s68
ds_read_b64_tr_b16 v[192:193], v30 offset:20480
ds_read_b64_tr_b16 v[194:195], v30 offset:22528
s_waitcnt lgkmcnt(10)
v_mfma_f32_16x16x32_bf16 v[152:155], v[248:251], v[172:175], 0
s_waitcnt lgkmcnt(8)
v_mfma_f32_16x16x32_bf16 v[152:155], v[248:251], v[176:179], v[152:155]
s_waitcnt lgkmcnt(6)
v_mfma_f32_16x16x32_bf16 v[152:155], v[248:251], v[180:183], v[152:155]
s_waitcnt lgkmcnt(4)
v_mfma_f32_16x16x32_bf16 v[152:155], v[248:251], v[184:187], v[152:155]
s_waitcnt lgkmcnt(2)
v_mfma_f32_16x16x32_bf16 v[152:155], v[248:251], v[188:191], v[152:155]
Lpad1079:
s_cbranch_execz Lpad1177
s_waitcnt lgkmcnt(0)
v_mfma_f32_16x16x32_bf16 v[152:155], v[248:251], v[192:195], v[152:155]
s_nop 7
v_mov_b32 v153, s59
s_mov_b64 exec, 0xffff
buffer_store_dwordx2 v[152:153], v31, s[20:23], s53 offen sc1
s_mov_b64 exec, -1
s_lshl_b32 s50, s84, 13
s_add_u32 s50, s50, 34250752
s_add_u32 s51, s50, 4096
v_lshrrev_b32 v3, 4, v2
v_lshlrev_b32 v3, 7, v3
v_and_b32 v4, 7, v2
v_lshl_add_u32 v3, v4, 4, v3
v_and_b32 v4, 8, v2
v_lshl_add_u32 v9, v4, 6, v3
s_lshl_b32 s52, s57, 6
s_add_u32 s52, s52, s84
s_lshl_b32 s53, s52, 2
s_add_u32 s53, s53, 44224512
s_mul_i32 s52, s52, 9216
s_add_u32 s52, s52, 2621440
s_lshl_b32 s54, s77, 11
s_lshl_b32 s65, s84, 8
s_add_u32 s54, s54, s65
s_add_u32 s54, s54, 12058624
s_lshl_b32 s55, s56, 8
s_lshl_b32 s65, s57, 4
s_add_u32 s55, s55, s65
s_lshl_b32 s65, s58, 2
s_add_u32 s55, s55, s65
s_add_u32 s55, s55, 44228608
s_lshl_b32 s86, s57, 8
s_add_u32 s86, s86, 44224512
LH_Y:
s_barrier
s_bfe_u32 s62, s2, 65541
s_lshl_b32 s62, s62, 2
s_add_u32 s62, s62, s58
s_mov_b32 s3, 1
s_mov_b64 exec, 0
s_cmp_eq_u32 s62, 0
s_cbranch_scc1 Lpad3257
s_cmp_eq_u32 s62, 1
s_cbranch_scc1 Lpad3401
s_cmp_eq_u32 s62, 2
s_cbranch_scc1 Lpad3470
s_cmp_eq_u32 s62, 3
s_cbranch_scc1 Lpad3642
s_cmp_eq_u32 s62, 4
s_cbranch_scc1 Lpad3718
s_cmp_eq_u32 s62, 5
s_cbranch_scc1 Lpad3797
s_cmp_eq_u32 s62, 6
s_cbranch_scc1 Lpad3955
s_branch Lpad4032
Lback1:
s_cmp_eq_u32 s3, 1
s_mov_b32 s3, 0
s_mov_b64 exec, -1
LH_L10:
s_barrier
s_mul_i32 s69, s68, 221184
s_add_u32 s69, s69, s77
s_add_u32 m0, s73, 38912
s_mov_b32 exec_hi, 0
buffer_load_dwordx4 v15, s[8:11], s69 offen lds
s_mov_b32 exec_hi, -1
buffer_load_dwordx4 v16, s[8:11], s69 offen offset:512 lds
buffer_load_dwordx4 v17, s[8:11], s69 offen offset:1536 lds
buffer_load_dwordx4 v18, s[8:11], s69 offen offset:2560 lds
s_add_u32 s68, s68, 1
s_cmp_eq_u32 s68, 9
s_cselect_b32 s68, 0, s68
LH_L11:
s_waitcnt vmcnt(10)
s_barrier
s_mul_i32 s69, s68, 221184
s_add_u32 s69, s69, s77
s_add_u32 m0, s73, 55296
s_mov_b32 exec_hi, 0
buffer_load_dwordx4 v15, s[8:11], s69 offen lds
s_mov_b32 exec_hi, -1
buffer_load_dwordx4 v16, s[8:11], s69 offen offset:512 lds
buffer_load_dwordx4 v17, s[8:11], s69 offen offset:1536 lds
buffer_load_dwordx4 v18, s[8:11], s69 offen offset:2560 lds
s_add_u32 s68, s68, 1
s_cmp_eq_u32 s68, 9
s_cselect_b32 s68, 0, s68
buffer_load_dwordx4 v[68:71], v9, s[20:23], s50 offen offset:0 sc1
buffer_load_dwordx4 v[72:75], v9, s[20:23], s50 offen offset:1024 sc1
buffer_load_dwordx4 v[76:79], v9, s[20:23], s50 offen offset:2048 sc1
buffer_load_dwordx4 v[80:83], v9, s[20:23], s50 offen offset:3072 sc1
buffer_load_dwordx4 v[84:87], v9, s[20:23], s51 offen offset:0 sc1
buffer_load_dwordx4 v[88:91], v9, s[20:23], s51 offen offset:1024 sc1
buffer_load_dwordx4 v[92:95], v9, s[20:23], s51 offen offset:2048 sc1
buffer_load_dwordx4 v[96:99], v9, s[20:23], s51 offen offset:3072 sc1
LH_L12:
Lpad1177:
s_cbranch_execz Lpad1260
s_waitcnt vmcnt(17)
s_barrier
s_mul_i32 s69, s68, 221184
s_add_u32 s69, s69, s77
s_add_u32 m0, s73, 73728
s_mov_b32 exec_hi, 0
buffer_load_dwordx4 v15, s[8:11], s69 offen lds
s_mov_b32 exec_hi, -1
buffer_load_dwordx4 v16, s[8:11], s69 offen offset:512 lds
buffer_load_dwordx4 v17, s[8:11], s69 offen offset:1536 lds
buffer_load_dwordx4 v18, s[8:11], s69 offen offset:2560 lds
s_add_u32 s68, s68, 1
s_cmp_eq_u32 s68, 9
s_cselect_b32 s68, 0, s68
LH_L13:
s_waitcnt vmcnt(16)
s_barrier
s_mul_i32 s69, s68, 221184
s_add_u32 s69, s69, s77
s_add_u32 m0, s73, 0
s_mov_b32 exec_hi, 0
buffer_load_dwordx4 v15, s[8:11], s69 offen lds
s_mov_b32 exec_hi, -1
buffer_load_dwordx4 v16, s[8:11], s69 offen offset:512 lds
buffer_load_dwordx4 v17, s[8:11], s69 offen offset:1536 lds
buffer_load_dwordx4 v18, s[8:11], s69 offen offset:2560 lds
s_add_u32 s68, s68, 1
s_cmp_eq_u32 s68, 9
s_cselect_b32 s68, 0, s68
v_and_b32 v26, 255, v0
s_lshl_b32 s62, s77, 2
s_add_u32 s62, s62, 44453888
s_mul_i32 s63, s57, 1152
s_add_u32 s63, s63, 44466816
v_mov_b32 v3, s62
v_mov_b32 v4, s63
v_cmp_gt_u32 vcc, 112, v26
s_nop 1
v_cndmask_b32 v27, v4, v3, vcc
v_lshlrev_b32 v26, 3, v26
v_add_u32 v27, v27, v26
v_add_u32 v26, 151680, v26
v_add_u32 v200, 0, v27
v_add_u32 v201, 32256, v27
v_add_u32 v202, 64512, v27
buffer_load_dwordx2 v[176:177], v200, s[20:23], 0 offen sc1
buffer_load_dwordx2 v[178:179], v201, s[20:23], 0 offen sc1
buffer_load_dwordx2 v[180:181], v202, s[20:23], 0 offen sc1
s_waitcnt vmcnt(11)
Lp11:
v_xor_b32 v69, s59, v69
v_bitop3_b32 v69, s59, v71, v69 bitop3:0xbe
v_bitop3_b32 v69, s59, v73, v69 bitop3:0xbe
v_bitop3_b32 v69, s59, v75, v69 bitop3:0xbe
v_bitop3_b32 v69, s59, v77, v69 bitop3:0xbe
v_bitop3_b32 v69, s59, v79, v69 bitop3:0xbe
v_bitop3_b32 v69, s59, v81, v69 bitop3:0xbe
v_bitop3_b32 v69, s59, v83, v69 bitop3:0xbe
v_bitop3_b32 v69, s59, v85, v69 bitop3:0xbe
v_bitop3_b32 v69, s59, v87, v69 bitop3:0xbe
v_bitop3_b32 v69, s59, v89, v69 bitop3:0xbe
v_bitop3_b32 v69, s59, v91, v69 bitop3:0xbe
v_bitop3_b32 v69, s59, v93, v69 bitop3:0xbe
v_bitop3_b32 v69, s59, v95, v69 bitop3:0xbe
v_bitop3_b32 v69, s59, v97, v69 bitop3:0xbe
v_bitop3_b32 v69, s59, v99, v69 bitop3:0xbe
v_cmp_ne_u32 vcc, 0, v69
s_cbranch_vccz Lq12
buffer_load_dwordx4 v[68:71], v9, s[20:23], s50 offen offset:0 sc1
buffer_load_dwordx4 v[72:75], v9, s[20:23], s50 offen offset:1024 sc1
buffer_load_dwordx4 v[76:79], v9, s[20:23], s50 offen offset:2048 sc1
buffer_load_dwordx4 v[80:83], v9, s[20:23], s50 offen offset:3072 sc1
buffer_load_dwordx4 v[84:87], v9, s[20:23], s51 offen offset:0 sc1
buffer_load_dwordx4 v[88:91], v9, s[20:23], s51 offen offset:1024 sc1
buffer_load_dwordx4 v[92:95], v9, s[20:23], s51 offen offset:2048 sc1
buffer_load_dwordx4 v[96:99], v9, s[20:23], s51 offen offset:3072 sc1
s_waitcnt vmcnt(0)
s_add_u32 s60, s60, 1
s_cmp_lt_u32 s60, 131072
s_cbranch_scc1 Lp11
Lq12:
v_add_f32 v68, v68, v72
v_add_f32 v70, v70, v74
Lpad1260:
s_cbranch_execz Lpad1340
v_add_f32 v76, v76, v80
v_add_f32 v78, v78, v82
v_add_f32 v84, v84, v88
v_add_f32 v86, v86, v90
v_add_f32 v92, v92, v96
v_add_f32 v94, v94, v98
v_add_f32 v68, v68, v76
v_add_f32 v70, v70, v78
v_add_f32 v84, v84, v92
v_add_f32 v86, v86, v94
v_add_f32 v68, v68, v84
v_add_f32 v70, v70, v86
s_nop 0
v_add_f32_dpp v68, v68, v68 row_ror:8 row_mask:0xf bank_mask:0xf
v_add_f32_dpp v69, v70, v70 row_ror:8 row_mask:0xf bank_mask:0xf
v_mul_f32 v68, 0x39e38e39, v68
v_mul_f32 v69, 0x39e38e39, v69
v_fma_f32 v69, -v68, v68, v69
v_max_f32 v69, 0, v69
v_cvt_pk_bf16_f32 v68, v68, v68
v_and_b32 v68, 0xffff0000, v68
v_cvt_pk_bf16_f32 v69, v69, v69
v_and_b32 v69, 0xffff0000, v69
v_add_f32 v69, 0x3727c5ac, v69
v_cvt_pk_bf16_f32 v69, v69, v69
v_and_b32 v69, 0xffff0000, v69
v_sqrt_f32 v69, v69
s_nop 0
v_cvt_pk_bf16_f32 v69, v69, v69
v_and_b32 v69, 0xffff0000, v69
v_rcp_f32 v69, v69
s_nop 0
v_mul_f32 v68, v68, v69
v_sub_f32 v68, 0, v68
v_mov_b32_dpp v208, v69 row_newbcast:0 row_mask:0xf bank_mask:0xf
s_nop 0
v_mov_b32_dpp v216, v68 row_newbcast:0 row_mask:0xf bank_mask:0xf
v_mov_b32_dpp v209, v69 row_newbcast:1 row_mask:0xf bank_mask:0xf
v_mov_b32_dpp v217, v68 row_newbcast:1 row_mask:0xf bank_mask:0xf
v_mov_b32_dpp v210, v69 row_newbcast:2 row_mask:0xf bank_mask:0xf
v_mov_b32_dpp v218, v68 row_newbcast:2 row_mask:0xf bank_mask:0xf
v_mov_b32_dpp v211, v69 row_newbcast:3 row_mask:0xf bank_mask:0xf
v_mov_b32_dpp v219, v68 row_newbcast:3 row_mask:0xf bank_mask:0xf
v_mov_b32_dpp v212, v69 row_newbcast:4 row_mask:0xf bank_mask:0xf
v_mov_b32_dpp v220, v68 row_newbcast:4 row_mask:0xf bank_mask:0xf
v_mov_b32_dpp v213, v69 row_newbcast:5 row_mask:0xf bank_mask:0xf
v_mov_b32_dpp v221, v68 row_newbcast:5 row_mask:0xf bank_mask:0xf
v_mov_b32_dpp v214, v69 row_newbcast:6 row_mask:0xf bank_mask:0xf
v_mov_b32_dpp v222, v68 row_newbcast:6 row_mask:0xf bank_mask:0xf
v_mov_b32_dpp v215, v69 row_newbcast:7 row_mask:0xf bank_mask:0xf
v_mov_b32_dpp v223, v68 row_newbcast:7 row_mask:0xf bank_mask:0xf
LH_L14:
s_barrier
s_mul_i32 s69, s68, 589824
s_add_u32 s69, s69, s76
s_add_u32 m0, s72, 18432
s_mov_b32 exec_hi, 0
buffer_load_dwordx4 v10, s[12:15], s69 offen lds
s_mov_b32 exec_hi, -1
buffer_load_dwordx4 v11, s[12:15], s69 offen offset:512 lds
buffer_load_dwordx4 v12, s[12:15], s69 offen offset:1536 lds
buffer_load_dwordx4 v13, s[12:15], s69 offen offset:2560 lds
buffer_load_dwordx4 v14, s[12:15], s69 offen offset:3584 lds
s_add_u32 s68, s68, 1
s_cmp_eq_u32 s68, 9
s_cselect_b32 s68, 0, s68
v_lshlrev_b32 v72, 16, v32
v_and_b32 v73, 0xffff0000, v32
v_fma_f32 v72, v72, v208, v216
v_fma_f32 v73, v73, v209, v217
v_cvt_pk_bf16_f32 v32, v72, v73
v_lshlrev_b32 v74, 16, v33
v_and_b32 v75, 0xffff0000, v33
v_fma_f32 v74, v74, v210, v218
v_fma_f32 v75, v75, v211, v219
v_cvt_pk_bf16_f32 v33, v74, v75
v_lshlrev_b32 v72, 16, v34
v_and_b32 v73, 0xffff0000, v34
v_fma_f32 v72, v72, v212, v220
v_fma_f32 v73, v73, v213, v221
Lpad1340:
s_cbranch_execz Lpad1414
v_cvt_pk_bf16_f32 v34, v72, v73
v_lshlrev_b32 v74, 16, v35
v_and_b32 v75, 0xffff0000, v35
v_fma_f32 v74, v74, v214, v222
v_fma_f32 v75, v75, v215, v223
v_cvt_pk_bf16_f32 v35, v74, v75
buffer_store_dwordx4 v[32:35], v8, s[20:23], s52 offen offset:0 sc1
v_lshlrev_b32 v72, 16, v36
v_and_b32 v73, 0xffff0000, v36
v_fma_f32 v72, v72, v208, v216
v_fma_f32 v73, v73, v209, v217
v_cvt_pk_bf16_f32 v36, v72, v73
v_lshlrev_b32 v74, 16, v37
v_and_b32 v75, 0xffff0000, v37
v_fma_f32 v74, v74, v210, v218
v_fma_f32 v75, v75, v211, v219
v_cvt_pk_bf16_f32 v37, v74, v75
v_lshlrev_b32 v72, 16, v38
v_and_b32 v73, 0xffff0000, v38
v_fma_f32 v72, v72, v212, v220
v_fma_f32 v73, v73, v213, v221
v_cvt_pk_bf16_f32 v38, v72, v73
v_lshlrev_b32 v74, 16, v39
v_and_b32 v75, 0xffff0000, v39
v_fma_f32 v74, v74, v214, v222
v_fma_f32 v75, v75, v215, v223
v_cvt_pk_bf16_f32 v39, v74, v75
buffer_store_dwordx4 v[36:39], v8, s[20:23], s52 offen offset:1024 sc1
LH_L15:
s_waitcnt vmcnt(14)
s_barrier
s_mul_i32 s69, s68, 589824
s_add_u32 s69, s69, s76
s_add_u32 m0, s72, 36864
s_mov_b32 exec_hi, 0
buffer_load_dwordx4 v10, s[12:15], s69 offen lds
s_mov_b32 exec_hi, -1
buffer_load_dwordx4 v11, s[12:15], s69 offen offset:512 lds
buffer_load_dwordx4 v12, s[12:15], s69 offen offset:1536 lds
buffer_load_dwordx4 v13, s[12:15], s69 offen offset:2560 lds
buffer_load_dwordx4 v14, s[12:15], s69 offen offset:3584 lds
s_add_u32 s68, s68, 1
s_cmp_eq_u32 s68, 9
s_cselect_b32 s68, 0, s68
v_lshlrev_b32 v72, 16, v40
v_and_b32 v73, 0xffff0000, v40
v_fma_f32 v72, v72, v208, v216
v_fma_f32 v73, v73, v209, v217
v_cvt_pk_bf16_f32 v40, v72, v73
v_lshlrev_b32 v74, 16, v41
v_and_b32 v75, 0xffff0000, v41
v_fma_f32 v74, v74, v210, v218
v_fma_f32 v75, v75, v211, v219
v_cvt_pk_bf16_f32 v41, v74, v75
v_lshlrev_b32 v72, 16, v42
v_and_b32 v73, 0xffff0000, v42
v_fma_f32 v72, v72, v212, v220
v_fma_f32 v73, v73, v213, v221
v_cvt_pk_bf16_f32 v42, v72, v73
v_lshlrev_b32 v74, 16, v43
v_and_b32 v75, 0xffff0000, v43
v_fma_f32 v74, v74, v214, v222
v_fma_f32 v75, v75, v215, v223
v_cvt_pk_bf16_f32 v43, v74, v75
buffer_store_dwordx4 v[40:43], v8, s[20:23], s52 offen offset:2048 sc1
v_lshlrev_b32 v72, 16, v44
v_and_b32 v73, 0xffff0000, v44
v_fma_f32 v72, v72, v208, v216
v_fma_f32 v73, v73, v209, v217
v_cvt_pk_bf16_f32 v44, v72, v73
v_lshlrev_b32 v74, 16, v45
v_and_b32 v75, 0xffff0000, v45
v_fma_f32 v74, v74, v210, v218
v_fma_f32 v75, v75, v211, v219
Lpad1414:
s_cbranch_execz Lback0
v_cvt_pk_bf16_f32 v45, v74, v75
v_lshlrev_b32 v72, 16, v46
v_and_b32 v73, 0xffff0000, v46
v_fma_f32 v72, v72, v212, v220
v_fma_f32 v73, v73, v213, v221
v_cvt_pk_bf16_f32 v46, v72, v73
v_lshlrev_b32 v74, 16, v47
v_and_b32 v75, 0xffff0000, v47
v_fma_f32 v74, v74, v214, v222
v_fma_f32 v75, v75, v215, v223
v_cvt_pk_bf16_f32 v47, v74, v75
buffer_store_dwordx4 v[44:47], v8, s[20:23], s52 offen offset:3072 sc1
s_add_u32 s52, s52, 4096
LH_L16:
s_waitcnt vmcnt(17)
s_barrier
s_mul_i32 s69, s68, 589824
s_add_u32 s69, s69, s76
s_add_u32 m0, s72, 55296
s_mov_b32 exec_hi, 0
buffer_load_dwordx4 v10, s[12:15], s69 offen lds
s_mov_b32 exec_hi, -1
buffer_load_dwordx4 v11, s[12:15], s69 offen offset:512 lds
buffer_load_dwordx4 v12, s[12:15], s69 offen offset:1536 lds
buffer_load_dwordx4 v13, s[12:15], s69 offen offset:2560 lds
buffer_load_dwordx4 v14, s[12:15], s69 offen offset:3584 lds
s_add_u32 s68, s68, 1
s_cmp_eq_u32 s68, 9
s_cselect_b32 s68, 0, s68
s_waitcnt vmcnt(19)
Lp8:
v_xor_b32 v177, s59, v177
v_bitop3_b32 v177, s59, v179, v177 bitop3:0xbe
v_bitop3_b32 v177, s59, v181, v177 bitop3:0xbe
v_cmp_ne_u32 vcc, 0, v177
s_cbranch_vccz Lq9
buffer_load_dwordx2 v[176:177], v200, s[20:23], 0 offen sc1
buffer_load_dwordx2 v[178:179], v201, s[20:23], 0 offen sc1
buffer_load_dwordx2 v[180:181], v202, s[20:23], 0 offen sc1
s_waitcnt vmcnt(0)
s_add_u32 s60, s60, 1
s_cmp_lt_u32 s60, 131072
s_cbranch_scc1 Lp8
Lq9:
v_add_f32 v176, v176, v178
v_add_f32 v176, v176, v180
v_cvt_pk_bf16_f32 v177, v176, v176
v_and_b32 v177, 0xffff0000, v177
v_sub_f32 v177, v176, v177
v_cvt_pk_bf16_f32 v176, v176, v177
v_mov_b32 v177, 0
ds_write_b64 v26, v[176:177]
v_lshlrev_b32 v72, 16, v48
v_and_b32 v73, 0xffff0000, v48
v_fma_f32 v72, v72, v208, v216
v_fma_f32 v73, v73, v209, v217
v_cvt_pk_bf16_f32 v48, v72, v73
v_lshlrev_b32 v74, 16, v49
v_and_b32 v75, 0xffff0000, v49
v_fma_f32 v74, v74, v210, v218
v_fma_f32 v75, v75, v211, v219
v_cvt_pk_bf16_f32 v49, v74, v75
v_lshlrev_b32 v72, 16, v50
v_and_b32 v73, 0xffff0000, v50
v_fma_f32 v72, v72, v212, v220
v_fma_f32 v73, v73, v213, v221
v_cvt_pk_bf16_f32 v50, v72, v73
v_lshlrev_b32 v74, 16, v51
v_and_b32 v75, 0xffff0000, v51
v_fma_f32 v74, v74, v214, v222
v_fma_f32 v75, v75, v215, v223
v_cvt_pk_bf16_f32 v51, v74, v75
buffer_store_dwordx4 v[48:51], v8, s[20:23], s52 offen offset:0 sc1
LH_L17:
s_waitcnt vmcnt(15) lgkmcnt(0)
s_barrier
s_mul_i32 s69, s68, 589824
s_add_u32 s69, s69, s76
s_add_u32 m0, s72, 73728
s_mov_b32 exec_hi, 0
buffer_load_dwordx4 v10, s[12:15], s69 offen lds
s_mov_b32 exec_hi, -1
buffer_load_dwordx4 v11, s[12:15], s69 offen offset:512 lds
Lpad1497:
s_cbranch_execz Lpad1568
buffer_load_dwordx4 v12, s[12:15], s69 offen offset:1536 lds
buffer_load_dwordx4 v13, s[12:15], s69 offen offset:2560 lds
buffer_load_dwordx4 v14, s[12:15], s69 offen offset:3584 lds
s_add_u32 s68, s68, 1
s_cmp_eq_u32 s68, 9
s_cselect_b32 s68, 0, s68
v_lshlrev_b32 v72, 16, v52
v_and_b32 v73, 0xffff0000, v52
v_fma_f32 v72, v72, v208, v216
v_fma_f32 v73, v73, v209, v217
v_cvt_pk_bf16_f32 v52, v72, v73
v_lshlrev_b32 v74, 16, v53
v_and_b32 v75, 0xffff0000, v53
v_fma_f32 v74, v74, v210, v218
v_fma_f32 v75, v75, v211, v219
v_cvt_pk_bf16_f32 v53, v74, v75
v_lshlrev_b32 v72, 16, v54
v_and_b32 v73, 0xffff0000, v54
v_fma_f32 v72, v72, v212, v220
v_fma_f32 v73, v73, v213, v221
v_cvt_pk_bf16_f32 v54, v72, v73
v_lshlrev_b32 v74, 16, v55
v_and_b32 v75, 0xffff0000, v55
v_fma_f32 v74, v74, v214, v222
v_fma_f32 v75, v75, v215, v223
v_cvt_pk_bf16_f32 v55, v74, v75
buffer_store_dwordx4 v[52:55], v8, s[20:23], s52 offen offset:1024 sc1
v_lshlrev_b32 v72, 16, v56
v_and_b32 v73, 0xffff0000, v56
v_fma_f32 v72, v72, v208, v216
v_fma_f32 v73, v73, v209, v217
v_cvt_pk_bf16_f32 v56, v72, v73
v_lshlrev_b32 v74, 16, v57
v_and_b32 v75, 0xffff0000, v57
v_fma_f32 v74, v74, v210, v218
v_fma_f32 v75, v75, v211, v219
v_cvt_pk_bf16_f32 v57, v74, v75
v_lshlrev_b32 v72, 16, v58
v_and_b32 v73, 0xffff0000, v58
v_fma_f32 v72, v72, v212, v220
v_fma_f32 v73, v73, v213, v221
v_cvt_pk_bf16_f32 v58, v72, v73
v_lshlrev_b32 v74, 16, v59
v_and_b32 v75, 0xffff0000, v59
v_fma_f32 v74, v74, v214, v222
v_fma_f32 v75, v75, v215, v223
v_cvt_pk_bf16_f32 v59, v74, v75
buffer_store_dwordx4 v[56:59], v8, s[20:23], s52 offen offset:2048 sc1
v_lshlrev_b32 v72, 16, v60
v_and_b32 v73, 0xffff0000, v60
v_fma_f32 v72, v72, v208, v216
v_fma_f32 v73, v73, v209, v217
v_cvt_pk_bf16_f32 v60, v72, v73
v_lshlrev_b32 v74, 16, v61
v_and_b32 v75, 0xffff0000, v61
v_fma_f32 v74, v74, v210, v218
v_fma_f32 v75, v75, v211, v219
v_cvt_pk_bf16_f32 v61, v74, v75
v_lshlrev_b32 v72, 16, v62
v_and_b32 v73, 0xffff0000, v62
v_fma_f32 v72, v72, v212, v220
v_fma_f32 v73, v73, v213, v221
v_cvt_pk_bf16_f32 v62, v72, v73
v_lshlrev_b32 v74, 16, v63
v_and_b32 v75, 0xffff0000, v63
v_fma_f32 v74, v74, v214, v222
v_fma_f32 v75, v75, v215, v223
v_cvt_pk_bf16_f32 v63, v74, v75
buffer_store_dwordx4 v[60:63], v8, s[20:23], s52 offen offset:3072 sc1
s_add_u32 s52, s52, 4096
s_bfe_u32 s62, s2, 65541
Lpad1568:
s_cbranch_execz Lpad1659
s_lshl_b32 s62, s62, 2
s_add_u32 s62, s62, s58
s_mov_b32 s3, 1
s_mov_b64 exec, 0
s_cmp_eq_u32 s62, 0
s_cbranch_scc1 Lpad4120
s_cmp_eq_u32 s62, 1
s_cbranch_scc1 Lpad4289
s_cmp_eq_u32 s62, 2
s_cbranch_scc1 Lpad4362
s_cmp_eq_u32 s62, 3
s_cbranch_scc1 Lpad4437
s_cmp_eq_u32 s62, 4
s_cbranch_scc1 Lpad4507
s_cmp_eq_u32 s62, 5
s_cbranch_scc1 Lpad4587
s_cmp_eq_u32 s62, 6
s_cbranch_scc1 Lpad4674
s_branch Lpad4773
Lback3:
s_cmp_eq_u32 s3, 1
s_mov_b32 s3, 0
s_mov_b64 exec, -1
LH_L18:
s_waitcnt vmcnt(16)
s_barrier
ds_read_b128 v[136:139], v7 offset:0
ds_read_b128 v[140:143], v7 offset:1024
ds_read_b128 v[144:147], v7 offset:2048
ds_read_b128 v[148:151], v7 offset:3072
ds_read_b128 v[152:155], v7 offset:4096
ds_read_b128 v[156:159], v7 offset:5120
ds_read_b128 v[160:163], v7 offset:6144
s_mul_i32 s69, s68, 589824
s_add_u32 s69, s69, s76
s_add_u32 m0, s72, 0
s_mov_b32 exec_hi, 0
buffer_load_dwordx4 v10, s[12:15], s69 offen lds
s_mov_b32 exec_hi, -1
buffer_load_dwordx4 v11, s[12:15], s69 offen offset:512 lds
buffer_load_dwordx4 v12, s[12:15], s69 offen offset:1536 lds
buffer_load_dwordx4 v13, s[12:15], s69 offen offset:2560 lds
buffer_load_dwordx4 v14, s[12:15], s69 offen offset:3584 lds
s_add_u32 s68, s68, 1
s_cmp_eq_u32 s68, 9
s_cselect_b32 s68, 0, s68
v_lshlrev_b32 v72, 16, v64
v_and_b32 v73, 0xffff0000, v64
v_fma_f32 v72, v72, v208, v216
v_fma_f32 v73, v73, v209, v217
v_cvt_pk_bf16_f32 v64, v72, v73
v_lshlrev_b32 v74, 16, v65
v_and_b32 v75, 0xffff0000, v65
v_fma_f32 v74, v74, v210, v218
v_fma_f32 v75, v75, v211, v219
v_cvt_pk_bf16_f32 v65, v74, v75
v_lshlrev_b32 v72, 16, v66
v_and_b32 v73, 0xffff0000, v66
v_fma_f32 v72, v72, v212, v220
v_fma_f32 v73, v73, v213, v221
v_cvt_pk_bf16_f32 v66, v72, v73
v_lshlrev_b32 v74, 16, v67
v_and_b32 v75, 0xffff0000, v67
v_fma_f32 v74, v74, v214, v222
v_fma_f32 v75, v75, v215, v223
v_cvt_pk_bf16_f32 v67, v74, v75
buffer_store_dwordx4 v[64:67], v8, s[20:23], s52 offen offset:0 sc1
s_waitcnt lgkmcnt(0)
LH_L19:
s_waitcnt vmcnt(15)
s_barrier
s_mul_i32 s69, s68, 589824
s_add_u32 s69, s69, s76
s_add_u32 m0, s72, 18432
s_mov_b32 exec_hi, 0
buffer_load_dwordx4 v10, s[12:15], s69 offen lds
s_mov_b32 exec_hi, -1
buffer_load_dwordx4 v11, s[12:15], s69 offen offset:512 lds
buffer_load_dwordx4 v12, s[12:15], s69 offen offset:1536 lds
buffer_load_dwordx4 v13, s[12:15], s69 offen offset:2560 lds
buffer_load_dwordx4 v14, s[12:15], s69 offen offset:3584 lds
s_add_u32 s68, s68, 1
s_cmp_eq_u32 s68, 9
s_cselect_b32 s68, 0, s68
s_cmp_eq_u32 s57, 15
s_cselect_b32 s62, 0x40000000, s54
buffer_store_dwordx4 v[136:139], v233, s[20:23], s62 offen sc1
s_add_u32 s54, s54, 65536
LH_L20:
s_waitcnt vmcnt(15)
s_barrier
Lpad1659:
s_cbranch_execz Lpad1748
s_mul_i32 s69, s68, 589824
s_add_u32 s69, s69, s76
s_add_u32 m0, s72, 36864
s_mov_b32 exec_hi, 0
buffer_load_dwordx4 v10, s[12:15], s69 offen lds
s_mov_b32 exec_hi, -1
buffer_load_dwordx4 v11, s[12:15], s69 offen offset:512 lds
buffer_load_dwordx4 v12, s[12:15], s69 offen offset:1536 lds
buffer_load_dwordx4 v13, s[12:15], s69 offen offset:2560 lds
buffer_load_dwordx4 v14, s[12:15], s69 offen offset:3584 lds
s_add_u32 s68, s68, 1
s_cmp_eq_u32 s68, 9
s_cselect_b32 s68, 0, s68
s_waitcnt vmcnt(11)
v_mov_b32 v3, 0
v_mov_b32 v4, s59
s_mov_b64 exec, 1
buffer_store_dword v4, v3, s[20:23], s53 offen sc1
s_mov_b64 exec, -1
s_cmp_eq_u32 s57, 15
s_cselect_b32 s62, 0x40000000, s54
buffer_store_dwordx4 v[140:143], v233, s[20:23], s62 offen sc1
s_add_u32 s54, s54, 65536
s_cmp_eq_u32 s57, 15
s_cselect_b32 s62, 0x40000000, s54
buffer_store_dwordx4 v[144:147], v233, s[20:23], s62 offen sc1
s_add_u32 s54, s54, 65536
LH_L21:
s_barrier
s_mul_i32 s69, s68, 589824
s_add_u32 s69, s69, s76
s_add_u32 m0, s72, 55296
s_mov_b32 exec_hi, 0
buffer_load_dwordx4 v10, s[12:15], s69 offen lds
s_mov_b32 exec_hi, -1
buffer_load_dwordx4 v11, s[12:15], s69 offen offset:512 lds
buffer_load_dwordx4 v12, s[12:15], s69 offen offset:1536 lds
buffer_load_dwordx4 v13, s[12:15], s69 offen offset:2560 lds
buffer_load_dwordx4 v14, s[12:15], s69 offen offset:3584 lds
s_add_u32 s68, s68, 1
s_cmp_eq_u32 s68, 9
s_cselect_b32 s68, 0, s68
s_cmp_eq_u32 s57, 15
s_cselect_b32 s62, 0x40000000, s54
buffer_store_dwordx4 v[148:151], v233, s[20:23], s62 offen sc1
s_add_u32 s54, s54, 65536
LH_L22:
s_waitcnt vmcnt(15)
s_barrier
s_mul_i32 s69, s68, 589824
s_add_u32 s69, s69, s76
s_add_u32 m0, s72, 73728
s_mov_b32 exec_hi, 0
buffer_load_dwordx4 v10, s[12:15], s69 offen lds
s_mov_b32 exec_hi, -1
buffer_load_dwordx4 v11, s[12:15], s69 offen offset:512 lds
buffer_load_dwordx4 v12, s[12:15], s69 offen offset:1536 lds
buffer_load_dwordx4 v13, s[12:15], s69 offen offset:2560 lds
buffer_load_dwordx4 v14, s[12:15], s69 offen offset:3584 lds
s_add_u32 s68, s68, 1
s_cmp_eq_u32 s68, 9
s_cselect_b32 s68, 0, s68
buffer_store_dwordx4 v[152:155], v233, s[20:23], s54 offen sc1
s_add_u32 s54, s54, 65536
buffer_store_dwordx4 v[156:159], v233, s[20:23], s54 offen sc1
s_add_u32 s54, s54, 65536
LH_L23:
s_waitcnt vmcnt(16)
s_barrier
buffer_store_dwordx4 v[160:163], v233, s[20:23], s54 offen sc1
s_add_u32 s54, s54, 65536
LH_L24:
s_waitcnt vmcnt(9)
s_barrier
s_add_u32 m0, s45, 0
s_nop 0
buffer_load_dwordx4 v128, s[40:43], s44 offen lds
s_add_u32 m0, s45, 1024
s_nop 0
buffer_load_dwordx4 v129, s[40:43], s44 offen lds
s_add_u32 m0, s45, 2048
s_nop 0
buffer_load_dwordx4 v130, s[40:43], s44 offen lds
s_add_u32 m0, s45, 3072
s_nop 0
buffer_load_dwordx4 v131, s[40:43], s44 offen lds
s_add_u32 m0, s45, 4096
s_nop 0
buffer_load_dwordx4 v132, s[40:43], s44 offen lds
Lpad1748:
s_cbranch_execz Lpad1834
buffer_load_dword v6, v25, s[20:23], s86 offen offset:0 sc1
LH_L25:
s_waitcnt vmcnt(9)
s_barrier
s_waitcnt vmcnt(6)
v_mov_b32 v3, 0
v_mov_b32 v4, s59
s_mov_b64 exec, 1
buffer_store_dword v4, v3, s[20:23], s55 offen sc1
s_mov_b64 exec, -1
LH_L26:
s_barrier
s_waitcnt vmcnt(1)
Lp14:
v_cmp_ne_u32 vcc, s59, v6
s_cbranch_vccz Lq15
buffer_load_dword v6, v25, s[20:23], s86 offen offset:0 sc1
s_waitcnt vmcnt(0)
s_add_u32 s60, s60, 1
s_cmp_lt_u32 s60, 131072
s_cbranch_scc1 Lp14
Lq15:
s_add_u32 m0, s72, 16384
s_mov_b32 exec_hi, 0
buffer_load_dwordx4 v23, s[20:23], s79 offen sc1 lds
s_mov_b32 exec_hi, -1
buffer_load_dwordx4 v23, s[20:23], s79 offen offset:512 sc1 lds
buffer_load_dwordx4 v23, s[20:23], s79 offen offset:1536 sc1 lds
buffer_load_dwordx4 v23, s[20:23], s79 offen offset:2560 sc1 lds
buffer_load_dwordx4 v23, s[20:23], s79 offen offset:3584 sc1 lds
s_add_u32 s79, s79, 18432
s_cmp_eq_u32 s79, 589824
s_cselect_b32 s79, 0, s79
s_add_u32 m0, s74, 0
s_nop 0
buffer_load_dwordx4 v252, s[16:19], s78 offen offset:0 lds
buffer_load_dwordx4 v253, s[16:19], s78 offen offset:1024 lds
buffer_load_dwordx4 v254, s[16:19], s78 offen offset:2048 lds
buffer_load_dwordx4 v255, s[16:19], s78 offen offset:3072 lds
s_add_u32 s78, s78, 128
s_and_b32 s78, s78, 4095
s_add_u32 m0, s72, 51200
s_mov_b32 exec_hi, 0
buffer_load_dwordx4 v23, s[20:23], s79 offen sc1 lds
s_mov_b32 exec_hi, -1
buffer_load_dwordx4 v23, s[20:23], s79 offen offset:512 sc1 lds
buffer_load_dwordx4 v23, s[20:23], s79 offen offset:1536 sc1 lds
buffer_load_dwordx4 v23, s[20:23], s79 offen offset:2560 sc1 lds
buffer_load_dwordx4 v23, s[20:23], s79 offen offset:3584 sc1 lds
s_add_u32 s79, s79, 18432
s_cmp_eq_u32 s79, 589824
s_cselect_b32 s79, 0, s79
s_add_u32 m0, s74, 34816
s_nop 0
buffer_load_dwordx4 v252, s[16:19], s78 offen offset:0 lds
buffer_load_dwordx4 v253, s[16:19], s78 offen offset:1024 lds
buffer_load_dwordx4 v254, s[16:19], s78 offen offset:2048 lds
buffer_load_dwordx4 v255, s[16:19], s78 offen offset:3072 lds
s_add_u32 s78, s78, 128
s_and_b32 s78, s78, 4095
LH_C2:
s_barrier
s_add_u32 m0, s72, 86016
s_mov_b32 exec_hi, 0
buffer_load_dwordx4 v23, s[20:23], s79 offen sc1 lds
s_mov_b32 exec_hi, -1
s_lshl_b32 s83, s84, 7
s_lshl_b32 s63, s57, 2
s_add_u32 s83, s83, s63
buffer_load_dwordx4 v23, s[20:23], s79 offen offset:512 sc1 lds
s_add_u32 s83, s83, 44232704
s_lshl_b32 s62, s84, 4
buffer_load_dwordx4 v23, s[20:23], s79 offen offset:1536 sc1 lds
s_add_u32 s62, s62, s57
s_lshl_b32 s87, s62, 11
s_add_u32 s87, s87, 28573696
buffer_load_dwordx4 v23, s[20:23], s79 offen offset:2560 sc1 lds
s_lshl_b32 s82, s62, 8
s_add_u32 s82, s82, 30670848
v_lshrrev_b32 v5, 4, v2
buffer_load_dwordx4 v23, s[20:23], s79 offen offset:3584 sc1 lds
s_add_u32 s79, s79, 18432
s_cmp_eq_u32 s79, 589824
s_cselect_b32 s79, 0, s79
v_and_b32 v3, 7, v2
v_bfe_u32 v4, v2, 3, 1
Lpad1834:
s_cbranch_execz Lpad1918
s_add_u32 m0, s74, 69632
s_nop 0
buffer_load_dwordx4 v252, s[16:19], s78 offen offset:0 lds
v_lshlrev_b32 v243, 10, v4
v_lshl_add_u32 v243, v5, 8, v243
v_lshl_add_u32 v243, v3, 4, v243
buffer_load_dwordx4 v253, s[16:19], s78 offen offset:1024 lds
v_and_b32 v244, 15, v2
v_lshlrev_b32 v244, 3, v244
v_bfe_u32 v3, v2, 3, 1
buffer_load_dwordx4 v254, s[16:19], s78 offen offset:2048 lds
v_lshlrev_b32 v3, 3, v3
v_and_b32 v4, 3, v2
buffer_load_dwordx4 v255, s[16:19], s78 offen offset:3072 lds
s_add_u32 s78, s78, 128
s_and_b32 s78, s78, 4095
v_lshl_add_u32 v3, v4, 1, v3
v_bfe_u32 v6, v2, 2, 1
v_add_u32 v3, v3, v6
s_lshl_b32 s62, s58, 8
v_lshlrev_b32 v3, 3, v3
v_add_u32 v3, s62, v3
v_mul_u32_u24 v6, 3072, v5
v_add_u32 v245, v3, v6
v_add_u32 v245, 104448, v245
v_bfe_u32 v6, v2, 4, 1
v_lshlrev_b32 v6, 7, v6
v_sub_u32 v246, v245, v6
v_add_u32 v245, v245, v6
v_add_u32 v237, 116736, v3
v_add_u32 v6, 160384, v3
v_cmp_eq_u32 vcc, 3, v5
s_nop 1
v_cndmask_b32 v237, v237, v6, vcc
v_mov_b32 v6, 0x3f800000
v_cndmask_b32 v242, 0, v6, vcc
v_lshrrev_b32 v3, 5, v2
v_lshlrev_b32 v3, 3, v3
v_bfe_u32 v6, v2, 2, 2
v_lshl_add_u32 v3, v6, 1, v3
v_bfe_u32 v6, v2, 4, 1
v_add_u32 v3, v3, v6
v_lshlrev_b32 v3, 3, v3
v_add_u32 v3, s62, v3
ds_read_b64_tr_b16 v[108:109], v101 offset:0
ds_read_b64_tr_b16 v[110:111], v101 offset:2560
ds_read_b64_tr_b16 v[112:113], v101 offset:8
ds_read_b64_tr_b16 v[114:115], v101 offset:2568
ds_read_b64_tr_b16 v[116:117], v101 offset:64
ds_read_b64_tr_b16 v[118:119], v101 offset:2624
ds_read_b64_tr_b16 v[120:121], v101 offset:72
ds_read_b64_tr_b16 v[122:123], v101 offset:2632
ds_read_b64_tr_b16 v[124:125], v102 offset:128
ds_read_b64_tr_b16 v[126:127], v102 offset:2688
s_waitcnt lgkmcnt(8)
buffer_store_dwordx4 v[108:111], v8, s[20:23], s46 offen offset:0 sc1
s_waitcnt lgkmcnt(6)
buffer_store_dwordx4 v[112:115], v8, s[20:23], s46 offen offset:1024 sc1
s_waitcnt lgkmcnt(4)
buffer_store_dwordx4 v[116:119], v8, s[20:23], s46 offen offset:2048 sc1
s_waitcnt lgkmcnt(2)
buffer_store_dwordx4 v[120:123], v8, s[20:23], s46 offen offset:3072 sc1
s_waitcnt lgkmcnt(0)
buffer_store_dwordx4 v[124:127], v8, s[20:23], s47 offen offset:0 sc1
LH_E2:
s_waitcnt vmcnt(23)
s_barrier
v_mul_u32_u24 v6, 3136, v4
v_add_u32 v238, v3, v6
v_add_u32 v238, 132096, v238
v_add_u32 v239, 160384, v3
v_add_u32 v6, 144640, v3
v_cmp_eq_u32 vcc, 0, v4
s_nop 1
v_cndmask_b32 v239, v239, v6, vcc
v_bfe_u32 v3, v2, 2, 1
v_lshl_add_u32 v3, v3, 3, v4
v_bfe_u32 v6, v2, 3, 1
v_lshl_add_u32 v3, v6, 2, v3
v_lshlrev_b32 v5, 2, v5
v_add_u32 v6, 0, v5
v_cmp_gt_u32 s[88:89], v6, v3
v_add_u32 v6, 1, v5
v_cmp_gt_u32 s[90:91], v6, v3
Lpad1918:
s_cbranch_execz Lpad2000
v_add_u32 v6, 2, v5
v_cmp_gt_u32 s[92:93], v6, v3
v_add_u32 v6, 3, v5
v_cmp_gt_u32 s[94:95], v6, v3
v_mov_b32 v3, 0xffff
v_mov_b32 v4, 0xffff0000
v_cndmask_b32 v5, 0, v3, s[88:89]
v_cndmask_b32 v6, 0, v4, s[90:91]
v_or_b32 v234, v5, v6
v_cndmask_b32 v5, 0, v3, s[92:93]
v_cndmask_b32 v6, 0, v4, s[94:95]
v_or_b32 v235, v5, v6
s_mov_b32 s80, 0x3eae1a93
v_and_b32 v3, 255, v0
s_lshl_b32 s62, s56, 7
s_sub_u32 s62, 256, s62
v_mov_b32 v4, 0x3f803f80
v_mov_b32 v5, 0x3f80
v_mov_b32 v6, 0xf1493f80
v_cmp_gt_i32 vcc, s62, v3
v_lshlrev_b32 v3, 3, v3
v_add_u32 v3, 160384, v3
v_and_b32 v70, 127, v0
v_lshlrev_b32 v70, 3, v70
v_add_u32 v70, 162432, v70
ds_write_b64 v70, v[4:5]
v_mov_b32 v68, v4
v_cndmask_b32 v69, v5, v6, vcc
ds_write_b64 v3, v[68:69]
s_waitcnt lgkmcnt(0)
LH_G0:
s_waitcnt vmcnt(14)
s_barrier
s_add_u32 m0, s72, 16384
s_mov_b32 exec_hi, 0
buffer_load_dwordx4 v23, s[20:23], s79 offen sc1 lds
s_mov_b32 exec_hi, -1
buffer_load_dwordx4 v23, s[20:23], s79 offen offset:512 sc1 lds
buffer_load_dwordx4 v23, s[20:23], s79 offen offset:1536 sc1 lds
buffer_load_dwordx4 v23, s[20:23], s79 offen offset:2560 sc1 lds
buffer_load_dwordx4 v23, s[20:23], s79 offen offset:3584 sc1 lds
s_add_u32 s79, s79, 18432
s_cmp_eq_u32 s79, 589824
s_cselect_b32 s79, 0, s79
s_add_u32 m0, s74, 0
s_nop 0
buffer_load_dwordx4 v252, s[16:19], s78 offen offset:0 lds
buffer_load_dwordx4 v253, s[16:19], s78 offen offset:1024 lds
buffer_load_dwordx4 v254, s[16:19], s78 offen offset:2048 lds
buffer_load_dwordx4 v255, s[16:19], s78 offen offset:3072 lds
s_add_u32 s78, s78, 128
s_and_b32 s78, s78, 4095
s_add_u32 s50, s56, -2
s_max_i32 s50, s50, 0
s_lshl_b32 s50, s50, 10
s_add_u32 s51, s56, -1
s_max_i32 s51, s51, 0
s_lshl_b32 s51, s51, 10
s_add_u32 s52, s56, 0
s_max_i32 s52, s52, 0
s_lshl_b32 s52, s52, 10
s_lshl_b32 s69, s56, 8
s_sub_u32 s69, s69, 512
s_mov_b32 s70, 44228608
v_min_u32 v80, 752, v8
v_add_u32 v80, s69, v80
v_and_b32 v81, 255, v80
v_max_i32 v80, v80, v81
buffer_load_dwordx4 v[72:75], v80, s[20:23], s70 offen sc1
LH_X0:
s_waitcnt vmcnt(10)
s_barrier
s_add_u32 m0, s72, 51200
s_mov_b32 exec_hi, 0
buffer_load_dwordx4 v23, s[20:23], s79 offen sc1 lds
s_mov_b32 exec_hi, -1
buffer_load_dwordx4 v23, s[20:23], s79 offen offset:512 sc1 lds
buffer_load_dwordx4 v23, s[20:23], s79 offen offset:1536 sc1 lds
buffer_load_dwordx4 v23, s[20:23], s79 offen offset:2560 sc1 lds
buffer_load_dwordx4 v23, s[20:23], s79 offen offset:3584 sc1 lds
s_add_u32 s79, s79, 18432
s_cmp_eq_u32 s79, 589824
Lpad2000:
s_cbranch_execz Lback0
s_cselect_b32 s79, 0, s79
s_add_u32 m0, s74, 34816
s_nop 0
buffer_load_dwordx4 v252, s[16:19], s78 offen offset:0 lds
buffer_load_dwordx4 v253, s[16:19], s78 offen offset:1024 lds
buffer_load_dwordx4 v254, s[16:19], s78 offen offset:2048 lds
buffer_load_dwordx4 v255, s[16:19], s78 offen offset:3072 lds
s_add_u32 s78, s78, 128
s_and_b32 s78, s78, 4095
v_mov_b32 v9, 0
v_mov_b32 v22, s59
s_mov_b64 exec, 1
buffer_store_dword v22, v9, s[20:23], s49 offen sc1
s_mov_b64 exec, -1
LH_X1:
s_waitcnt vmcnt(11)
s_barrier
s_add_u32 m0, s72, 86016
s_mov_b32 exec_hi, 0
buffer_load_dwordx4 v23, s[20:23], s79 offen sc1 lds
s_mov_b32 exec_hi, -1
buffer_load_dwordx4 v23, s[20:23], s79 offen offset:512 sc1 lds
buffer_load_dwordx4 v23, s[20:23], s79 offen offset:1536 sc1 lds
buffer_load_dwordx4 v23, s[20:23], s79 offen offset:2560 sc1 lds
buffer_load_dwordx4 v23, s[20:23], s79 offen offset:3584 sc1 lds
s_add_u32 s79, s79, 18432
s_cmp_eq_u32 s79, 589824
s_cselect_b32 s79, 0, s79
s_add_u32 m0, s74, 69632
s_nop 0
buffer_load_dwordx4 v252, s[16:19], s78 offen offset:0 lds
buffer_load_dwordx4 v253, s[16:19], s78 offen offset:1024 lds
buffer_load_dwordx4 v254, s[16:19], s78 offen offset:2048 lds
buffer_load_dwordx4 v255, s[16:19], s78 offen offset:3072 lds
s_add_u32 s78, s78, 128
s_and_b32 s78, s78, 4095
s_waitcnt vmcnt(19)
Lp17:
v_xor_b32 v72, s59, v72
v_bitop3_b32 v72, s59, v73, v72 bitop3:0xbe
v_bitop3_b32 v72, s59, v74, v72 bitop3:0xbe
v_bitop3_b32 v72, s59, v75, v72 bitop3:0xbe
v_cmp_ne_u32 vcc, 0, v72
s_cbranch_vccz Lq18
buffer_load_dwordx4 v[72:75], v80, s[20:23], s70 offen sc1
s_waitcnt vmcnt(0)
s_add_u32 s60, s60, 1
s_cmp_lt_u32 s60, 131072
s_cbranch_scc1 Lp17
Lq18:
s_mul_i32 s53, s57, 9
s_lshl_b32 s63, s84, 8
s_lshl_b32 s64, s53, 14
s_add_u32 s63, s63, s64
s_add_u32 s63, s63, 12058624
s_add_u32 s64, s63, 81920
s_add_u32 s65, s63, 65536
buffer_load_dwordx2 v[208:209], v236, s[20:23], s63 offen offset:0 sc1
buffer_load_dwordx2 v[210:211], v236, s[20:23], s64 offen offset:0 sc1
buffer_load_dwordx2 v[216:217], v241, s[20:23], s65 offen offset:0 sc1
buffer_load_dwordx2 v[212:213], v236, s[20:23], s63 offen offset:128 sc1
buffer_load_dwordx2 v[214:215], v236, s[20:23], s64 offen offset:128 sc1
buffer_load_dwordx2 v[218:219], v241, s[20:23], s65 offen offset:128 sc1
s_mov_b32 s62, s58
s_lshr_b32 s65, 0x14a, s62
s_and_b32 s65, s65, 1
s_lshl_b32 s65, s65, 7
v_xor_b32 v79, s65, v8
s_mul_i32 s63, s62, 3072
s_add_u32 s63, s63, 104448
s_mul_i32 s64, s62, 3136
s_add_u32 s64, s64, 103872
s_cmp_lt_u32 s62, 9
s_cselect_b32 s63, s63, s64
s_cselect_b32 s64, 0, 135
s_add_u32 s62, s62, s64
s_add_u32 s62, s62, s53
s_lshl_b32 s62, s62, 14
s_add_u32 s62, s62, 14417920
s_add_u32 m0, s63, 0
s_add_u32 s64, s62, s50
buffer_load_dwordx4 v79, s[20:23], s64 offen sc1 lds
s_add_u32 m0, s63, 1024
s_add_u32 s64, s62, s51
Lpad2084:
s_cbranch_execz Lpad2170
buffer_load_dwordx4 v79, s[20:23], s64 offen sc1 lds
s_add_u32 m0, s63, 2048
s_add_u32 s64, s62, s52
buffer_load_dwordx4 v79, s[20:23], s64 offen sc1 lds
s_mul_i32 s62, s58, 9
s_add_u32 s62, s62, 4
s_min_u32 s62, s62, 17
s_lshr_b32 s65, 0x14a, s62
s_and_b32 s65, s65, 1
s_lshl_b32 s65, s65, 7
v_xor_b32 v79, s65, v8
s_mul_i32 s63, s62, 3072
s_add_u32 s63, s63, 104448
s_mul_i32 s64, s62, 3136
s_add_u32 s64, s64, 103872
s_cmp_lt_u32 s62, 9
s_cselect_b32 s63, s63, s64
s_cselect_b32 s64, 0, 135
s_add_u32 s62, s62, s64
s_add_u32 s62, s62, s53
s_lshl_b32 s62, s62, 14
s_add_u32 s62, s62, 14417920
LH_X2:
s_waitcnt vmcnt(19)
s_barrier
s_add_u32 m0, s72, 16384
s_mov_b32 exec_hi, 0
buffer_load_dwordx4 v23, s[20:23], s79 offen sc1 lds
s_mov_b32 exec_hi, -1
buffer_load_dwordx4 v23, s[20:23], s79 offen offset:512 sc1 lds
buffer_load_dwordx4 v23, s[20:23], s79 offen offset:1536 sc1 lds
buffer_load_dwordx4 v23, s[20:23], s79 offen offset:2560 sc1 lds
buffer_load_dwordx4 v23, s[20:23], s79 offen offset:3584 sc1 lds
s_add_u32 s79, s79, 18432
s_cmp_eq_u32 s79, 589824
s_cselect_b32 s79, 0, s79
s_add_u32 m0, s74, 0
s_nop 0
buffer_load_dwordx4 v252, s[16:19], s78 offen offset:0 lds
buffer_load_dwordx4 v253, s[16:19], s78 offen offset:1024 lds
buffer_load_dwordx4 v254, s[16:19], s78 offen offset:2048 lds
buffer_load_dwordx4 v255, s[16:19], s78 offen offset:3072 lds
s_add_u32 s78, s78, 128
s_and_b32 s78, s78, 4095
s_cmp_ge_u32 s58, 2
s_cbranch_scc1 Lk19
s_add_u32 m0, s63, 0
s_add_u32 s64, s62, s50
buffer_load_dwordx4 v79, s[20:23], s64 offen sc1 lds
s_add_u32 m0, s63, 1024
s_add_u32 s64, s62, s51
buffer_load_dwordx4 v79, s[20:23], s64 offen sc1 lds
s_add_u32 m0, s63, 2048
s_add_u32 s64, s62, s52
buffer_load_dwordx4 v79, s[20:23], s64 offen sc1 lds
Lk19:
s_add_u32 s62, s58, 9
s_lshr_b32 s65, 0x14a, s62
s_and_b32 s65, s65, 1
s_lshl_b32 s65, s65, 7
v_xor_b32 v79, s65, v8
s_mul_i32 s63, s62, 3072
s_add_u32 s63, s63, 104448
s_mul_i32 s64, s62, 3136
s_add_u32 s64, s64, 103872
s_cmp_lt_u32 s62, 9
s_cselect_b32 s63, s63, s64
s_cselect_b32 s64, 0, 135
s_add_u32 s62, s62, s64
s_add_u32 s62, s62, s53
s_lshl_b32 s62, s62, 14
s_add_u32 s62, s62, 14417920
s_add_u32 m0, s63, 0
s_add_u32 s64, s62, s50
buffer_load_dwordx4 v79, s[20:23], s64 offen sc1 lds
s_add_u32 m0, s63, 1024
s_add_u32 s64, s62, s51
buffer_load_dwordx4 v79, s[20:23], s64 offen sc1 lds
s_add_u32 m0, s63, 2048
s_add_u32 s64, s62, s52
buffer_load_dwordx4 v79, s[20:23], s64 offen sc1 lds
s_add_u32 s62, s58, 5
s_mul_i32 s44, s62, 3072
s_add_u32 s44, s44, 104448
s_add_u32 s62, s62, s53
s_lshl_b32 s62, s62, 14
Lpad2170:
s_cbranch_execz Lpad2250
s_add_u32 s45, s62, 14417920
s_and_b32 s65, s58, 1
s_lshl_b32 s65, s65, 7
v_xor_b32 v24, s65, v8
s_add_u32 s62, s58, 5
s_mul_i32 s46, s62, 3136
s_add_u32 s46, s46, 132096
s_add_u32 s62, s62, s53
s_lshl_b32 s62, s62, 14
s_add_u32 s47, s62, 16777216
LH_X3:
s_waitcnt vmcnt(21)
s_barrier
s_add_u32 m0, s72, 51200
s_mov_b32 exec_hi, 0
buffer_load_dwordx4 v23, s[20:23], s79 offen sc1 lds
s_mov_b32 exec_hi, -1
buffer_load_dwordx4 v23, s[20:23], s79 offen offset:512 sc1 lds
buffer_load_dwordx4 v23, s[20:23], s79 offen offset:1536 sc1 lds
buffer_load_dwordx4 v23, s[20:23], s79 offen offset:2560 sc1 lds
buffer_load_dwordx4 v23, s[20:23], s79 offen offset:3584 sc1 lds
s_add_u32 s79, s79, 18432
s_cmp_eq_u32 s79, 589824
s_cselect_b32 s79, 0, s79
s_add_u32 m0, s74, 34816
s_nop 0
buffer_load_dwordx4 v252, s[16:19], s78 offen offset:0 lds
buffer_load_dwordx4 v253, s[16:19], s78 offen offset:1024 lds
buffer_load_dwordx4 v254, s[16:19], s78 offen offset:2048 lds
buffer_load_dwordx4 v255, s[16:19], s78 offen offset:3072 lds
s_add_u32 s78, s78, 128
s_and_b32 s78, s78, 4095
LH_X4:
s_waitcnt vmcnt(9)
s_barrier
s_add_u32 m0, s72, 86016
s_mov_b32 exec_hi, 0
buffer_load_dwordx4 v23, s[20:23], s79 offen sc1 lds
s_mov_b32 exec_hi, -1
v_mov_b32 v10, v208
v_mov_b32 v11, v209
v_and_b32 v12, v216, v240
v_mov_b32 v13, v242
buffer_load_dwordx4 v23, s[20:23], s79 offen offset:512 sc1 lds
v_mov_b32 v14, v212
v_mov_b32 v15, v213
v_and_b32 v16, v218, v240
buffer_load_dwordx4 v23, s[20:23], s79 offen offset:1536 sc1 lds
v_mov_b32 v17, v242
ds_read_b64 v[176:177], v245 offset:0
ds_read_b64 v[178:179], v237 offset:0
ds_read_b64 v[180:181], v246 offset:128
buffer_load_dwordx4 v23, s[20:23], s79 offen offset:2560 sc1 lds
ds_read_b64 v[182:183], v237 offset:128
ds_read_b64 v[184:185], v245 offset:256
ds_read_b64 v[186:187], v237 offset:256
ds_read_b64 v[188:189], v246 offset:384
buffer_load_dwordx4 v23, s[20:23], s79 offen offset:3584 sc1 lds
s_add_u32 s79, s79, 18432
s_cmp_eq_u32 s79, 589824
s_cselect_b32 s79, 0, s79
ds_read_b64 v[190:191], v237 offset:384
ds_read_b64 v[192:193], v245 offset:512
ds_read_b64 v[194:195], v237 offset:512
s_add_u32 m0, s74, 69632
s_nop 0
buffer_load_dwordx4 v252, s[16:19], s78 offen offset:0 lds
s_waitcnt lgkmcnt(8)
v_mfma_f32_16x16x32_bf16 v[32:35], v[176:179], v[10:13], 0
ds_read_b64 v[196:197], v246 offset:640
ds_read_b64 v[198:199], v237 offset:640
buffer_load_dwordx4 v253, s[16:19], s78 offen offset:1024 lds
s_waitcnt lgkmcnt(8)
v_mfma_f32_16x16x32_bf16 v[36:39], v[180:183], v[10:13], 0
v_mfma_f32_16x16x32_bf16 v[108:111], v[180:183], v[14:17], 0
ds_read_b64 v[200:201], v245 offset:768
buffer_load_dwordx4 v254, s[16:19], s78 offen offset:2048 lds
ds_read_b64 v[202:203], v237 offset:768
s_waitcnt lgkmcnt(8)
v_mfma_f32_16x16x32_bf16 v[40:43], v[184:187], v[10:13], 0
Lpad2250:
s_cbranch_execz Lpad2326
v_mfma_f32_16x16x32_bf16 v[112:115], v[184:187], v[14:17], 0
buffer_load_dwordx4 v255, s[16:19], s78 offen offset:3072 lds
s_add_u32 s78, s78, 128
s_and_b32 s78, s78, 4095
ds_read_b64 v[204:205], v246 offset:896
ds_read_b64 v[206:207], v237 offset:896
s_waitcnt lgkmcnt(8)
v_mfma_f32_16x16x32_bf16 v[44:47], v[188:191], v[10:13], 0
v_mfma_f32_16x16x32_bf16 v[116:119], v[188:191], v[14:17], 0
ds_read_b64 v[176:177], v245 offset:1024
ds_read_b64 v[178:179], v237 offset:1024
LH_X5:
s_waitcnt vmcnt(9)
s_barrier
s_add_u32 m0, s72, 16384
s_mov_b32 exec_hi, 0
buffer_load_dwordx4 v23, s[20:23], s79 offen sc1 lds
s_mov_b32 exec_hi, -1
v_max_f32 v4, v36, v37
v_max_f32 v5, v38, v39
s_waitcnt lgkmcnt(8)
buffer_load_dwordx4 v23, s[20:23], s79 offen offset:512 sc1 lds
v_mfma_f32_16x16x32_bf16 v[48:51], v[192:195], v[10:13], 0
v_mfma_f32_16x16x32_bf16 v[120:123], v[192:195], v[14:17], 0
ds_read_b64 v[180:181], v246 offset:1152
buffer_load_dwordx4 v23, s[20:23], s79 offen offset:1536 sc1 lds
ds_read_b64 v[182:183], v237 offset:1152
v_max3_f32 v4, v4, v40, v41
v_max3_f32 v5, v5, v42, v43
v_max_f32 v236, v112, v113
buffer_load_dwordx4 v23, s[20:23], s79 offen offset:2560 sc1 lds
v_max_f32 v241, v114, v115
s_waitcnt lgkmcnt(8)
v_mfma_f32_16x16x32_bf16 v[52:55], v[196:199], v[10:13], 0
buffer_load_dwordx4 v23, s[20:23], s79 offen offset:3584 sc1 lds
s_add_u32 s79, s79, 18432
s_cmp_eq_u32 s79, 589824
s_cselect_b32 s79, 0, s79
v_mfma_f32_16x16x32_bf16 v[124:127], v[196:199], v[14:17], 0
ds_read_b64 v[184:185], v245 offset:1280
ds_read_b64 v[186:187], v237 offset:1280
s_add_u32 m0, s74, 0
s_nop 0
buffer_load_dwordx4 v252, s[16:19], s78 offen offset:0 lds
v_max3_f32 v4, v4, v44, v45
v_max3_f32 v5, v5, v46, v47
v_max3_f32 v236, v236, v116, v117
buffer_load_dwordx4 v253, s[16:19], s78 offen offset:1024 lds
v_max3_f32 v241, v241, v118, v119
s_waitcnt lgkmcnt(8)
v_mfma_f32_16x16x32_bf16 v[56:59], v[200:203], v[10:13], 0
v_mfma_f32_16x16x32_bf16 v[128:131], v[200:203], v[14:17], 0
buffer_load_dwordx4 v254, s[16:19], s78 offen offset:2048 lds
ds_read_b64 v[188:189], v246 offset:1408
ds_read_b64 v[190:191], v237 offset:1408
v_max3_f32 v4, v4, v48, v49
buffer_load_dwordx4 v255, s[16:19], s78 offen offset:3072 lds
s_add_u32 s78, s78, 128
s_and_b32 s78, s78, 4095
v_max3_f32 v5, v5, v50, v51
v_max3_f32 v236, v236, v120, v121
v_max3_f32 v241, v241, v122, v123
s_add_u32 m0, s44, 0
s_add_u32 s64, s45, s50
buffer_load_dwordx4 v24, s[20:23], s64 offen sc1 lds
s_waitcnt lgkmcnt(8)
v_mfma_f32_16x16x32_bf16 v[60:63], v[204:207], v[10:13], 0
v_mfma_f32_16x16x32_bf16 v[132:135], v[204:207], v[14:17], 0
ds_read_b64 v[192:193], v245 offset:1536
ds_read_b64 v[194:195], v237 offset:1536
v_max3_f32 v4, v4, v52, v53
v_max3_f32 v5, v5, v54, v55
LH_X6:
s_waitcnt vmcnt(10)
s_barrier
s_add_u32 m0, s72, 51200
Lpad2326:
s_cbranch_execz Lpad2397
s_mov_b32 exec_hi, 0
buffer_load_dwordx4 v23, s[20:23], s79 offen sc1 lds
s_mov_b32 exec_hi, -1
v_max3_f32 v236, v236, v124, v125
v_max3_f32 v241, v241, v126, v127
s_waitcnt lgkmcnt(8)
buffer_load_dwordx4 v23, s[20:23], s79 offen offset:512 sc1 lds
v_mfma_f32_16x16x32_bf16 v[64:67], v[176:179], v[10:13], 0
v_mfma_f32_16x16x32_bf16 v[136:139], v[176:179], v[14:17], 0
ds_read_b64 v[196:197], v246 offset:1664
buffer_load_dwordx4 v23, s[20:23], s79 offen offset:1536 sc1 lds
ds_read_b64 v[198:199], v237 offset:1664
v_max3_f32 v4, v4, v56, v57
v_max3_f32 v5, v5, v58, v59
v_max3_f32 v236, v236, v128, v129
buffer_load_dwordx4 v23, s[20:23], s79 offen offset:2560 sc1 lds
v_max3_f32 v241, v241, v130, v131
s_waitcnt lgkmcnt(8)
v_mfma_f32_16x16x32_bf16 v[68:71], v[180:183], v[10:13], 0
buffer_load_dwordx4 v23, s[20:23], s79 offen offset:3584 sc1 lds
s_add_u32 s79, s79, 18432
s_cmp_eq_u32 s79, 589824
s_cselect_b32 s79, 0, s79
v_mfma_f32_16x16x32_bf16 v[140:143], v[180:183], v[14:17], 0
ds_read_b64 v[200:201], v245 offset:1792
ds_read_b64 v[202:203], v237 offset:1792
s_add_u32 m0, s74, 34816
s_nop 0
buffer_load_dwordx4 v252, s[16:19], s78 offen offset:0 lds
v_max3_f32 v4, v4, v60, v61
v_max3_f32 v5, v5, v62, v63
v_max3_f32 v236, v236, v132, v133
buffer_load_dwordx4 v253, s[16:19], s78 offen offset:1024 lds
v_max3_f32 v241, v241, v134, v135
s_waitcnt lgkmcnt(8)
v_mfma_f32_16x16x32_bf16 v[72:75], v[184:187], v[10:13], 0
v_mfma_f32_16x16x32_bf16 v[144:147], v[184:187], v[14:17], 0
buffer_load_dwordx4 v254, s[16:19], s78 offen offset:2048 lds
ds_read_b64 v[204:205], v246 offset:1920
ds_read_b64 v[206:207], v237 offset:1920
v_max3_f32 v4, v4, v64, v65
buffer_load_dwordx4 v255, s[16:19], s78 offen offset:3072 lds
s_add_u32 s78, s78, 128
s_and_b32 s78, s78, 4095
v_max3_f32 v5, v5, v66, v67
v_max3_f32 v236, v236, v136, v137
v_max3_f32 v241, v241, v138, v139
s_add_u32 m0, s44, 1024
s_add_u32 s64, s45, s51
buffer_load_dwordx4 v24, s[20:23], s64 offen sc1 lds
s_waitcnt lgkmcnt(8)
v_mfma_f32_16x16x32_bf16 v[76:79], v[188:191], v[10:13], 0
v_mfma_f32_16x16x32_bf16 v[148:151], v[188:191], v[14:17], 0
ds_read_b64 v[176:177], v245 offset:2048
ds_read_b64 v[178:179], v237 offset:2048
v_max3_f32 v4, v4, v68, v69
v_max3_f32 v5, v5, v70, v71
LH_X7:
s_waitcnt vmcnt(11)
s_barrier
s_add_u32 m0, s72, 86016
s_mov_b32 exec_hi, 0
buffer_load_dwordx4 v23, s[20:23], s79 offen sc1 lds
s_mov_b32 exec_hi, -1
v_max3_f32 v236, v236, v140, v141
v_max3_f32 v241, v241, v142, v143
s_waitcnt lgkmcnt(8)
buffer_load_dwordx4 v23, s[20:23], s79 offen offset:512 sc1 lds
v_mfma_f32_16x16x32_bf16 v[80:83], v[192:195], v[10:13], 0
v_mfma_f32_16x16x32_bf16 v[152:155], v[192:195], v[14:17], 0
ds_read_b64 v[180:181], v246 offset:2176
Lpad2397:
s_cbranch_execz Lpad2468
buffer_load_dwordx4 v23, s[20:23], s79 offen offset:1536 sc1 lds
ds_read_b64 v[182:183], v237 offset:2176
v_max3_f32 v4, v4, v72, v73
v_max3_f32 v5, v5, v74, v75
buffer_load_dwordx4 v23, s[20:23], s79 offen offset:2560 sc1 lds
v_max3_f32 v236, v236, v144, v145
v_max3_f32 v241, v241, v146, v147
s_waitcnt lgkmcnt(8)
buffer_load_dwordx4 v23, s[20:23], s79 offen offset:3584 sc1 lds
s_add_u32 s79, s79, 18432
s_cmp_eq_u32 s79, 589824
s_cselect_b32 s79, 0, s79
v_mfma_f32_16x16x32_bf16 v[84:87], v[196:199], v[10:13], 0
v_mfma_f32_16x16x32_bf16 v[156:159], v[196:199], v[14:17], 0
v_max3_f32 v4, v4, v76, v77
s_add_u32 m0, s74, 69632
s_nop 0
buffer_load_dwordx4 v252, s[16:19], s78 offen offset:0 lds
v_max3_f32 v5, v5, v78, v79
v_max3_f32 v236, v236, v148, v149
v_max3_f32 v241, v241, v150, v151
buffer_load_dwordx4 v253, s[16:19], s78 offen offset:1024 lds
s_waitcnt lgkmcnt(6)
v_mfma_f32_16x16x32_bf16 v[88:91], v[200:203], v[10:13], 0
v_mfma_f32_16x16x32_bf16 v[160:163], v[200:203], v[14:17], 0
buffer_load_dwordx4 v254, s[16:19], s78 offen offset:2048 lds
v_max3_f32 v4, v4, v80, v81
v_max3_f32 v5, v5, v82, v83
v_max3_f32 v236, v236, v152, v153
buffer_load_dwordx4 v255, s[16:19], s78 offen offset:3072 lds
s_add_u32 s78, s78, 128
s_and_b32 s78, s78, 4095
v_max3_f32 v241, v241, v154, v155
s_waitcnt lgkmcnt(4)
v_mfma_f32_16x16x32_bf16 v[92:95], v[204:207], v[10:13], 0
v_mfma_f32_16x16x32_bf16 v[164:167], v[204:207], v[14:17], 0
s_add_u32 m0, s44, 2048
s_add_u32 s64, s45, s52
buffer_load_dwordx4 v24, s[20:23], s64 offen sc1 lds
v_max3_f32 v4, v4, v84, v85
v_max3_f32 v5, v5, v86, v87
v_max3_f32 v236, v236, v156, v157
v_max3_f32 v241, v241, v158, v159
s_waitcnt lgkmcnt(2)
v_mfma_f32_16x16x32_bf16 v[96:99], v[176:179], v[10:13], 0
LH_X8:
s_waitcnt vmcnt(11)
s_barrier
s_add_u32 m0, s72, 16384
s_mov_b32 exec_hi, 0
buffer_load_dwordx4 v23, s[20:23], s79 offen sc1 lds
s_mov_b32 exec_hi, -1
v_mfma_f32_16x16x32_bf16 v[168:171], v[176:179], v[14:17], 0
v_max3_f32 v4, v4, v88, v89
v_max3_f32 v5, v5, v90, v91
v_max3_f32 v236, v236, v160, v161
v_max3_f32 v241, v241, v162, v163
buffer_load_dwordx4 v23, s[20:23], s79 offen offset:512 sc1 lds
s_waitcnt lgkmcnt(0)
v_mfma_f32_16x16x32_bf16 v[172:175], v[180:183], v[14:17], 0
v_max3_f32 v4, v4, v92, v93
v_max3_f32 v5, v5, v94, v95
buffer_load_dwordx4 v23, s[20:23], s79 offen offset:1536 sc1 lds
v_max3_f32 v236, v236, v164, v165
v_max3_f32 v241, v241, v166, v167
ds_read_b64_tr_b16 v[184:185], v238 offset:0
ds_read_b64_tr_b16 v[188:189], v239 offset:0
ds_read_b64_tr_b16 v[186:187], v238 offset:128
buffer_load_dwordx4 v23, s[20:23], s79 offen offset:2560 sc1 lds
ds_read_b64_tr_b16 v[190:191], v239 offset:128
v_max3_f32 v236, v236, v168, v169
Lpad2468:
s_cbranch_execz Lpad2550
v_max3_f32 v241, v241, v170, v171
v_cndmask_b32 v32, v96, v32, s[88:89]
buffer_load_dwordx4 v23, s[20:23], s79 offen offset:3584 sc1 lds
s_add_u32 s79, s79, 18432
s_cmp_eq_u32 s79, 589824
s_cselect_b32 s79, 0, s79
v_cndmask_b32 v33, v97, v33, s[90:91]
v_cndmask_b32 v34, v98, v34, s[92:93]
v_cndmask_b32 v35, v99, v35, s[94:95]
v_cndmask_b32 v108, v172, v108, s[88:89]
v_cndmask_b32 v109, v173, v109, s[90:91]
s_add_u32 m0, s74, 0
s_nop 0
buffer_load_dwordx4 v252, s[16:19], s78 offen offset:0 lds
v_cndmask_b32 v110, v174, v110, s[92:93]
v_cndmask_b32 v111, v175, v111, s[94:95]
v_max3_f32 v4, v4, v32, v33
v_max3_f32 v5, v5, v34, v35
v_max3_f32 v236, v236, v108, v109
buffer_load_dwordx4 v253, s[16:19], s78 offen offset:1024 lds
v_max3_f32 v241, v241, v110, v111
v_max_f32 v4, v4, v5
v_max_f32 v236, v236, v241
v_mov_b32 v5, v4
buffer_load_dwordx4 v254, s[16:19], s78 offen offset:2048 lds
v_mov_b32 v241, v236
ds_read_b64_tr_b16 v[192:193], v238 offset:256
ds_read_b64_tr_b16 v[196:197], v239 offset:256
ds_read_b64_tr_b16 v[194:195], v238 offset:384
ds_read_b64_tr_b16 v[198:199], v239 offset:384
buffer_load_dwordx4 v255, s[16:19], s78 offen offset:3072 lds
s_add_u32 s78, s78, 128
s_and_b32 s78, s78, 4095
v_permlane16_swap_b32 v4, v5
v_permlane16_swap_b32 v236, v241
v_max_f32 v4, v4, v5
v_max_f32 v236, v236, v241
s_add_u32 m0, s46, 0
s_add_u32 s64, s47, s50
buffer_load_dwordx4 v8, s[20:23], s64 offen sc1 lds
v_mov_b32 v5, v4
v_mov_b32 v241, v236
ds_read_b64_tr_b16 v[200:201], v238 offset:512
ds_read_b64_tr_b16 v[204:205], v239 offset:512
ds_read_b64_tr_b16 v[202:203], v238 offset:640
ds_read_b64_tr_b16 v[206:207], v239 offset:640
v_permlane32_swap_b32 v4, v5
v_permlane32_swap_b32 v236, v241
v_max_f32 v4, v4, v5
v_max_f32 v236, v236, v241
LH_X9:
s_waitcnt vmcnt(11)
s_barrier
s_add_u32 m0, s72, 51200
s_mov_b32 exec_hi, 0
buffer_load_dwordx4 v23, s[20:23], s79 offen sc1 lds
s_mov_b32 exec_hi, -1
v_mul_f32 v4, s80, v4
v_mul_f32 v236, s80, v236
v_fma_f32 v32, v32, s80, -v4
v_fma_f32 v33, v33, s80, -v4
v_fma_f32 v34, v34, s80, -v4
buffer_load_dwordx4 v23, s[20:23], s79 offen offset:512 sc1 lds
v_fma_f32 v35, v35, s80, -v4
v_exp_f32 v32, v32
v_exp_f32 v33, v33
v_exp_f32 v34, v34
buffer_load_dwordx4 v23, s[20:23], s79 offen offset:1536 sc1 lds
v_exp_f32 v35, v35
v_cvt_pk_bf16_f32 v100, v32, v33
v_cvt_pk_bf16_f32 v101, v34, v35
v_and_b32 v32, v100, v234
v_and_b32 v33, v101, v235
buffer_load_dwordx4 v23, s[20:23], s79 offen offset:2560 sc1 lds
v_xor_b32 v96, v100, v32
v_xor_b32 v97, v101, v33
v_mov_b32 v98, 0
v_mov_b32 v99, 0
buffer_load_dwordx4 v23, s[20:23], s79 offen offset:3584 sc1 lds
s_add_u32 s79, s79, 18432
s_cmp_eq_u32 s79, 589824
s_cselect_b32 s79, 0, s79
Lpad2550:
s_cbranch_execz Lpad2630
v_fma_f32 v36, v36, s80, -v4
v_fma_f32 v37, v37, s80, -v4
v_fma_f32 v38, v38, s80, -v4
v_fma_f32 v39, v39, s80, -v4
s_add_u32 m0, s74, 34816
s_nop 0
buffer_load_dwordx4 v252, s[16:19], s78 offen offset:0 lds
v_exp_f32 v36, v36
v_exp_f32 v37, v37
v_exp_f32 v38, v38
v_exp_f32 v39, v39
v_cvt_pk_bf16_f32 v34, v36, v37
buffer_load_dwordx4 v253, s[16:19], s78 offen offset:1024 lds
v_cvt_pk_bf16_f32 v35, v38, v39
v_fma_f32 v108, v108, s80, -v236
v_fma_f32 v109, v109, s80, -v236
v_fma_f32 v110, v110, s80, -v236
v_fma_f32 v111, v111, s80, -v236
buffer_load_dwordx4 v254, s[16:19], s78 offen offset:2048 lds
v_exp_f32 v108, v108
v_exp_f32 v109, v109
v_exp_f32 v110, v110
v_exp_f32 v111, v111
buffer_load_dwordx4 v255, s[16:19], s78 offen offset:3072 lds
s_add_u32 s78, s78, 128
s_and_b32 s78, s78, 4095
v_cvt_pk_bf16_f32 v172, v108, v109
v_cvt_pk_bf16_f32 v173, v110, v111
v_and_b32 v106, v172, v234
v_and_b32 v107, v173, v235
s_add_u32 m0, s46, 1024
s_add_u32 s64, s47, s51
buffer_load_dwordx4 v8, s[20:23], s64 offen sc1 lds
v_xor_b32 v172, v172, v106
v_xor_b32 v173, v173, v107
v_mov_b32 v104, 0
v_mov_b32 v105, 0
v_fma_f32 v40, v40, s80, -v4
v_fma_f32 v41, v41, s80, -v4
v_fma_f32 v42, v42, s80, -v4
v_fma_f32 v43, v43, s80, -v4
v_exp_f32 v40, v40
v_exp_f32 v41, v41
LH_X10:
s_waitcnt vmcnt(11)
s_barrier
s_add_u32 m0, s72, 86016
s_mov_b32 exec_hi, 0
buffer_load_dwordx4 v23, s[20:23], s79 offen sc1 lds
s_mov_b32 exec_hi, -1
v_exp_f32 v42, v42
v_exp_f32 v43, v43
v_cvt_pk_bf16_f32 v40, v40, v41
v_cvt_pk_bf16_f32 v41, v42, v43
buffer_load_dwordx4 v23, s[20:23], s79 offen offset:512 sc1 lds
v_fma_f32 v112, v112, s80, -v236
v_fma_f32 v113, v113, s80, -v236
v_fma_f32 v114, v114, s80, -v236
buffer_load_dwordx4 v23, s[20:23], s79 offen offset:1536 sc1 lds
v_fma_f32 v115, v115, s80, -v236
v_exp_f32 v112, v112
v_exp_f32 v113, v113
v_exp_f32 v114, v114
buffer_load_dwordx4 v23, s[20:23], s79 offen offset:2560 sc1 lds
v_exp_f32 v115, v115
v_cvt_pk_bf16_f32 v112, v112, v113
v_cvt_pk_bf16_f32 v113, v114, v115
buffer_load_dwordx4 v23, s[20:23], s79 offen offset:3584 sc1 lds
s_add_u32 s79, s79, 18432
s_cmp_eq_u32 s79, 589824
s_cselect_b32 s79, 0, s79
s_waitcnt lgkmcnt(8)
v_mfma_f32_16x16x32_bf16 v[220:223], v[184:187], v[32:35], 0
v_mfma_f32_16x16x32_bf16 v[18:21], v[188:191], v[32:35], 0
v_mfma_f32_16x16x32_bf16 v[224:227], v[184:187], v[104:107], 0
s_add_u32 m0, s74, 69632
s_nop 0
buffer_load_dwordx4 v252, s[16:19], s78 offen offset:0 lds
v_mfma_f32_16x16x32_bf16 v[248:251], v[188:191], v[104:107], 0
ds_read_b64_tr_b16 v[176:177], v238 offset:768
Lpad2630:
s_cbranch_execz Lback0
ds_read_b64_tr_b16 v[180:181], v239 offset:768
buffer_load_dwordx4 v253, s[16:19], s78 offen offset:1024 lds
ds_read_b64_tr_b16 v[178:179], v238 offset:896
ds_read_b64_tr_b16 v[182:183], v239 offset:896
v_fma_f32 v44, v44, s80, -v4
v_fma_f32 v45, v45, s80, -v4
buffer_load_dwordx4 v254, s[16:19], s78 offen offset:2048 lds
v_fma_f32 v46, v46, s80, -v4
v_fma_f32 v47, v47, s80, -v4
v_exp_f32 v44, v44
buffer_load_dwordx4 v255, s[16:19], s78 offen offset:3072 lds
s_add_u32 s78, s78, 128
s_and_b32 s78, s78, 4095
v_exp_f32 v45, v45
v_exp_f32 v46, v46
v_exp_f32 v47, v47
v_cvt_pk_bf16_f32 v42, v44, v45
s_add_u32 m0, s46, 2048
s_add_u32 s64, s47, s52
buffer_load_dwordx4 v8, s[20:23], s64 offen sc1 lds
v_cvt_pk_bf16_f32 v43, v46, v47
v_fma_f32 v116, v116, s80, -v236
v_fma_f32 v117, v117, s80, -v236
v_fma_f32 v118, v118, s80, -v236
v_fma_f32 v119, v119, s80, -v236
v_exp_f32 v116, v116
v_exp_f32 v117, v117
LH_X11:
s_waitcnt vmcnt(11)
s_barrier
s_add_u32 m0, s72, 16384
s_mov_b32 exec_hi, 0
buffer_load_dwordx4 v23, s[20:23], s79 offen sc1 lds
s_mov_b32 exec_hi, -1
v_exp_f32 v118, v118
v_exp_f32 v119, v119
v_cvt_pk_bf16_f32 v114, v116, v117
v_cvt_pk_bf16_f32 v115, v118, v119
buffer_load_dwordx4 v23, s[20:23], s79 offen offset:512 sc1 lds
v_fma_f32 v48, v48, s80, -v4
v_fma_f32 v49, v49, s80, -v4
v_fma_f32 v50, v50, s80, -v4
v_fma_f32 v51, v51, s80, -v4
buffer_load_dwordx4 v23, s[20:23], s79 offen offset:1536 sc1 lds
v_exp_f32 v48, v48
v_exp_f32 v49, v49
v_exp_f32 v50, v50
v_exp_f32 v51, v51
buffer_load_dwordx4 v23, s[20:23], s79 offen offset:2560 sc1 lds
v_cvt_pk_bf16_f32 v48, v48, v49
v_cvt_pk_bf16_f32 v49, v50, v51
v_fma_f32 v120, v120, s80, -v236
v_fma_f32 v121, v121, s80, -v236
buffer_load_dwordx4 v23, s[20:23], s79 offen offset:3584 sc1 lds
s_add_u32 s79, s79, 18432
s_cmp_eq_u32 s79, 589824
s_cselect_b32 s79, 0, s79
v_fma_f32 v122, v122, s80, -v236
v_fma_f32 v123, v123, s80, -v236
v_exp_f32 v120, v120
v_exp_f32 v121, v121
s_add_u32 m0, s74, 0
s_nop 0
buffer_load_dwordx4 v252, s[16:19], s78 offen offset:0 lds
v_exp_f32 v122, v122
v_exp_f32 v123, v123
v_cvt_pk_bf16_f32 v120, v120, v121
buffer_load_dwordx4 v253, s[16:19], s78 offen offset:1024 lds
v_cvt_pk_bf16_f32 v121, v122, v123
s_waitcnt lgkmcnt(8)
v_mfma_f32_16x16x32_bf16 v[220:223], v[192:195], v[40:43], v[220:223]
v_mfma_f32_16x16x32_bf16 v[18:21], v[196:199], v[40:43], v[18:21]
buffer_load_dwordx4 v254, s[16:19], s78 offen offset:2048 lds
v_mfma_f32_16x16x32_bf16 v[224:227], v[192:195], v[112:115], v[224:227]
v_mfma_f32_16x16x32_bf16 v[248:251], v[196:199], v[112:115], v[248:251]
ds_read_b64_tr_b16 v[184:185], v238 offset:1024
ds_read_b64_tr_b16 v[188:189], v239 offset:1024
Lpad2707:
s_cbranch_execz Lpad2786
buffer_load_dwordx4 v255, s[16:19], s78 offen offset:3072 lds
s_add_u32 s78, s78, 128
s_and_b32 s78, s78, 4095
ds_read_b64_tr_b16 v[186:187], v238 offset:1152
ds_read_b64_tr_b16 v[190:191], v239 offset:1152
v_fma_f32 v52, v52, s80, -v4
v_fma_f32 v53, v53, s80, -v4
v_fma_f32 v54, v54, s80, -v4
v_fma_f32 v55, v55, s80, -v4
v_exp_f32 v52, v52
v_exp_f32 v53, v53
LH_X12:
s_waitcnt vmcnt(10)
s_barrier
s_add_u32 m0, s72, 51200
s_mov_b32 exec_hi, 0
buffer_load_dwordx4 v23, s[20:23], s79 offen sc1 lds
s_mov_b32 exec_hi, -1
v_exp_f32 v54, v54
v_exp_f32 v55, v55
v_cvt_pk_bf16_f32 v50, v52, v53
v_cvt_pk_bf16_f32 v51, v54, v55
buffer_load_dwordx4 v23, s[20:23], s79 offen offset:512 sc1 lds
v_fma_f32 v124, v124, s80, -v236
v_fma_f32 v125, v125, s80, -v236
v_fma_f32 v126, v126, s80, -v236
v_fma_f32 v127, v127, s80, -v236
buffer_load_dwordx4 v23, s[20:23], s79 offen offset:1536 sc1 lds
v_exp_f32 v124, v124
v_exp_f32 v125, v125
v_exp_f32 v126, v126
v_exp_f32 v127, v127
buffer_load_dwordx4 v23, s[20:23], s79 offen offset:2560 sc1 lds
v_cvt_pk_bf16_f32 v122, v124, v125
v_cvt_pk_bf16_f32 v123, v126, v127
v_fma_f32 v56, v56, s80, -v4
v_fma_f32 v57, v57, s80, -v4
buffer_load_dwordx4 v23, s[20:23], s79 offen offset:3584 sc1 lds
s_add_u32 s79, s79, 18432
s_cmp_eq_u32 s79, 589824
s_cselect_b32 s79, 0, s79
v_fma_f32 v58, v58, s80, -v4
v_fma_f32 v59, v59, s80, -v4
v_exp_f32 v56, v56
v_exp_f32 v57, v57
s_add_u32 m0, s74, 34816
s_nop 0
buffer_load_dwordx4 v252, s[16:19], s78 offen offset:0 lds
v_exp_f32 v58, v58
v_exp_f32 v59, v59
v_cvt_pk_bf16_f32 v56, v56, v57
buffer_load_dwordx4 v253, s[16:19], s78 offen offset:1024 lds
v_cvt_pk_bf16_f32 v57, v58, v59
v_fma_f32 v128, v128, s80, -v236
v_fma_f32 v129, v129, s80, -v236
v_fma_f32 v130, v130, s80, -v236
buffer_load_dwordx4 v254, s[16:19], s78 offen offset:2048 lds
v_fma_f32 v131, v131, s80, -v236
v_exp_f32 v128, v128
v_exp_f32 v129, v129
v_exp_f32 v130, v130
buffer_load_dwordx4 v255, s[16:19], s78 offen offset:3072 lds
s_add_u32 s78, s78, 128
s_and_b32 s78, s78, 4095
v_exp_f32 v131, v131
v_cvt_pk_bf16_f32 v128, v128, v129
v_cvt_pk_bf16_f32 v129, v130, v131
s_waitcnt lgkmcnt(8)
v_mfma_f32_16x16x32_bf16 v[220:223], v[200:203], v[48:51], v[220:223]
v_mfma_f32_16x16x32_bf16 v[18:21], v[204:207], v[48:51], v[18:21]
v_mfma_f32_16x16x32_bf16 v[224:227], v[200:203], v[120:123], v[224:227]
v_mfma_f32_16x16x32_bf16 v[248:251], v[204:207], v[120:123], v[248:251]
LH_X13:
s_waitcnt vmcnt(9)
s_barrier
s_add_u32 m0, s72, 86016
s_mov_b32 exec_hi, 0
buffer_load_dwordx4 v23, s[20:23], s79 offen sc1 lds
s_mov_b32 exec_hi, -1
Lpad2786:
s_cbranch_execz Lpad2862
ds_read_b64_tr_b16 v[192:193], v238 offset:1280
ds_read_b64_tr_b16 v[196:197], v239 offset:1280
ds_read_b64_tr_b16 v[194:195], v238 offset:1408
ds_read_b64_tr_b16 v[198:199], v239 offset:1408
buffer_load_dwordx4 v23, s[20:23], s79 offen offset:512 sc1 lds
v_fma_f32 v60, v60, s80, -v4
v_fma_f32 v61, v61, s80, -v4
v_fma_f32 v62, v62, s80, -v4
v_fma_f32 v63, v63, s80, -v4
v_exp_f32 v60, v60
buffer_load_dwordx4 v23, s[20:23], s79 offen offset:1536 sc1 lds
v_exp_f32 v61, v61
v_exp_f32 v62, v62
v_exp_f32 v63, v63
v_cvt_pk_bf16_f32 v58, v60, v61
v_cvt_pk_bf16_f32 v59, v62, v63
buffer_load_dwordx4 v23, s[20:23], s79 offen offset:2560 sc1 lds
v_fma_f32 v132, v132, s80, -v236
v_fma_f32 v133, v133, s80, -v236
v_fma_f32 v134, v134, s80, -v236
v_fma_f32 v135, v135, s80, -v236
buffer_load_dwordx4 v23, s[20:23], s79 offen offset:3584 sc1 lds
s_add_u32 s79, s79, 18432
s_cmp_eq_u32 s79, 589824
s_cselect_b32 s79, 0, s79
v_exp_f32 v132, v132
v_exp_f32 v133, v133
v_exp_f32 v134, v134
v_exp_f32 v135, v135
s_add_u32 m0, s74, 69632
s_nop 0
buffer_load_dwordx4 v252, s[16:19], s78 offen offset:0 lds
v_cvt_pk_bf16_f32 v130, v132, v133
v_cvt_pk_bf16_f32 v131, v134, v135
v_fma_f32 v64, v64, s80, -v4
v_fma_f32 v65, v65, s80, -v4
v_fma_f32 v66, v66, s80, -v4
buffer_load_dwordx4 v253, s[16:19], s78 offen offset:1024 lds
v_fma_f32 v67, v67, s80, -v4
v_exp_f32 v64, v64
v_exp_f32 v65, v65
v_exp_f32 v66, v66
v_exp_f32 v67, v67
buffer_load_dwordx4 v254, s[16:19], s78 offen offset:2048 lds
v_cvt_pk_bf16_f32 v64, v64, v65
v_cvt_pk_bf16_f32 v65, v66, v67
v_fma_f32 v136, v136, s80, -v236
v_fma_f32 v137, v137, s80, -v236
buffer_load_dwordx4 v255, s[16:19], s78 offen offset:3072 lds
s_add_u32 s78, s78, 128
s_and_b32 s78, s78, 4095
v_fma_f32 v138, v138, s80, -v236
v_fma_f32 v139, v139, s80, -v236
v_exp_f32 v136, v136
v_exp_f32 v137, v137
v_exp_f32 v138, v138
v_exp_f32 v139, v139
v_cvt_pk_bf16_f32 v136, v136, v137
v_cvt_pk_bf16_f32 v137, v138, v139
s_waitcnt lgkmcnt(8)
LH_X14:
s_waitcnt vmcnt(9)
s_barrier
s_add_u32 m0, s72, 16384
s_mov_b32 exec_hi, 0
buffer_load_dwordx4 v23, s[20:23], s79 offen sc1 lds
s_mov_b32 exec_hi, -1
v_mfma_f32_16x16x32_bf16 v[220:223], v[176:179], v[56:59], v[220:223]
v_mfma_f32_16x16x32_bf16 v[18:21], v[180:183], v[56:59], v[18:21]
v_mfma_f32_16x16x32_bf16 v[224:227], v[176:179], v[128:131], v[224:227]
v_mfma_f32_16x16x32_bf16 v[248:251], v[180:183], v[128:131], v[248:251]
buffer_load_dwordx4 v23, s[20:23], s79 offen offset:512 sc1 lds
ds_read_b64_tr_b16 v[200:201], v238 offset:1536
ds_read_b64_tr_b16 v[204:205], v239 offset:1536
ds_read_b64_tr_b16 v[202:203], v238 offset:1664
ds_read_b64_tr_b16 v[206:207], v239 offset:1664
Lpad2862:
s_cbranch_execz Lpad2939
buffer_load_dwordx4 v23, s[20:23], s79 offen offset:1536 sc1 lds
v_fma_f32 v68, v68, s80, -v4
v_fma_f32 v69, v69, s80, -v4
v_fma_f32 v70, v70, s80, -v4
v_fma_f32 v71, v71, s80, -v4
buffer_load_dwordx4 v23, s[20:23], s79 offen offset:2560 sc1 lds
v_exp_f32 v68, v68
v_exp_f32 v69, v69
v_exp_f32 v70, v70
v_exp_f32 v71, v71
buffer_load_dwordx4 v23, s[20:23], s79 offen offset:3584 sc1 lds
s_add_u32 s79, s79, 18432
s_cmp_eq_u32 s79, 589824
s_cselect_b32 s79, 0, s79
v_cvt_pk_bf16_f32 v66, v68, v69
v_cvt_pk_bf16_f32 v67, v70, v71
v_fma_f32 v140, v140, s80, -v236
v_fma_f32 v141, v141, s80, -v236
s_add_u32 m0, s74, 0
s_nop 0
buffer_load_dwordx4 v252, s[16:19], s78 offen offset:0 lds
v_fma_f32 v142, v142, s80, -v236
v_fma_f32 v143, v143, s80, -v236
v_exp_f32 v140, v140
v_exp_f32 v141, v141
buffer_load_dwordx4 v253, s[16:19], s78 offen offset:1024 lds
v_exp_f32 v142, v142
v_exp_f32 v143, v143
v_cvt_pk_bf16_f32 v138, v140, v141
v_cvt_pk_bf16_f32 v139, v142, v143
buffer_load_dwordx4 v254, s[16:19], s78 offen offset:2048 lds
v_fma_f32 v72, v72, s80, -v4
v_fma_f32 v73, v73, s80, -v4
v_fma_f32 v74, v74, s80, -v4
v_fma_f32 v75, v75, s80, -v4
buffer_load_dwordx4 v255, s[16:19], s78 offen offset:3072 lds
s_add_u32 s78, s78, 128
s_and_b32 s78, s78, 4095
v_exp_f32 v72, v72
v_exp_f32 v73, v73
v_exp_f32 v74, v74
v_exp_f32 v75, v75
v_cvt_pk_bf16_f32 v72, v72, v73
v_cvt_pk_bf16_f32 v73, v74, v75
v_fma_f32 v144, v144, s80, -v236
v_fma_f32 v145, v145, s80, -v236
LH_X15:
s_waitcnt vmcnt(9)
s_barrier
s_add_u32 m0, s72, 51200
s_mov_b32 exec_hi, 0
buffer_load_dwordx4 v23, s[20:23], s79 offen sc1 lds
s_mov_b32 exec_hi, -1
v_fma_f32 v146, v146, s80, -v236
v_fma_f32 v147, v147, s80, -v236
v_exp_f32 v144, v144
v_exp_f32 v145, v145
buffer_load_dwordx4 v23, s[20:23], s79 offen offset:512 sc1 lds
v_exp_f32 v146, v146
v_exp_f32 v147, v147
v_cvt_pk_bf16_f32 v144, v144, v145
v_cvt_pk_bf16_f32 v145, v146, v147
buffer_load_dwordx4 v23, s[20:23], s79 offen offset:1536 sc1 lds
s_waitcnt lgkmcnt(8)
v_mfma_f32_16x16x32_bf16 v[220:223], v[184:187], v[64:67], v[220:223]
v_mfma_f32_16x16x32_bf16 v[18:21], v[188:191], v[64:67], v[18:21]
v_mfma_f32_16x16x32_bf16 v[224:227], v[184:187], v[136:139], v[224:227]
buffer_load_dwordx4 v23, s[20:23], s79 offen offset:2560 sc1 lds
v_mfma_f32_16x16x32_bf16 v[248:251], v[188:191], v[136:139], v[248:251]
ds_read_b64_tr_b16 v[176:177], v238 offset:1792
ds_read_b64_tr_b16 v[180:181], v239 offset:1792
ds_read_b64_tr_b16 v[178:179], v238 offset:1920
buffer_load_dwordx4 v23, s[20:23], s79 offen offset:3584 sc1 lds
s_add_u32 s79, s79, 18432
s_cmp_eq_u32 s79, 589824
s_cselect_b32 s79, 0, s79
ds_read_b64_tr_b16 v[182:183], v239 offset:1920
Lpad2939:
s_cbranch_execz Lpad3016
v_fma_f32 v76, v76, s80, -v4
v_fma_f32 v77, v77, s80, -v4
v_fma_f32 v78, v78, s80, -v4
s_add_u32 m0, s74, 34816
s_nop 0
buffer_load_dwordx4 v252, s[16:19], s78 offen offset:0 lds
v_fma_f32 v79, v79, s80, -v4
v_exp_f32 v76, v76
v_exp_f32 v77, v77
buffer_load_dwordx4 v253, s[16:19], s78 offen offset:1024 lds
v_exp_f32 v78, v78
v_exp_f32 v79, v79
v_cvt_pk_bf16_f32 v74, v76, v77
v_cvt_pk_bf16_f32 v75, v78, v79
buffer_load_dwordx4 v254, s[16:19], s78 offen offset:2048 lds
v_fma_f32 v148, v148, s80, -v236
v_fma_f32 v149, v149, s80, -v236
v_fma_f32 v150, v150, s80, -v236
v_fma_f32 v151, v151, s80, -v236
buffer_load_dwordx4 v255, s[16:19], s78 offen offset:3072 lds
s_add_u32 s78, s78, 128
s_and_b32 s78, s78, 4095
v_exp_f32 v148, v148
v_exp_f32 v149, v149
v_exp_f32 v150, v150
v_exp_f32 v151, v151
v_cvt_pk_bf16_f32 v146, v148, v149
v_cvt_pk_bf16_f32 v147, v150, v151
v_fma_f32 v80, v80, s80, -v4
v_fma_f32 v81, v81, s80, -v4
LH_X16:
s_waitcnt vmcnt(9)
s_barrier
s_add_u32 m0, s72, 86016
s_mov_b32 exec_hi, 0
buffer_load_dwordx4 v23, s[20:23], s79 offen sc1 lds
s_mov_b32 exec_hi, -1
v_fma_f32 v82, v82, s80, -v4
v_fma_f32 v83, v83, s80, -v4
v_exp_f32 v80, v80
v_exp_f32 v81, v81
buffer_load_dwordx4 v23, s[20:23], s79 offen offset:512 sc1 lds
v_exp_f32 v82, v82
v_exp_f32 v83, v83
v_cvt_pk_bf16_f32 v80, v80, v81
v_cvt_pk_bf16_f32 v81, v82, v83
buffer_load_dwordx4 v23, s[20:23], s79 offen offset:1536 sc1 lds
v_fma_f32 v152, v152, s80, -v236
v_fma_f32 v153, v153, s80, -v236
v_fma_f32 v154, v154, s80, -v236
v_fma_f32 v155, v155, s80, -v236
buffer_load_dwordx4 v23, s[20:23], s79 offen offset:2560 sc1 lds
v_exp_f32 v152, v152
v_exp_f32 v153, v153
v_exp_f32 v154, v154
v_exp_f32 v155, v155
buffer_load_dwordx4 v23, s[20:23], s79 offen offset:3584 sc1 lds
s_add_u32 s79, s79, 18432
s_cmp_eq_u32 s79, 589824
s_cselect_b32 s79, 0, s79
v_cvt_pk_bf16_f32 v152, v152, v153
v_cvt_pk_bf16_f32 v153, v154, v155
s_waitcnt lgkmcnt(8)
v_mfma_f32_16x16x32_bf16 v[220:223], v[192:195], v[72:75], v[220:223]
s_add_u32 m0, s74, 69632
s_nop 0
buffer_load_dwordx4 v252, s[16:19], s78 offen offset:0 lds
v_mfma_f32_16x16x32_bf16 v[18:21], v[196:199], v[72:75], v[18:21]
v_mfma_f32_16x16x32_bf16 v[224:227], v[192:195], v[144:147], v[224:227]
v_mfma_f32_16x16x32_bf16 v[248:251], v[196:199], v[144:147], v[248:251]
buffer_load_dwordx4 v253, s[16:19], s78 offen offset:1024 lds
ds_read_b64_tr_b16 v[184:185], v238 offset:2048
ds_read_b64_tr_b16 v[188:189], v239 offset:2048
ds_read_b64_tr_b16 v[186:187], v238 offset:2176
ds_read_b64_tr_b16 v[190:191], v239 offset:2176
buffer_load_dwordx4 v254, s[16:19], s78 offen offset:2048 lds
v_fma_f32 v84, v84, s80, -v4
Lpad3016:
s_cbranch_execz Lpad3095
v_fma_f32 v85, v85, s80, -v4
v_fma_f32 v86, v86, s80, -v4
v_fma_f32 v87, v87, s80, -v4
buffer_load_dwordx4 v255, s[16:19], s78 offen offset:3072 lds
s_add_u32 s78, s78, 128
s_and_b32 s78, s78, 4095
v_exp_f32 v84, v84
v_exp_f32 v85, v85
v_exp_f32 v86, v86
v_exp_f32 v87, v87
v_cvt_pk_bf16_f32 v82, v84, v85
v_cvt_pk_bf16_f32 v83, v86, v87
v_fma_f32 v156, v156, s80, -v236
v_fma_f32 v157, v157, s80, -v236
LH_X17:
s_waitcnt vmcnt(9)
s_barrier
s_add_u32 m0, s72, 16384
s_mov_b32 exec_hi, 0
buffer_load_dwordx4 v23, s[20:23], s79 offen sc1 lds
s_mov_b32 exec_hi, -1
v_fma_f32 v158, v158, s80, -v236
v_fma_f32 v159, v159, s80, -v236
v_exp_f32 v156, v156
v_exp_f32 v157, v157
buffer_load_dwordx4 v23, s[20:23], s79 offen offset:512 sc1 lds
v_exp_f32 v158, v158
v_exp_f32 v159, v159
v_cvt_pk_bf16_f32 v154, v156, v157
v_cvt_pk_bf16_f32 v155, v158, v159
buffer_load_dwordx4 v23, s[20:23], s79 offen offset:1536 sc1 lds
v_fma_f32 v88, v88, s80, -v4
v_fma_f32 v89, v89, s80, -v4
v_fma_f32 v90, v90, s80, -v4
v_fma_f32 v91, v91, s80, -v4
buffer_load_dwordx4 v23, s[20:23], s79 offen offset:2560 sc1 lds
v_exp_f32 v88, v88
v_exp_f32 v89, v89
v_exp_f32 v90, v90
v_exp_f32 v91, v91
buffer_load_dwordx4 v23, s[20:23], s79 offen offset:3584 sc1 lds
s_add_u32 s79, s79, 18432
s_cmp_eq_u32 s79, 589824
s_cselect_b32 s79, 0, s79
v_cvt_pk_bf16_f32 v88, v88, v89
v_cvt_pk_bf16_f32 v89, v90, v91
v_fma_f32 v160, v160, s80, -v236
v_fma_f32 v161, v161, s80, -v236
s_add_u32 m0, s74, 0
s_nop 0
buffer_load_dwordx4 v252, s[16:19], s78 offen offset:0 lds
v_fma_f32 v162, v162, s80, -v236
v_fma_f32 v163, v163, s80, -v236
v_exp_f32 v160, v160
buffer_load_dwordx4 v253, s[16:19], s78 offen offset:1024 lds
v_exp_f32 v161, v161
v_exp_f32 v162, v162
v_exp_f32 v163, v163
v_cvt_pk_bf16_f32 v160, v160, v161
buffer_load_dwordx4 v254, s[16:19], s78 offen offset:2048 lds
v_cvt_pk_bf16_f32 v161, v162, v163
s_waitcnt lgkmcnt(8)
v_mfma_f32_16x16x32_bf16 v[220:223], v[200:203], v[80:83], v[220:223]
v_mfma_f32_16x16x32_bf16 v[18:21], v[204:207], v[80:83], v[18:21]
buffer_load_dwordx4 v255, s[16:19], s78 offen offset:3072 lds
s_add_u32 s78, s78, 128
s_and_b32 s78, s78, 4095
v_mfma_f32_16x16x32_bf16 v[224:227], v[200:203], v[152:155], v[224:227]
v_mfma_f32_16x16x32_bf16 v[248:251], v[204:207], v[152:155], v[248:251]
v_fma_f32 v92, v92, s80, -v4
v_fma_f32 v93, v93, s80, -v4
v_fma_f32 v94, v94, s80, -v4
v_fma_f32 v95, v95, s80, -v4
v_exp_f32 v92, v92
v_exp_f32 v93, v93
LH_X18:
s_waitcnt vmcnt(9)
s_barrier
s_add_u32 m0, s72, 51200
Lpad3095:
s_cbranch_execz Lpad3181
s_mov_b32 exec_hi, 0
buffer_load_dwordx4 v23, s[20:23], s79 offen sc1 lds
s_mov_b32 exec_hi, -1
v_exp_f32 v94, v94
v_exp_f32 v95, v95
v_cvt_pk_bf16_f32 v90, v92, v93
buffer_load_dwordx4 v23, s[20:23], s79 offen offset:512 sc1 lds
v_cvt_pk_bf16_f32 v91, v94, v95
v_fma_f32 v164, v164, s80, -v236
v_fma_f32 v165, v165, s80, -v236
v_fma_f32 v166, v166, s80, -v236
buffer_load_dwordx4 v23, s[20:23], s79 offen offset:1536 sc1 lds
v_fma_f32 v167, v167, s80, -v236
v_exp_f32 v164, v164
v_exp_f32 v165, v165
buffer_load_dwordx4 v23, s[20:23], s79 offen offset:2560 sc1 lds
v_exp_f32 v166, v166
v_exp_f32 v167, v167
v_cvt_pk_bf16_f32 v162, v164, v165
v_cvt_pk_bf16_f32 v163, v166, v167
buffer_load_dwordx4 v23, s[20:23], s79 offen offset:3584 sc1 lds
s_add_u32 s79, s79, 18432
s_cmp_eq_u32 s79, 589824
s_cselect_b32 s79, 0, s79
v_fma_f32 v168, v168, s80, -v236
v_fma_f32 v169, v169, s80, -v236
v_fma_f32 v170, v170, s80, -v236
v_fma_f32 v171, v171, s80, -v236
s_add_u32 m0, s74, 34816
s_nop 0
buffer_load_dwordx4 v252, s[16:19], s78 offen offset:0 lds
v_exp_f32 v168, v168
v_exp_f32 v169, v169
v_exp_f32 v170, v170
buffer_load_dwordx4 v253, s[16:19], s78 offen offset:1024 lds
v_exp_f32 v171, v171
v_cvt_pk_bf16_f32 v168, v168, v169
v_cvt_pk_bf16_f32 v169, v170, v171
v_mov_b32 v170, v172
buffer_load_dwordx4 v254, s[16:19], s78 offen offset:2048 lds
v_mov_b32 v171, v173
s_waitcnt lgkmcnt(4)
v_mfma_f32_16x16x32_bf16 v[220:223], v[176:179], v[88:91], v[220:223]
buffer_load_dwordx4 v255, s[16:19], s78 offen offset:3072 lds
s_add_u32 s78, s78, 128
s_and_b32 s78, s78, 4095
v_mfma_f32_16x16x32_bf16 v[18:21], v[180:183], v[88:91], v[18:21]
v_mfma_f32_16x16x32_bf16 v[224:227], v[176:179], v[160:163], v[224:227]
v_mfma_f32_16x16x32_bf16 v[248:251], v[180:183], v[160:163], v[248:251]
s_waitcnt lgkmcnt(0)
v_mfma_f32_16x16x32_bf16 v[220:223], v[184:187], v[96:99], v[220:223]
v_mfma_f32_16x16x32_bf16 v[18:21], v[188:191], v[96:99], v[18:21]
v_mfma_f32_16x16x32_bf16 v[224:227], v[184:187], v[168:171], v[224:227]
LH_X19:
s_waitcnt vmcnt(9)
s_barrier
s_add_u32 m0, s72, 86016
s_mov_b32 exec_hi, 0
buffer_load_dwordx4 v23, s[20:23], s79 offen sc1 lds
s_mov_b32 exec_hi, -1
v_mfma_f32_16x16x32_bf16 v[248:251], v[188:191], v[168:171], v[248:251]
v_mov_b32 v4, v18
s_nop 6
v_mov_b32 v236, v248
v_mov_b32 v5, v18
v_mov_b32 v241, v248
buffer_load_dwordx4 v23, s[20:23], s79 offen offset:512 sc1 lds
v_permlane16_swap_b32 v4, v5
v_permlane16_swap_b32 v236, v241
v_rcp_f32 v5, v5
v_rcp_f32 v241, v241
v_mul_f32 v220, v220, v5
buffer_load_dwordx4 v23, s[20:23], s79 offen offset:1536 sc1 lds
v_mul_f32 v224, v224, v241
v_mul_f32 v221, v221, v5
v_mul_f32 v225, v225, v241
v_mul_f32 v222, v222, v5
v_mul_f32 v226, v226, v241
buffer_load_dwordx4 v23, s[20:23], s79 offen offset:2560 sc1 lds
v_mul_f32 v223, v223, v5
v_mul_f32 v227, v227, v241
v_mul_f32 v18, v18, v5
v_mul_f32 v248, v248, v241
v_mul_f32 v19, v19, v5
buffer_load_dwordx4 v23, s[20:23], s79 offen offset:3584 sc1 lds
s_add_u32 s79, s79, 18432
Lpad3181:
s_cbranch_execz Lback0
s_cmp_eq_u32 s79, 589824
s_cselect_b32 s79, 0, s79
v_mul_f32 v249, v249, v241
v_cvt_pk_bf16_f32 v228, v220, v221
v_cvt_pk_bf16_f32 v26, v224, v225
v_cvt_pk_bf16_f32 v229, v222, v223
s_add_u32 m0, s74, 69632
s_nop 0
buffer_load_dwordx4 v252, s[16:19], s78 offen offset:0 lds
v_cvt_pk_bf16_f32 v27, v226, v227
v_cvt_pk_bf16_f32 v232, v18, v19
v_cvt_pk_bf16_f32 v30, v248, v249
v_mov_b32 v10, v210
v_mov_b32 v11, v211
buffer_load_dwordx4 v253, s[16:19], s78 offen offset:1024 lds
v_mov_b32 v12, 0
v_and_or_b32 v13, v217, v240, v242
v_mov_b32 v14, v214
v_mov_b32 v15, v215
v_mov_b32 v16, 0
buffer_load_dwordx4 v254, s[16:19], s78 offen offset:2048 lds
v_and_or_b32 v17, v219, v240, v242
ds_read_b64 v[176:177], v245 offset:15360
ds_read_b64 v[178:179], v237 offset:0
ds_read_b64 v[180:181], v246 offset:15488
ds_read_b64 v[182:183], v237 offset:128
buffer_load_dwordx4 v255, s[16:19], s78 offen offset:3072 lds
s_add_u32 s78, s78, 128
s_and_b32 s78, s78, 4095
ds_read_b64 v[184:185], v245 offset:15616
ds_read_b64 v[186:187], v237 offset:256
ds_read_b64 v[188:189], v246 offset:15744
ds_read_b64 v[190:191], v237 offset:384
ds_read_b64 v[192:193], v245 offset:15872
ds_read_b64 v[194:195], v237 offset:512
s_waitcnt lgkmcnt(8)
v_mfma_f32_16x16x32_bf16 v[32:35], v[176:179], v[10:13], 0
ds_read_b64 v[196:197], v246 offset:16000
ds_read_b64 v[198:199], v237 offset:640
LH_X20:
s_waitcnt vmcnt(9)
s_barrier
s_add_u32 m0, s72, 16384
s_mov_b32 exec_hi, 0
buffer_load_dwordx4 v23, s[20:23], s79 offen sc1 lds
s_mov_b32 exec_hi, -1
s_waitcnt lgkmcnt(8)
v_mfma_f32_16x16x32_bf16 v[36:39], v[180:183], v[10:13], 0
v_mfma_f32_16x16x32_bf16 v[108:111], v[180:183], v[14:17], 0
buffer_load_dwordx4 v23, s[20:23], s79 offen offset:512 sc1 lds
ds_read_b64 v[200:201], v245 offset:16128
ds_read_b64 v[202:203], v237 offset:768
s_waitcnt lgkmcnt(8)
buffer_load_dwordx4 v23, s[20:23], s79 offen offset:1536 sc1 lds
v_mfma_f32_16x16x32_bf16 v[40:43], v[184:187], v[10:13], 0
v_mfma_f32_16x16x32_bf16 v[112:115], v[184:187], v[14:17], 0
ds_read_b64 v[204:205], v246 offset:16256
buffer_load_dwordx4 v23, s[20:23], s79 offen offset:2560 sc1 lds
ds_read_b64 v[206:207], v237 offset:896
s_waitcnt lgkmcnt(8)
v_mfma_f32_16x16x32_bf16 v[44:47], v[188:191], v[10:13], 0
buffer_load_dwordx4 v23, s[20:23], s79 offen offset:3584 sc1 lds
s_add_u32 s79, s79, 18432
s_cmp_eq_u32 s79, 589824
s_cselect_b32 s79, 0, s79
v_mfma_f32_16x16x32_bf16 v[116:119], v[188:191], v[14:17], 0
ds_read_b64 v[176:177], v245 offset:16384
s_add_u32 m0, s74, 0
s_nop 0
buffer_load_dwordx4 v252, s[16:19], s78 offen offset:0 lds
ds_read_b64 v[178:179], v237 offset:1024
v_max_f32 v4, v36, v37
v_max_f32 v5, v38, v39
buffer_load_dwordx4 v253, s[16:19], s78 offen offset:1024 lds
s_waitcnt lgkmcnt(8)
v_mfma_f32_16x16x32_bf16 v[48:51], v[192:195], v[10:13], 0
Lpad3257:
s_cbranch_execz Lpad3328
v_mfma_f32_16x16x32_bf16 v[120:123], v[192:195], v[14:17], 0
buffer_load_dwordx4 v254, s[16:19], s78 offen offset:2048 lds
ds_read_b64 v[180:181], v246 offset:16512
ds_read_b64 v[182:183], v237 offset:1152
v_max3_f32 v4, v4, v40, v41
buffer_load_dwordx4 v255, s[16:19], s78 offen offset:3072 lds
s_add_u32 s78, s78, 128
s_and_b32 s78, s78, 4095
v_max3_f32 v5, v5, v42, v43
v_max_f32 v236, v112, v113
v_max_f32 v241, v114, v115
s_waitcnt lgkmcnt(8)
v_mfma_f32_16x16x32_bf16 v[52:55], v[196:199], v[10:13], 0
v_mfma_f32_16x16x32_bf16 v[124:127], v[196:199], v[14:17], 0
LH_X21:
s_waitcnt vmcnt(9)
s_barrier
s_add_u32 m0, s72, 51200
s_mov_b32 exec_hi, 0
buffer_load_dwordx4 v23, s[20:23], s79 offen sc1 lds
s_mov_b32 exec_hi, -1
ds_read_b64 v[184:185], v245 offset:16640
ds_read_b64 v[186:187], v237 offset:1280
v_max3_f32 v4, v4, v44, v45
v_max3_f32 v5, v5, v46, v47
buffer_load_dwordx4 v23, s[20:23], s79 offen offset:512 sc1 lds
v_max3_f32 v236, v236, v116, v117
v_max3_f32 v241, v241, v118, v119
s_waitcnt lgkmcnt(8)
buffer_load_dwordx4 v23, s[20:23], s79 offen offset:1536 sc1 lds
v_mfma_f32_16x16x32_bf16 v[56:59], v[200:203], v[10:13], 0
v_mfma_f32_16x16x32_bf16 v[128:131], v[200:203], v[14:17], 0
ds_read_b64 v[188:189], v246 offset:16768
ds_read_b64 v[190:191], v237 offset:1408
buffer_load_dwordx4 v23, s[20:23], s79 offen offset:2560 sc1 lds
v_max3_f32 v4, v4, v48, v49
v_max3_f32 v5, v5, v50, v51
v_max3_f32 v236, v236, v120, v121
buffer_load_dwordx4 v23, s[20:23], s79 offen offset:3584 sc1 lds
s_add_u32 s79, s79, 18432
s_cmp_eq_u32 s79, 589824
s_cselect_b32 s79, 0, s79
v_max3_f32 v241, v241, v122, v123
s_waitcnt lgkmcnt(8)
v_mfma_f32_16x16x32_bf16 v[60:63], v[204:207], v[10:13], 0
v_mfma_f32_16x16x32_bf16 v[132:135], v[204:207], v[14:17], 0
s_add_u32 m0, s74, 34816
s_nop 0
buffer_load_dwordx4 v252, s[16:19], s78 offen offset:0 lds
ds_read_b64 v[192:193], v245 offset:16896
ds_read_b64 v[194:195], v237 offset:1536
v_max3_f32 v4, v4, v52, v53
v_max3_f32 v5, v5, v54, v55
buffer_load_dwordx4 v253, s[16:19], s78 offen offset:1024 lds
v_max3_f32 v236, v236, v124, v125
v_max3_f32 v241, v241, v126, v127
s_waitcnt lgkmcnt(8)
buffer_load_dwordx4 v254, s[16:19], s78 offen offset:2048 lds
v_mfma_f32_16x16x32_bf16 v[64:67], v[176:179], v[10:13], 0
v_mfma_f32_16x16x32_bf16 v[136:139], v[176:179], v[14:17], 0
ds_read_b64 v[196:197], v246 offset:17024
ds_read_b64 v[198:199], v237 offset:1664
buffer_load_dwordx4 v255, s[16:19], s78 offen offset:3072 lds
s_add_u32 s78, s78, 128
s_and_b32 s78, s78, 4095
v_max3_f32 v4, v4, v56, v57
v_max3_f32 v5, v5, v58, v59
v_max3_f32 v236, v236, v128, v129
v_max3_f32 v241, v241, v130, v131
s_waitcnt lgkmcnt(8)
v_mfma_f32_16x16x32_bf16 v[68:71], v[180:183], v[10:13], 0
Lpad3328:
s_cbranch_execz Lback1
v_mfma_f32_16x16x32_bf16 v[140:143], v[180:183], v[14:17], 0
LH_X22:
s_waitcnt vmcnt(9)
s_barrier
s_add_u32 m0, s72, 86016
s_mov_b32 exec_hi, 0
buffer_load_dwordx4 v23, s[20:23], s79 offen sc1 lds
s_mov_b32 exec_hi, -1
ds_read_b64 v[200:201], v245 offset:17152
ds_read_b64 v[202:203], v237 offset:1792
v_max3_f32 v4, v4, v60, v61
v_max3_f32 v5, v5, v62, v63
buffer_load_dwordx4 v23, s[20:23], s79 offen offset:512 sc1 lds
v_max3_f32 v236, v236, v132, v133
v_max3_f32 v241, v241, v134, v135
s_waitcnt lgkmcnt(8)
buffer_load_dwordx4 v23, s[20:23], s79 offen offset:1536 sc1 lds
v_mfma_f32_16x16x32_bf16 v[72:75], v[184:187], v[10:13], 0
v_mfma_f32_16x16x32_bf16 v[144:147], v[184:187], v[14:17], 0
ds_read_b64 v[204:205], v246 offset:17280
ds_read_b64 v[206:207], v237 offset:1920
buffer_load_dwordx4 v23, s[20:23], s79 offen offset:2560 sc1 lds
v_max3_f32 v4, v4, v64, v65
v_max3_f32 v5, v5, v66, v67
v_max3_f32 v236, v236, v136, v137
buffer_load_dwordx4 v23, s[20:23], s79 offen offset:3584 sc1 lds
s_add_u32 s79, s79, 18432
s_cmp_eq_u32 s79, 589824
s_cselect_b32 s79, 0, s79
v_max3_f32 v241, v241, v138, v139
s_waitcnt lgkmcnt(8)
v_mfma_f32_16x16x32_bf16 v[76:79], v[188:191], v[10:13], 0
v_mfma_f32_16x16x32_bf16 v[148:151], v[188:191], v[14:17], 0
s_add_u32 m0, s74, 69632
s_nop 0
buffer_load_dwordx4 v252, s[16:19], s78 offen offset:0 lds
ds_read_b64 v[176:177], v245 offset:17408
ds_read_b64 v[178:179], v237 offset:2048
v_max3_f32 v4, v4, v68, v69
v_max3_f32 v5, v5, v70, v71
buffer_load_dwordx4 v253, s[16:19], s78 offen offset:1024 lds
v_max3_f32 v236, v236, v140, v141
v_max3_f32 v241, v241, v142, v143
s_waitcnt lgkmcnt(8)
buffer_load_dwordx4 v254, s[16:19], s78 offen offset:2048 lds
v_mfma_f32_16x16x32_bf16 v[80:83], v[192:195], v[10:13], 0
v_mfma_f32_16x16x32_bf16 v[152:155], v[192:195], v[14:17], 0
ds_read_b64 v[180:181], v246 offset:17536
ds_read_b64 v[182:183], v237 offset:2176
buffer_load_dwordx4 v255, s[16:19], s78 offen offset:3072 lds
s_add_u32 s78, s78, 128
s_and_b32 s78, s78, 4095
v_max3_f32 v4, v4, v72, v73
v_max3_f32 v5, v5, v74, v75
v_max3_f32 v236, v236, v144, v145
v_max3_f32 v241, v241, v146, v147
s_waitcnt lgkmcnt(8)
v_mfma_f32_16x16x32_bf16 v[84:87], v[196:199], v[10:13], 0
v_mfma_f32_16x16x32_bf16 v[156:159], v[196:199], v[14:17], 0
LH_X23:
s_waitcnt vmcnt(9)
s_barrier
s_add_u32 m0, s72, 16384
s_mov_b32 exec_hi, 0
buffer_load_dwordx4 v23, s[20:23], s79 offen sc1 lds
s_mov_b32 exec_hi, -1
v_max3_f32 v4, v4, v76, v77
v_max3_f32 v5, v5, v78, v79
v_max3_f32 v236, v236, v148, v149
v_max3_f32 v241, v241, v150, v151
buffer_load_dwordx4 v23, s[20:23], s79 offen offset:512 sc1 lds
s_waitcnt lgkmcnt(6)
v_mfma_f32_16x16x32_bf16 v[88:91], v[200:203], v[10:13], 0
Lpad3401:
s_cbranch_execz Lback1
v_mfma_f32_16x16x32_bf16 v[160:163], v[200:203], v[14:17], 0
v_max3_f32 v4, v4, v80, v81
buffer_load_dwordx4 v23, s[20:23], s79 offen offset:1536 sc1 lds
v_max3_f32 v5, v5, v82, v83
v_max3_f32 v236, v236, v152, v153
v_max3_f32 v241, v241, v154, v155
buffer_load_dwordx4 v23, s[20:23], s79 offen offset:2560 sc1 lds
s_waitcnt lgkmcnt(4)
v_mfma_f32_16x16x32_bf16 v[92:95], v[204:207], v[10:13], 0
v_mfma_f32_16x16x32_bf16 v[164:167], v[204:207], v[14:17], 0
v_max3_f32 v4, v4, v84, v85
buffer_load_dwordx4 v23, s[20:23], s79 offen offset:3584 sc1 lds
s_add_u32 s79, s79, 18432
s_cmp_eq_u32 s79, 589824
s_cselect_b32 s79, 0, s79
v_max3_f32 v5, v5, v86, v87
v_max3_f32 v236, v236, v156, v157
v_max3_f32 v241, v241, v158, v159
s_waitcnt lgkmcnt(2)
s_add_u32 m0, s74, 0
s_nop 0
buffer_load_dwordx4 v252, s[16:19], s78 offen offset:0 lds
v_mfma_f32_16x16x32_bf16 v[96:99], v[176:179], v[10:13], 0
v_mfma_f32_16x16x32_bf16 v[168:171], v[176:179], v[14:17], 0
v_max3_f32 v4, v4, v88, v89
v_max3_f32 v5, v5, v90, v91
buffer_load_dwordx4 v253, s[16:19], s78 offen offset:1024 lds
v_max3_f32 v236, v236, v160, v161
v_max3_f32 v241, v241, v162, v163
s_waitcnt lgkmcnt(0)
v_mfma_f32_16x16x32_bf16 v[172:175], v[180:183], v[14:17], 0
buffer_load_dwordx4 v254, s[16:19], s78 offen offset:2048 lds
v_max3_f32 v4, v4, v92, v93
v_max3_f32 v5, v5, v94, v95
v_max3_f32 v236, v236, v164, v165
buffer_load_dwordx4 v255, s[16:19], s78 offen offset:3072 lds
s_add_u32 s78, s78, 128
s_and_b32 s78, s78, 4095
v_max3_f32 v241, v241, v166, v167
ds_read_b64_tr_b16 v[184:185], v238 offset:15680
ds_read_b64_tr_b16 v[188:189], v239 offset:0
ds_read_b64_tr_b16 v[186:187], v238 offset:15808
ds_read_b64_tr_b16 v[190:191], v239 offset:128
v_max3_f32 v236, v236, v168, v169
v_max3_f32 v241, v241, v170, v171
v_cndmask_b32 v32, v96, v32, s[88:89]
s_mov_b32 s44, 44306432
v_min_u32 v212, 752, v8
buffer_load_dwordx4 v[208:211], v212, s[20:23], s44 offen sc1
LH_X24:
s_waitcnt vmcnt(10)
s_barrier
s_add_u32 m0, s72, 51200
s_mov_b32 exec_hi, 0
buffer_load_dwordx4 v23, s[20:23], s79 offen sc1 lds
s_mov_b32 exec_hi, -1
v_cndmask_b32 v33, v97, v33, s[90:91]
v_cndmask_b32 v34, v98, v34, s[92:93]
v_cndmask_b32 v35, v99, v35, s[94:95]
v_cndmask_b32 v108, v172, v108, s[88:89]
v_cndmask_b32 v109, v173, v109, s[90:91]
v_cndmask_b32 v110, v174, v110, s[92:93]
buffer_load_dwordx4 v23, s[20:23], s79 offen offset:512 sc1 lds
v_cndmask_b32 v111, v175, v111, s[94:95]
v_max3_f32 v4, v4, v32, v33
v_max3_f32 v5, v5, v34, v35
v_max3_f32 v236, v236, v108, v109
v_max3_f32 v241, v241, v110, v111
buffer_load_dwordx4 v23, s[20:23], s79 offen offset:1536 sc1 lds
Lpad3470:
s_cbranch_execz Lpad3559
v_max_f32 v4, v4, v5
v_max_f32 v236, v236, v241
v_mov_b32 v5, v4
v_mov_b32 v241, v236
ds_read_b64_tr_b16 v[192:193], v238 offset:15936
ds_read_b64_tr_b16 v[196:197], v239 offset:256
buffer_load_dwordx4 v23, s[20:23], s79 offen offset:2560 sc1 lds
ds_read_b64_tr_b16 v[194:195], v238 offset:16064
ds_read_b64_tr_b16 v[198:199], v239 offset:384
v_permlane16_swap_b32 v4, v5
v_permlane16_swap_b32 v236, v241
v_max_f32 v4, v4, v5
buffer_load_dwordx4 v23, s[20:23], s79 offen offset:3584 sc1 lds
s_add_u32 s79, s79, 18432
s_cmp_eq_u32 s79, 589824
s_cselect_b32 s79, 0, s79
v_max_f32 v236, v236, v241
v_mov_b32 v5, v4
v_mov_b32 v241, v236
ds_read_b64_tr_b16 v[200:201], v238 offset:16192
ds_read_b64_tr_b16 v[204:205], v239 offset:512
ds_read_b64_tr_b16 v[202:203], v238 offset:16320
s_add_u32 m0, s74, 34816
s_nop 0
buffer_load_dwordx4 v252, s[16:19], s78 offen offset:0 lds
ds_read_b64_tr_b16 v[206:207], v239 offset:640
v_permlane32_swap_b32 v4, v5
v_permlane32_swap_b32 v236, v241
v_max_f32 v4, v4, v5
v_max_f32 v236, v236, v241
v_mul_f32 v4, s80, v4
buffer_load_dwordx4 v253, s[16:19], s78 offen offset:1024 lds
v_mul_f32 v236, s80, v236
v_fma_f32 v32, v32, s80, -v4
v_fma_f32 v33, v33, s80, -v4
v_fma_f32 v34, v34, s80, -v4
v_fma_f32 v35, v35, s80, -v4
buffer_load_dwordx4 v254, s[16:19], s78 offen offset:2048 lds
v_exp_f32 v32, v32
v_exp_f32 v33, v33
v_exp_f32 v34, v34
v_exp_f32 v35, v35
v_cvt_pk_bf16_f32 v100, v32, v33
v_cvt_pk_bf16_f32 v101, v34, v35
buffer_load_dwordx4 v255, s[16:19], s78 offen offset:3072 lds
s_add_u32 s78, s78, 128
s_and_b32 s78, s78, 4095
v_and_b32 v32, v100, v234
v_and_b32 v33, v101, v235
v_xor_b32 v96, v100, v32
v_xor_b32 v97, v101, v33
v_mov_b32 v98, 0
v_mov_b32 v99, 0
v_fma_f32 v36, v36, s80, -v4
v_fma_f32 v37, v37, s80, -v4
v_fma_f32 v38, v38, s80, -v4
v_fma_f32 v39, v39, s80, -v4
v_exp_f32 v36, v36
s_mul_i32 s62, s57, 165888
s_add_u32 s62, s62, s72
s_add_u32 s62, s62, 30932992
v_add_u32 v24, s62, v8
s_and_b32 s75, s57, 3
s_lshl_b32 s68, s75, 2
s_lshr_b32 s76, s57, 2
s_lshl_b32 s77, s56, 2
s_add_u32 s77, s77, s76
s_lshl_b32 s45, s77, 7
s_add_u32 s45, s45, 44232704
v_and_b32 v7, 63, v25
s_mul_i32 s48, s75, 165888
s_add_u32 s48, s48, 33587200
s_lshl_b32 s47, s58, 11
s_add_u32 s47, s47, s48
s_add_u32 s48, s48, 8192
s_cmp_eq_u32 s58, 0
s_cselect_b32 s48, s48, 0x40000000
s_cselect_b32 s49, 9216, 0
LH_X25:
s_waitcnt vmcnt(10)
s_barrier
s_add_u32 m0, s72, 86016
s_mov_b32 exec_hi, 0
buffer_load_dwordx4 v23, s[20:23], s79 offen sc1 lds
s_mov_b32 exec_hi, -1
v_exp_f32 v37, v37
v_exp_f32 v38, v38
v_exp_f32 v39, v39
v_cvt_pk_bf16_f32 v34, v36, v37
Lpad3559:
s_cbranch_execz Lback1
buffer_load_dwordx4 v23, s[20:23], s79 offen offset:512 sc1 lds
v_cvt_pk_bf16_f32 v35, v38, v39
v_fma_f32 v108, v108, s80, -v236
v_fma_f32 v109, v109, s80, -v236
v_fma_f32 v110, v110, s80, -v236
v_fma_f32 v111, v111, s80, -v236
buffer_load_dwordx4 v23, s[20:23], s79 offen offset:1536 sc1 lds
v_exp_f32 v108, v108
v_exp_f32 v109, v109
v_exp_f32 v110, v110
v_exp_f32 v111, v111
buffer_load_dwordx4 v23, s[20:23], s79 offen offset:2560 sc1 lds
v_cvt_pk_bf16_f32 v172, v108, v109
v_cvt_pk_bf16_f32 v173, v110, v111
v_and_b32 v106, v172, v234
v_and_b32 v107, v173, v235
v_xor_b32 v172, v172, v106
buffer_load_dwordx4 v23, s[20:23], s79 offen offset:3584 sc1 lds
s_add_u32 s79, s79, 18432
s_cmp_eq_u32 s79, 589824
s_cselect_b32 s79, 0, s79
v_xor_b32 v173, v173, v107
v_mov_b32 v104, 0
v_mov_b32 v105, 0
v_fma_f32 v40, v40, s80, -v4
s_add_u32 m0, s74, 69632
s_nop 0
buffer_load_dwordx4 v252, s[16:19], s78 offen offset:0 lds
v_fma_f32 v41, v41, s80, -v4
v_fma_f32 v42, v42, s80, -v4
v_fma_f32 v43, v43, s80, -v4
v_exp_f32 v40, v40
buffer_load_dwordx4 v253, s[16:19], s78 offen offset:1024 lds
v_exp_f32 v41, v41
v_exp_f32 v42, v42
v_exp_f32 v43, v43
v_cvt_pk_bf16_f32 v40, v40, v41
v_cvt_pk_bf16_f32 v41, v42, v43
buffer_load_dwordx4 v254, s[16:19], s78 offen offset:2048 lds
v_fma_f32 v112, v112, s80, -v236
v_fma_f32 v113, v113, s80, -v236
v_fma_f32 v114, v114, s80, -v236
v_fma_f32 v115, v115, s80, -v236
buffer_load_dwordx4 v255, s[16:19], s78 offen offset:3072 lds
s_add_u32 s78, s78, 128
s_and_b32 s78, s78, 4095
v_exp_f32 v112, v112
v_exp_f32 v113, v113
v_exp_f32 v114, v114
v_exp_f32 v115, v115
v_cvt_pk_bf16_f32 v112, v112, v113
v_cvt_pk_bf16_f32 v113, v114, v115
s_waitcnt lgkmcnt(8)
v_mfma_f32_16x16x32_bf16 v[220:223], v[184:187], v[32:35], 0
v_mfma_f32_16x16x32_bf16 v[18:21], v[188:191], v[32:35], 0
s_waitcnt vmcnt(18)
Lp21:
v_xor_b32 v208, s59, v208
v_bitop3_b32 v208, s59, v209, v208 bitop3:0xbe
v_bitop3_b32 v208, s59, v210, v208 bitop3:0xbe
v_bitop3_b32 v208, s59, v211, v208 bitop3:0xbe
v_cmp_ne_u32 vcc, 0, v208
s_cbranch_vccz Lq22
buffer_load_dwordx4 v[208:211], v212, s[20:23], s44 offen sc1
s_waitcnt vmcnt(0)
s_add_u32 s60, s60, 1
s_cmp_lt_u32 s60, 131072
s_cbranch_scc1 Lp21
Lq22:
LH_X26:
s_waitcnt vmcnt(9)
s_barrier
s_add_u32 m0, s72, 16384
s_mov_b32 exec_hi, 0
buffer_load_dwordx4 v23, s[20:23], s79 offen sc1 lds
s_mov_b32 exec_hi, -1
v_mfma_f32_16x16x32_bf16 v[224:227], v[184:187], v[104:107], 0
v_mfma_f32_16x16x32_bf16 v[248:251], v[188:191], v[104:107], 0
ds_read_b64_tr_b16 v[176:177], v238 offset:16448
ds_read_b64_tr_b16 v[180:181], v239 offset:768
buffer_load_dwordx4 v23, s[20:23], s79 offen offset:512 sc1 lds
ds_read_b64_tr_b16 v[178:179], v238 offset:16576
ds_read_b64_tr_b16 v[182:183], v239 offset:896
Lpad3642:
s_cbranch_execz Lback1
v_fma_f32 v44, v44, s80, -v4
v_fma_f32 v45, v45, s80, -v4
buffer_load_dwordx4 v23, s[20:23], s79 offen offset:1536 sc1 lds
v_fma_f32 v46, v46, s80, -v4
v_fma_f32 v47, v47, s80, -v4
v_exp_f32 v44, v44
v_exp_f32 v45, v45
v_exp_f32 v46, v46
buffer_load_dwordx4 v23, s[20:23], s79 offen offset:2560 sc1 lds
v_exp_f32 v47, v47
v_cvt_pk_bf16_f32 v42, v44, v45
v_cvt_pk_bf16_f32 v43, v46, v47
v_fma_f32 v116, v116, s80, -v236
buffer_load_dwordx4 v23, s[20:23], s79 offen offset:3584 sc1 lds
s_add_u32 s79, s79, 18432
s_cmp_eq_u32 s79, 589824
s_cselect_b32 s79, 0, s79
v_fma_f32 v117, v117, s80, -v236
v_fma_f32 v118, v118, s80, -v236
v_fma_f32 v119, v119, s80, -v236
v_exp_f32 v116, v116
s_add_u32 m0, s74, 0
s_nop 0
buffer_load_dwordx4 v252, s[16:19], s78 offen offset:0 lds
v_exp_f32 v117, v117
v_exp_f32 v118, v118
v_exp_f32 v119, v119
v_cvt_pk_bf16_f32 v114, v116, v117
buffer_load_dwordx4 v253, s[16:19], s78 offen offset:1024 lds
v_cvt_pk_bf16_f32 v115, v118, v119
v_fma_f32 v48, v48, s80, -v4
v_fma_f32 v49, v49, s80, -v4
v_fma_f32 v50, v50, s80, -v4
buffer_load_dwordx4 v254, s[16:19], s78 offen offset:2048 lds
v_fma_f32 v51, v51, s80, -v4
v_exp_f32 v48, v48
v_exp_f32 v49, v49
v_exp_f32 v50, v50
v_exp_f32 v51, v51
buffer_load_dwordx4 v255, s[16:19], s78 offen offset:3072 lds
s_add_u32 s78, s78, 128
s_and_b32 s78, s78, 4095
v_cvt_pk_bf16_f32 v48, v48, v49
v_cvt_pk_bf16_f32 v49, v50, v51
v_fma_f32 v120, v120, s80, -v236
v_fma_f32 v121, v121, s80, -v236
v_fma_f32 v122, v122, s80, -v236
v_fma_f32 v123, v123, s80, -v236
v_exp_f32 v120, v120
v_exp_f32 v121, v121
LH_X27:
s_waitcnt vmcnt(9)
s_barrier
s_add_u32 m0, s72, 51200
s_mov_b32 exec_hi, 0
buffer_load_dwordx4 v23, s[20:23], s79 offen sc1 lds
s_mov_b32 exec_hi, -1
v_exp_f32 v122, v122
v_exp_f32 v123, v123
v_cvt_pk_bf16_f32 v120, v120, v121
v_cvt_pk_bf16_f32 v121, v122, v123
buffer_load_dwordx4 v23, s[20:23], s79 offen offset:512 sc1 lds
s_waitcnt lgkmcnt(8)
v_mfma_f32_16x16x32_bf16 v[220:223], v[192:195], v[40:43], v[220:223]
v_mfma_f32_16x16x32_bf16 v[18:21], v[196:199], v[40:43], v[18:21]
v_mfma_f32_16x16x32_bf16 v[224:227], v[192:195], v[112:115], v[224:227]
buffer_load_dwordx4 v23, s[20:23], s79 offen offset:1536 sc1 lds
v_mfma_f32_16x16x32_bf16 v[248:251], v[196:199], v[112:115], v[248:251]
ds_read_b64_tr_b16 v[184:185], v238 offset:16704
ds_read_b64_tr_b16 v[188:189], v239 offset:1024
ds_read_b64_tr_b16 v[186:187], v238 offset:16832
buffer_load_dwordx4 v23, s[20:23], s79 offen offset:2560 sc1 lds
ds_read_b64_tr_b16 v[190:191], v239 offset:1152
v_fma_f32 v52, v52, s80, -v4
v_fma_f32 v53, v53, s80, -v4
v_fma_f32 v54, v54, s80, -v4
Lpad3718:
s_cbranch_execz Lback1
buffer_load_dwordx4 v23, s[20:23], s79 offen offset:3584 sc1 lds
s_add_u32 s79, s79, 18432
s_cmp_eq_u32 s79, 589824
s_cselect_b32 s79, 0, s79
v_fma_f32 v55, v55, s80, -v4
v_exp_f32 v52, v52
v_exp_f32 v53, v53
v_exp_f32 v54, v54
s_add_u32 m0, s74, 34816
s_nop 0
buffer_load_dwordx4 v252, s[16:19], s78 offen offset:0 lds
v_exp_f32 v55, v55
v_cvt_pk_bf16_f32 v50, v52, v53
v_cvt_pk_bf16_f32 v51, v54, v55
buffer_load_dwordx4 v253, s[16:19], s78 offen offset:1024 lds
v_fma_f32 v124, v124, s80, -v236
v_fma_f32 v125, v125, s80, -v236
v_fma_f32 v126, v126, s80, -v236
v_fma_f32 v127, v127, s80, -v236
buffer_load_dwordx4 v254, s[16:19], s78 offen offset:2048 lds
v_exp_f32 v124, v124
v_exp_f32 v125, v125
v_exp_f32 v126, v126
v_exp_f32 v127, v127
buffer_load_dwordx4 v255, s[16:19], s78 offen offset:3072 lds
s_add_u32 s78, s78, 128
s_and_b32 s78, s78, 4095
v_cvt_pk_bf16_f32 v122, v124, v125
v_cvt_pk_bf16_f32 v123, v126, v127
v_fma_f32 v56, v56, s80, -v4
v_fma_f32 v57, v57, s80, -v4
v_fma_f32 v58, v58, s80, -v4
v_fma_f32 v59, v59, s80, -v4
v_exp_f32 v56, v56
v_exp_f32 v57, v57
LH_X28:
s_waitcnt vmcnt(9)
s_barrier
s_add_u32 s69, s68, 0
s_and_b32 s69, s69, 15
s_mul_i32 s69, s69, 9216
s_add_u32 m0, s72, 73728
s_mov_b32 exec_hi, 0
buffer_load_dwordx4 v24, s[20:23], s69 offen sc1 lds
s_mov_b32 exec_hi, -1
v_exp_f32 v58, v58
v_exp_f32 v59, v59
v_cvt_pk_bf16_f32 v56, v56, v57
v_cvt_pk_bf16_f32 v57, v58, v59
v_fma_f32 v128, v128, s80, -v236
v_fma_f32 v129, v129, s80, -v236
v_fma_f32 v130, v130, s80, -v236
v_fma_f32 v131, v131, s80, -v236
v_exp_f32 v128, v128
buffer_load_dwordx4 v24, s[20:23], s69 offen offset:512 sc1 lds
v_exp_f32 v129, v129
v_exp_f32 v130, v130
v_exp_f32 v131, v131
v_cvt_pk_bf16_f32 v128, v128, v129
v_cvt_pk_bf16_f32 v129, v130, v131
s_waitcnt lgkmcnt(8)
v_mfma_f32_16x16x32_bf16 v[220:223], v[200:203], v[48:51], v[220:223]
v_mfma_f32_16x16x32_bf16 v[18:21], v[204:207], v[48:51], v[18:21]
v_mfma_f32_16x16x32_bf16 v[224:227], v[200:203], v[120:123], v[224:227]
buffer_load_dwordx4 v24, s[20:23], s69 offen offset:1536 sc1 lds
v_mfma_f32_16x16x32_bf16 v[248:251], v[204:207], v[120:123], v[248:251]
ds_read_b64_tr_b16 v[192:193], v238 offset:16960
ds_read_b64_tr_b16 v[196:197], v239 offset:1280
ds_read_b64_tr_b16 v[194:195], v238 offset:17088
ds_read_b64_tr_b16 v[198:199], v239 offset:1408
v_fma_f32 v60, v60, s80, -v4
v_fma_f32 v61, v61, s80, -v4
v_fma_f32 v62, v62, s80, -v4
v_fma_f32 v63, v63, s80, -v4
buffer_load_dwordx4 v24, s[20:23], s69 offen offset:2560 sc1 lds
v_exp_f32 v60, v60
v_exp_f32 v61, v61
v_exp_f32 v62, v62
v_exp_f32 v63, v63
Lpad3797:
s_cbranch_execz Lpad3876
v_cvt_pk_bf16_f32 v58, v60, v61
v_cvt_pk_bf16_f32 v59, v62, v63
v_fma_f32 v132, v132, s80, -v236
v_fma_f32 v133, v133, s80, -v236
v_fma_f32 v134, v134, s80, -v236
buffer_load_dwordx4 v24, s[20:23], s69 offen offset:3584 sc1 lds
v_fma_f32 v135, v135, s80, -v236
v_exp_f32 v132, v132
v_exp_f32 v133, v133
v_exp_f32 v134, v134
v_exp_f32 v135, v135
v_cvt_pk_bf16_f32 v130, v132, v133
v_cvt_pk_bf16_f32 v131, v134, v135
v_fma_f32 v64, v64, s80, -v4
v_fma_f32 v65, v65, s80, -v4
v_fma_f32 v66, v66, s80, -v4
v_fma_f32 v67, v67, s80, -v4
v_exp_f32 v64, v64
v_exp_f32 v65, v65
v_exp_f32 v66, v66
LH_X29:
s_waitcnt vmcnt(5)
s_barrier
s_add_u32 s69, s68, 2
s_and_b32 s69, s69, 15
s_mul_i32 s69, s69, 9216
s_add_u32 m0, s72, 0
s_mov_b32 exec_hi, 0
buffer_load_dwordx4 v24, s[20:23], s69 offen sc1 lds
s_mov_b32 exec_hi, -1
v_exp_f32 v67, v67
v_cvt_pk_bf16_f32 v64, v64, v65
v_cvt_pk_bf16_f32 v65, v66, v67
v_fma_f32 v136, v136, s80, -v236
v_fma_f32 v137, v137, s80, -v236
v_fma_f32 v138, v138, s80, -v236
v_fma_f32 v139, v139, s80, -v236
v_exp_f32 v136, v136
v_exp_f32 v137, v137
buffer_load_dwordx4 v24, s[20:23], s69 offen offset:512 sc1 lds
v_exp_f32 v138, v138
v_exp_f32 v139, v139
v_cvt_pk_bf16_f32 v136, v136, v137
v_cvt_pk_bf16_f32 v137, v138, v139
s_waitcnt lgkmcnt(8)
v_mfma_f32_16x16x32_bf16 v[220:223], v[176:179], v[56:59], v[220:223]
v_mfma_f32_16x16x32_bf16 v[18:21], v[180:183], v[56:59], v[18:21]
v_mfma_f32_16x16x32_bf16 v[224:227], v[176:179], v[128:131], v[224:227]
v_mfma_f32_16x16x32_bf16 v[248:251], v[180:183], v[128:131], v[248:251]
buffer_load_dwordx4 v24, s[20:23], s69 offen offset:1536 sc1 lds
ds_read_b64_tr_b16 v[200:201], v238 offset:17216
ds_read_b64_tr_b16 v[204:205], v239 offset:1536
ds_read_b64_tr_b16 v[202:203], v238 offset:17344
ds_read_b64_tr_b16 v[206:207], v239 offset:1664
v_fma_f32 v68, v68, s80, -v4
v_fma_f32 v69, v69, s80, -v4
v_fma_f32 v70, v70, s80, -v4
v_fma_f32 v71, v71, s80, -v4
v_exp_f32 v68, v68
buffer_load_dwordx4 v24, s[20:23], s69 offen offset:2560 sc1 lds
v_exp_f32 v69, v69
v_exp_f32 v70, v70
v_exp_f32 v71, v71
v_cvt_pk_bf16_f32 v66, v68, v69
v_cvt_pk_bf16_f32 v67, v70, v71
v_fma_f32 v140, v140, s80, -v236
v_fma_f32 v141, v141, s80, -v236
v_fma_f32 v142, v142, s80, -v236
v_fma_f32 v143, v143, s80, -v236
buffer_load_dwordx4 v24, s[20:23], s69 offen offset:3584 sc1 lds
v_exp_f32 v140, v140
v_exp_f32 v141, v141
v_exp_f32 v142, v142
v_exp_f32 v143, v143
v_cvt_pk_bf16_f32 v138, v140, v141
v_cvt_pk_bf16_f32 v139, v142, v143
v_fma_f32 v72, v72, s80, -v4
v_fma_f32 v73, v73, s80, -v4
v_fma_f32 v74, v74, s80, -v4
Lpad3876:
s_cbranch_execz Lback1
v_fma_f32 v75, v75, s80, -v4
v_exp_f32 v72, v72
v_exp_f32 v73, v73
v_exp_f32 v74, v74
v_exp_f32 v75, v75
LH_X30:
s_barrier
s_setprio 0
s_add_u32 s69, s68, 4
s_and_b32 s69, s69, 15
s_mul_i32 s69, s69, 9216
s_add_u32 m0, s72, 18432
s_mov_b32 exec_hi, 0
buffer_load_dwordx4 v24, s[20:23], s69 offen sc1 lds
s_mov_b32 exec_hi, -1
v_cvt_pk_bf16_f32 v72, v72, v73
v_cvt_pk_bf16_f32 v73, v74, v75
v_fma_f32 v144, v144, s80, -v236
v_fma_f32 v145, v145, s80, -v236
v_fma_f32 v146, v146, s80, -v236
v_fma_f32 v147, v147, s80, -v236
v_exp_f32 v144, v144
v_exp_f32 v145, v145
v_exp_f32 v146, v146
v_exp_f32 v147, v147
v_cvt_pk_bf16_f32 v144, v144, v145
buffer_load_dwordx4 v24, s[20:23], s69 offen offset:512 sc1 lds
v_cvt_pk_bf16_f32 v145, v146, v147
s_waitcnt lgkmcnt(8)
v_mfma_f32_16x16x32_bf16 v[220:223], v[184:187], v[64:67], v[220:223]
v_mfma_f32_16x16x32_bf16 v[18:21], v[188:191], v[64:67], v[18:21]
v_mfma_f32_16x16x32_bf16 v[224:227], v[184:187], v[136:139], v[224:227]
v_mfma_f32_16x16x32_bf16 v[248:251], v[188:191], v[136:139], v[248:251]
ds_read_b64_tr_b16 v[176:177], v238 offset:17472
ds_read_b64_tr_b16 v[180:181], v239 offset:1792
ds_read_b64_tr_b16 v[178:179], v238 offset:17600
ds_read_b64_tr_b16 v[182:183], v239 offset:1920
v_fma_f32 v76, v76, s80, -v4
buffer_load_dwordx4 v24, s[20:23], s69 offen offset:1536 sc1 lds
v_fma_f32 v77, v77, s80, -v4
v_fma_f32 v78, v78, s80, -v4
v_fma_f32 v79, v79, s80, -v4
v_exp_f32 v76, v76
v_exp_f32 v77, v77
v_exp_f32 v78, v78
v_exp_f32 v79, v79
v_cvt_pk_bf16_f32 v74, v76, v77
v_cvt_pk_bf16_f32 v75, v78, v79
v_fma_f32 v148, v148, s80, -v236
v_fma_f32 v149, v149, s80, -v236
v_fma_f32 v150, v150, s80, -v236
buffer_load_dwordx4 v24, s[20:23], s69 offen offset:2560 sc1 lds
v_fma_f32 v151, v151, s80, -v236
v_exp_f32 v148, v148
v_exp_f32 v149, v149
v_exp_f32 v150, v150
v_exp_f32 v151, v151
v_cvt_pk_bf16_f32 v146, v148, v149
v_cvt_pk_bf16_f32 v147, v150, v151
v_fma_f32 v80, v80, s80, -v4
v_fma_f32 v81, v81, s80, -v4
v_fma_f32 v82, v82, s80, -v4
v_fma_f32 v83, v83, s80, -v4
buffer_load_dwordx4 v24, s[20:23], s69 offen offset:3584 sc1 lds
v_exp_f32 v80, v80
v_exp_f32 v81, v81
v_exp_f32 v82, v82
v_exp_f32 v83, v83
v_cvt_pk_bf16_f32 v80, v80, v81
v_cvt_pk_bf16_f32 v81, v82, v83
v_fma_f32 v152, v152, s80, -v236
v_fma_f32 v153, v153, s80, -v236
v_fma_f32 v154, v154, s80, -v236
v_fma_f32 v155, v155, s80, -v236
v_exp_f32 v152, v152
s_add_u32 s69, s68, 6
s_and_b32 s69, s69, 15
s_mul_i32 s69, s69, 9216
s_add_u32 m0, s72, 36864
Lpad3955:
s_cbranch_execz Lback1
s_mov_b32 exec_hi, 0
buffer_load_dwordx4 v24, s[20:23], s69 offen sc1 lds
s_mov_b32 exec_hi, -1
v_exp_f32 v153, v153
v_exp_f32 v154, v154
v_exp_f32 v155, v155
v_cvt_pk_bf16_f32 v152, v152, v153
v_cvt_pk_bf16_f32 v153, v154, v155
s_waitcnt lgkmcnt(8)
v_mfma_f32_16x16x32_bf16 v[220:223], v[192:195], v[72:75], v[220:223]
v_mfma_f32_16x16x32_bf16 v[18:21], v[196:199], v[72:75], v[18:21]
v_mfma_f32_16x16x32_bf16 v[224:227], v[192:195], v[144:147], v[224:227]
v_mfma_f32_16x16x32_bf16 v[248:251], v[196:199], v[144:147], v[248:251]
ds_read_b64_tr_b16 v[184:185], v238 offset:17728
buffer_load_dwordx4 v24, s[20:23], s69 offen offset:512 sc1 lds
ds_read_b64_tr_b16 v[188:189], v239 offset:2048
ds_read_b64_tr_b16 v[186:187], v238 offset:17856
ds_read_b64_tr_b16 v[190:191], v239 offset:2176
v_fma_f32 v84, v84, s80, -v4
v_fma_f32 v85, v85, s80, -v4
v_fma_f32 v86, v86, s80, -v4
v_fma_f32 v87, v87, s80, -v4
v_exp_f32 v84, v84
v_exp_f32 v85, v85
v_exp_f32 v86, v86
v_exp_f32 v87, v87
v_cvt_pk_bf16_f32 v82, v84, v85
buffer_load_dwordx4 v24, s[20:23], s69 offen offset:1536 sc1 lds
v_cvt_pk_bf16_f32 v83, v86, v87
v_fma_f32 v156, v156, s80, -v236
v_fma_f32 v157, v157, s80, -v236
v_fma_f32 v158, v158, s80, -v236
v_fma_f32 v159, v159, s80, -v236
v_exp_f32 v156, v156
v_exp_f32 v157, v157
v_exp_f32 v158, v158
v_exp_f32 v159, v159
v_cvt_pk_bf16_f32 v154, v156, v157
v_cvt_pk_bf16_f32 v155, v158, v159
buffer_load_dwordx4 v24, s[20:23], s69 offen offset:2560 sc1 lds
v_fma_f32 v88, v88, s80, -v4
v_fma_f32 v89, v89, s80, -v4
v_fma_f32 v90, v90, s80, -v4
v_fma_f32 v91, v91, s80, -v4
v_exp_f32 v88, v88
v_exp_f32 v89, v89
v_exp_f32 v90, v90
v_exp_f32 v91, v91
v_cvt_pk_bf16_f32 v88, v88, v89
v_cvt_pk_bf16_f32 v89, v90, v91
v_fma_f32 v160, v160, s80, -v236
buffer_load_dwordx4 v24, s[20:23], s69 offen offset:3584 sc1 lds
v_fma_f32 v161, v161, s80, -v236
v_fma_f32 v162, v162, s80, -v236
v_fma_f32 v163, v163, s80, -v236
v_exp_f32 v160, v160
v_exp_f32 v161, v161
v_exp_f32 v162, v162
v_exp_f32 v163, v163
v_cvt_pk_bf16_f32 v160, v160, v161
v_cvt_pk_bf16_f32 v161, v162, v163
s_waitcnt lgkmcnt(8)
v_mfma_f32_16x16x32_bf16 v[220:223], v[200:203], v[80:83], v[220:223]
s_add_u32 s69, s68, 8
s_and_b32 s69, s69, 15
s_mul_i32 s69, s69, 9216
s_add_u32 m0, s72, 55296
s_mov_b32 exec_hi, 0
buffer_load_dwordx4 v24, s[20:23], s69 offen sc1 lds
s_mov_b32 exec_hi, -1
v_mfma_f32_16x16x32_bf16 v[18:21], v[204:207], v[80:83], v[18:21]
v_mfma_f32_16x16x32_bf16 v[224:227], v[200:203], v[152:155], v[224:227]
v_mfma_f32_16x16x32_bf16 v[248:251], v[204:207], v[152:155], v[248:251]
v_fma_f32 v92, v92, s80, -v4
v_fma_f32 v93, v93, s80, -v4
v_fma_f32 v94, v94, s80, -v4
v_fma_f32 v95, v95, s80, -v4
Lpad4032:
s_cbranch_execz Lback1
v_exp_f32 v92, v92
v_exp_f32 v93, v93
v_exp_f32 v94, v94
v_exp_f32 v95, v95
buffer_load_dwordx4 v24, s[20:23], s69 offen offset:512 sc1 lds
v_cvt_pk_bf16_f32 v90, v92, v93
v_cvt_pk_bf16_f32 v91, v94, v95
v_fma_f32 v164, v164, s80, -v236
v_fma_f32 v165, v165, s80, -v236
v_fma_f32 v166, v166, s80, -v236
v_fma_f32 v167, v167, s80, -v236
v_exp_f32 v164, v164
v_exp_f32 v165, v165
v_exp_f32 v166, v166
v_exp_f32 v167, v167
v_cvt_pk_bf16_f32 v162, v164, v165
v_cvt_pk_bf16_f32 v163, v166, v167
buffer_load_dwordx4 v24, s[20:23], s69 offen offset:1536 sc1 lds
v_fma_f32 v168, v168, s80, -v236
v_fma_f32 v169, v169, s80, -v236
v_fma_f32 v170, v170, s80, -v236
v_fma_f32 v171, v171, s80, -v236
v_exp_f32 v168, v168
v_exp_f32 v169, v169
v_exp_f32 v170, v170
v_exp_f32 v171, v171
v_cvt_pk_bf16_f32 v168, v168, v169
v_cvt_pk_bf16_f32 v169, v170, v171
v_mov_b32 v170, v172
buffer_load_dwordx4 v24, s[20:23], s69 offen offset:2560 sc1 lds
v_mov_b32 v171, v173
s_waitcnt lgkmcnt(4)
v_mfma_f32_16x16x32_bf16 v[220:223], v[176:179], v[88:91], v[220:223]
v_mfma_f32_16x16x32_bf16 v[18:21], v[180:183], v[88:91], v[18:21]
v_mfma_f32_16x16x32_bf16 v[224:227], v[176:179], v[160:163], v[224:227]
v_mfma_f32_16x16x32_bf16 v[248:251], v[180:183], v[160:163], v[248:251]
s_waitcnt lgkmcnt(0)
v_mfma_f32_16x16x32_bf16 v[220:223], v[184:187], v[96:99], v[220:223]
v_mfma_f32_16x16x32_bf16 v[18:21], v[188:191], v[96:99], v[18:21]
v_mfma_f32_16x16x32_bf16 v[224:227], v[184:187], v[168:171], v[224:227]
v_mfma_f32_16x16x32_bf16 v[248:251], v[188:191], v[168:171], v[248:251]
buffer_load_dwordx4 v24, s[20:23], s69 offen offset:3584 sc1 lds
s_nop 4
v_mov_b32 v4, v18
s_nop 0
v_mov_b32 v236, v248
v_mov_b32 v5, v18
v_mov_b32 v241, v248
s_nop 0
v_permlane16_swap_b32 v4, v5
v_permlane16_swap_b32 v236, v241
v_rcp_f32 v5, v5
v_rcp_f32 v241, v241
v_mul_f32 v220, v220, v5
v_mul_f32 v224, v224, v241
v_mul_f32 v221, v221, v5
v_mul_f32 v225, v225, v241
v_mul_f32 v222, v222, v5
v_mul_f32 v226, v226, v241
v_mul_f32 v223, v223, v5
v_mul_f32 v227, v227, v241
v_mul_f32 v20, v20, v5
v_mul_f32 v250, v250, v241
v_mul_f32 v21, v21, v5
v_mul_f32 v251, v251, v241
v_cvt_pk_bf16_f32 v230, v220, v221
v_cvt_pk_bf16_f32 v28, v224, v225
v_cvt_pk_bf16_f32 v231, v222, v223
v_cvt_pk_bf16_f32 v29, v226, v227
v_cvt_pk_bf16_f32 v233, v20, v21
v_cvt_pk_bf16_f32 v31, v250, v251
buffer_store_dwordx4 v[228:231], v243, s[20:23], s87 offen offset:0 sc1
s_mov_b64 exec, 0xffff
buffer_store_dwordx2 v[232:233], v244, s[20:23], s82 offen offset:0 sc1
s_mov_b64 exec, -1
buffer_store_dwordx4 v[26:29], v243, s[20:23], s87 offen offset:128 sc1
s_mov_b64 exec, 0xffff
buffer_store_dwordx2 v[30:31], v244, s[20:23], s82 offen offset:128 sc1
s_mov_b64 exec, -1
LH_X31:
s_waitcnt vmcnt(19) lgkmcnt(0)
s_barrier
s_add_u32 s69, s68, 10
s_and_b32 s69, s69, 15
s_mul_i32 s69, s69, 9216
s_add_u32 m0, s72, 104448
s_mov_b32 exec_hi, 0
buffer_load_dwordx4 v24, s[20:23], s69 offen sc1 lds
Lpad4120:
s_cbranch_execz Lpad4197
s_mov_b32 exec_hi, -1
buffer_load_dwordx4 v24, s[20:23], s69 offen offset:512 sc1 lds
buffer_load_dwordx4 v24, s[20:23], s69 offen offset:1536 sc1 lds
buffer_load_dwordx4 v24, s[20:23], s69 offen offset:2560 sc1 lds
buffer_load_dwordx4 v24, s[20:23], s69 offen offset:3584 sc1 lds
s_add_u32 s69, s68, 12
s_and_b32 s69, s69, 15
s_mul_i32 s69, s69, 9216
s_add_u32 m0, s72, 122880
s_mov_b32 exec_hi, 0
buffer_load_dwordx4 v24, s[20:23], s69 offen sc1 lds
s_mov_b32 exec_hi, -1
buffer_load_dwordx4 v24, s[20:23], s69 offen offset:512 sc1 lds
buffer_load_dwordx4 v24, s[20:23], s69 offen offset:1536 sc1 lds
buffer_load_dwordx4 v24, s[20:23], s69 offen offset:2560 sc1 lds
buffer_load_dwordx4 v24, s[20:23], s69 offen offset:3584 sc1 lds
buffer_load_dwordx4 v[32:35], v8, s[20:23], s47 offen sc1
buffer_load_dwordx4 v[36:39], v8, s[20:23], s47 offen offset:1024 sc1
s_add_u32 s47, s47, 9216
buffer_load_dwordx4 v[44:47], v8, s[20:23], s47 offen sc1
buffer_load_dwordx4 v[48:51], v8, s[20:23], s47 offen offset:1024 sc1
s_add_u32 s47, s47, 9216
buffer_load_dwordx4 v[56:59], v8, s[20:23], s47 offen sc1
buffer_load_dwordx4 v[60:63], v8, s[20:23], s47 offen offset:1024 sc1
s_add_u32 s47, s47, 9216
buffer_load_dwordx4 v[68:71], v8, s[20:23], s47 offen sc1
buffer_load_dwordx4 v[72:75], v8, s[20:23], s47 offen offset:1024 sc1
s_add_u32 s47, s47, 9216
s_cmp_lg_u32 s58, 0
s_cbranch_scc1 Lz23
buffer_load_dwordx4 v[40:43], v8, s[20:23], s48 offen sc1
s_add_u32 s48, s48, 9216
buffer_load_dwordx4 v[52:55], v8, s[20:23], s48 offen sc1
s_add_u32 s48, s48, 9216
buffer_load_dwordx4 v[64:67], v8, s[20:23], s48 offen sc1
s_add_u32 s48, s48, 9216
buffer_load_dwordx4 v[76:79], v8, s[20:23], s48 offen sc1
s_add_u32 s48, s48, 9216
Lz23:
v_lshrrev_b32 v3, 4, v2
v_lshlrev_b32 v27, 9, v3
v_bfe_u32 v4, v2, 3, 1
v_lshl_add_u32 v27, v4, 7, v27
v_and_b32 v4, 7, v2
v_lshl_add_u32 v27, v4, 3, v27
v_add_u32 v27, 51200, v27
v_bfe_u32 v3, v2, 2, 2
v_and_b32 v4, 3, v2
v_lshl_add_u32 v3, v3, 3, v4
v_mul_u32_u24 v3, 1152, v3
v_lshrrev_b32 v4, 4, v2
v_lshl_add_u32 v29, v4, 4, v3
v_lshl_add_u32 v30, v4, 3, v3
s_mul_i32 s50, s77, 36864
s_mul_i32 s62, s75, 288
s_add_u32 s50, s50, s62
s_add_u32 s52, s50, 256
s_lshl_b32 s62, s58, 6
s_add_u32 s50, s50, s62
s_add_u32 s51, s50, 4608
s_add_u32 s53, s52, 4608
s_cmp_eq_u32 s58, 0
s_cselect_b32 s52, s52, 0x40000000
s_cselect_b32 s53, s53, 0x40000000
s_lshl_b32 s62, s56, 2
s_add_u32 s62, s62, s75
s_lshl_b32 s62, s62, 2
s_add_u32 s62, s62, s76
s_lshl_b32 s54, s62, 7
s_add_u32 s54, s54, 44273664
s_mul_i32 s55, s62, 36864
s_add_u32 s55, s55, 34775040
v_and_b32 v5, 15, v25
s_lshl_b32 s62, s58, 11
v_add_u32 v26, s62, v8
v_add_u32 v22, 141312, v26
v_add_u32 v23, 141312, v8
Lpad4197:
s_cbranch_execz Lback3
s_add_u32 s62, s76, 1
s_and_b32 s62, s62, 3
s_mul_i32 s62, s62, 9216
s_add_u32 s84, s62, s55
s_add_u32 s85, s84, 8192
s_cmp_eq_u32 s58, 0
s_cselect_b32 s85, s85, 0x40000000
s_add_u32 s62, s76, 2
s_and_b32 s62, s62, 3
s_mul_i32 s62, s62, 9216
s_add_u32 s86, s62, s55
s_add_u32 s87, s86, 8192
s_cmp_eq_u32 s58, 0
s_cselect_b32 s87, s87, 0x40000000
s_add_u32 s62, s76, 3
s_and_b32 s62, s62, 3
s_mul_i32 s62, s62, 9216
s_add_u32 s88, s62, s55
s_add_u32 s89, s88, 8192
s_cmp_eq_u32 s58, 0
s_cselect_b32 s89, s89, 0x40000000
s_waitcnt vmcnt(18)
v_mov_b32 v3, 0
v_mov_b32 v4, s59
s_mov_b64 exec, 1
buffer_store_dword v4, v3, s[20:23], s83 offen sc1
s_mov_b64 exec, -1
LH_T0:
s_barrier
LH_T1:
s_waitcnt vmcnt(9)
s_barrier
s_add_u32 s69, s68, 14
s_and_b32 s69, s69, 15
s_mul_i32 s69, s69, 9216
s_add_u32 m0, s72, 0
s_mov_b32 exec_hi, 0
buffer_load_dwordx4 v24, s[20:23], s69 offen sc1 lds
s_mov_b32 exec_hi, -1
buffer_load_dwordx4 v24, s[20:23], s69 offen offset:512 sc1 lds
buffer_load_dwordx4 v24, s[20:23], s69 offen offset:1536 sc1 lds
buffer_load_dwordx4 v24, s[20:23], s69 offen offset:2560 sc1 lds
buffer_load_dwordx4 v24, s[20:23], s69 offen offset:3584 sc1 lds
s_mov_b32 s69, 147456
s_add_u32 m0, s72, 73728
s_mov_b32 exec_hi, 0
buffer_load_dwordx4 v24, s[20:23], s69 offen sc1 lds
s_mov_b32 exec_hi, -1
buffer_load_dwordx4 v24, s[20:23], s69 offen offset:512 sc1 lds
buffer_load_dwordx4 v24, s[20:23], s69 offen offset:1536 sc1 lds
buffer_load_dwordx4 v24, s[20:23], s69 offen offset:2560 sc1 lds
buffer_load_dwordx4 v24, s[20:23], s69 offen offset:3584 sc1 lds
buffer_load_dword v3, v7, s[20:23], s45 offen offset:0 sc1
LH_T2:
s_waitcnt vmcnt(1)
s_barrier
s_waitcnt vmcnt(0)
Lp25:
v_cmp_ne_u32 vcc, s59, v3
s_cbranch_vccz Lq26
buffer_load_dword v3, v7, s[20:23], s45 offen offset:0 sc1
s_waitcnt vmcnt(0)
s_add_u32 s60, s60, 1
s_cmp_lt_u32 s60, 131072
s_cbranch_scc1 Lp25
Lq26:
s_lshl_b32 s62, s77, 15
s_lshl_b32 s63, s58, 13
s_add_u32 s62, s62, s63
s_add_u32 s62, s62, 28573696
s_add_u32 m0, s63, 18432
s_nop 0
buffer_load_dwordx4 v8, s[20:23], s62 offen offset:0 sc1 lds
buffer_load_dwordx4 v8, s[20:23], s62 offen offset:1024 sc1 lds
buffer_load_dwordx4 v8, s[20:23], s62 offen offset:2048 sc1 lds
buffer_load_dwordx4 v8, s[20:23], s62 offen offset:3072 sc1 lds
s_add_u32 s62, s62, 4096
s_add_u32 m0, s63, 22528
s_nop 0
buffer_load_dwordx4 v8, s[20:23], s62 offen offset:0 sc1 lds
buffer_load_dwordx4 v8, s[20:23], s62 offen offset:1024 sc1 lds
buffer_load_dwordx4 v8, s[20:23], s62 offen offset:2048 sc1 lds
buffer_load_dwordx4 v8, s[20:23], s62 offen offset:3072 sc1 lds
s_lshl_b32 s62, s77, 12
s_lshl_b32 s63, s58, 10
s_add_u32 s62, s62, s63
s_add_u32 s62, s62, 30670848
s_add_u32 m0, s63, 51200
s_nop 0
buffer_load_dwordx4 v8, s[20:23], s62 offen sc1 lds
buffer_load_dwordx4 v[80:83], v8, s[20:23], s47 offen sc1
buffer_load_dwordx4 v[84:87], v8, s[20:23], s47 offen offset:1024 sc1
Lpad4289:
s_cbranch_execz Lback3
s_add_u32 s47, s47, 9216
buffer_load_dwordx4 v[92:95], v8, s[20:23], s47 offen sc1
buffer_load_dwordx4 v[96:99], v8, s[20:23], s47 offen offset:1024 sc1
s_add_u32 s47, s47, 9216
buffer_load_dwordx4 v[104:107], v8, s[20:23], s47 offen sc1
buffer_load_dwordx4 v[108:111], v8, s[20:23], s47 offen offset:1024 sc1
s_add_u32 s47, s47, 9216
buffer_load_dwordx4 v[116:119], v8, s[20:23], s47 offen sc1
buffer_load_dwordx4 v[120:123], v8, s[20:23], s47 offen offset:1024 sc1
s_add_u32 s47, s47, 9216
s_cmp_lg_u32 s58, 0
s_cbranch_scc1 Lz27
buffer_load_dwordx4 v[88:91], v8, s[20:23], s48 offen sc1
s_add_u32 s48, s48, 9216
buffer_load_dwordx4 v[100:103], v8, s[20:23], s48 offen sc1
s_add_u32 s48, s48, 9216
buffer_load_dwordx4 v[112:115], v8, s[20:23], s48 offen sc1
s_add_u32 s48, s48, 9216
buffer_load_dwordx4 v[124:127], v8, s[20:23], s48 offen sc1
s_add_u32 s48, s48, 9216
Lz27:
s_cmp_lg_u32 s58, 0
s_cbranch_scc1 Lz29
buffer_load_dwordx2 v[18:19], v30, s[4:7], s52 offen
buffer_load_dwordx2 v[20:21], v30, s[4:7], s53 offen
Lz29:
buffer_load_dwordx4 v[10:13], v29, s[4:7], s50 offen
buffer_load_dwordx4 v[14:17], v29, s[4:7], s51 offen
LH_T5:
s_barrier
LH_T7:
s_waitcnt vmcnt(10)
s_barrier
s_cmp_lg_u32 s58, 0
s_cbranch_scc1 Lz28
buffer_load_dwordx4 v[136:139], v8, s[20:23], s48 offen sc1
s_add_u32 s48, s48, 9216
buffer_load_dwordx4 v[148:151], v8, s[20:23], s48 offen sc1
s_add_u32 s48, s48, 9216
buffer_load_dwordx4 v[160:163], v8, s[20:23], s48 offen sc1
s_add_u32 s48, s48, 9216
buffer_load_dwordx4 v[172:175], v8, s[20:23], s48 offen sc1
s_add_u32 s48, s48, 9216
buffer_load_dwordx4 v[184:187], v8, s[20:23], s48 offen sc1
s_add_u32 s48, s48, 9216
buffer_load_dwordx4 v[196:199], v8, s[20:23], s48 offen sc1
s_add_u32 s48, s48, 9216
buffer_load_dwordx4 v[208:211], v8, s[20:23], s48 offen sc1
s_add_u32 s48, s48, 9216
Lz28:
buffer_load_dwordx4 v[128:131], v8, s[20:23], s47 offen sc1
buffer_load_dwordx4 v[132:135], v8, s[20:23], s47 offen offset:1024 sc1
s_add_u32 s47, s47, 9216
buffer_load_dwordx4 v[140:143], v8, s[20:23], s47 offen sc1
buffer_load_dwordx4 v[144:147], v8, s[20:23], s47 offen offset:1024 sc1
s_add_u32 s47, s47, 9216
buffer_load_dwordx4 v[152:155], v8, s[20:23], s47 offen sc1
buffer_load_dwordx4 v[156:159], v8, s[20:23], s47 offen offset:1024 sc1
s_add_u32 s47, s47, 9216
buffer_load_dwordx4 v[164:167], v8, s[20:23], s47 offen sc1
buffer_load_dwordx4 v[168:171], v8, s[20:23], s47 offen offset:1024 sc1
s_add_u32 s47, s47, 9216
buffer_load_dwordx4 v[176:179], v8, s[20:23], s47 offen sc1
buffer_load_dwordx4 v[180:183], v8, s[20:23], s47 offen offset:1024 sc1
s_add_u32 s47, s47, 9216
buffer_load_dwordx4 v[188:191], v8, s[20:23], s47 offen sc1
buffer_load_dwordx4 v[192:195], v8, s[20:23], s47 offen offset:1024 sc1
s_add_u32 s47, s47, 9216
buffer_load_dwordx4 v[200:203], v8, s[20:23], s47 offen sc1
buffer_load_dwordx4 v[204:207], v8, s[20:23], s47 offen offset:1024 sc1
s_add_u32 s47, s47, 9216
ds_read_b128 v[212:215], v8 offset:18432
ds_read_b128 v[216:219], v8 offset:19456
Lpad4362:
s_cbranch_execz Lback3
ds_read_b128 v[220:223], v8 offset:20480
ds_read_b128 v[224:227], v8 offset:21504
s_waitcnt lgkmcnt(3)
v_mfma_f32_16x16x32_bf16 v[232:235], v[32:35], v[212:215], 0
v_mfma_f32_16x16x32_bf16 v[240:243], v[36:39], v[212:215], 0
v_mfma_f32_16x16x32_bf16 v[248:251], v[40:43], v[212:215], 0
ds_read_b128 v[228:231], v8 offset:22528
s_waitcnt lgkmcnt(3)
v_mfma_f32_16x16x32_bf16 v[236:239], v[32:35], v[216:219], 0
v_mfma_f32_16x16x32_bf16 v[244:247], v[36:39], v[216:219], 0
v_mfma_f32_16x16x32_bf16 v[252:255], v[40:43], v[216:219], 0
ds_read_b128 v[212:215], v8 offset:23552
s_cmp_lg_u32 s58, 0
s_cbranch_scc1 Lz33
buffer_load_dwordx4 v[40:43], v8, s[20:23], s48 offen sc1
s_add_u32 s48, s48, 9216
Lz33:
buffer_load_dwordx4 v[32:35], v8, s[20:23], s47 offen sc1
buffer_load_dwordx4 v[36:39], v8, s[20:23], s47 offen offset:1024 sc1
s_add_u32 s47, s47, 9216
s_waitcnt lgkmcnt(3)
v_mfma_f32_16x16x32_bf16 v[232:235], v[44:47], v[220:223], v[232:235]
v_mfma_f32_16x16x32_bf16 v[240:243], v[48:51], v[220:223], v[240:243]
v_mfma_f32_16x16x32_bf16 v[248:251], v[52:55], v[220:223], v[248:251]
ds_read_b128 v[216:219], v8 offset:24576
s_waitcnt lgkmcnt(3)
v_mfma_f32_16x16x32_bf16 v[236:239], v[44:47], v[224:227], v[236:239]
v_mfma_f32_16x16x32_bf16 v[244:247], v[48:51], v[224:227], v[244:247]
v_mfma_f32_16x16x32_bf16 v[252:255], v[52:55], v[224:227], v[252:255]
ds_read_b128 v[220:223], v8 offset:25600
s_cmp_lg_u32 s58, 0
s_cbranch_scc1 Lz34
buffer_load_dwordx4 v[52:55], v8, s[20:23], s48 offen sc1
s_add_u32 s48, s48, 9216
Lz34:
buffer_load_dwordx4 v[44:47], v8, s[20:23], s47 offen sc1
buffer_load_dwordx4 v[48:51], v8, s[20:23], s47 offen offset:1024 sc1
s_add_u32 s47, s47, 9216
s_waitcnt lgkmcnt(3)
v_mfma_f32_16x16x32_bf16 v[232:235], v[56:59], v[228:231], v[232:235]
v_mfma_f32_16x16x32_bf16 v[240:243], v[60:63], v[228:231], v[240:243]
v_mfma_f32_16x16x32_bf16 v[248:251], v[64:67], v[228:231], v[248:251]
ds_read_b128 v[224:227], v8 offset:26624
s_waitcnt lgkmcnt(3)
v_mfma_f32_16x16x32_bf16 v[236:239], v[56:59], v[212:215], v[236:239]
v_mfma_f32_16x16x32_bf16 v[244:247], v[60:63], v[212:215], v[244:247]
v_mfma_f32_16x16x32_bf16 v[252:255], v[64:67], v[212:215], v[252:255]
ds_read_b128 v[228:231], v8 offset:27648
s_cmp_lg_u32 s58, 0
s_cbranch_scc1 Lz35
buffer_load_dwordx4 v[64:67], v8, s[20:23], s48 offen sc1
s_add_u32 s48, s48, 9216
Lz35:
buffer_load_dwordx4 v[56:59], v8, s[20:23], s47 offen sc1
buffer_load_dwordx4 v[60:63], v8, s[20:23], s47 offen offset:1024 sc1
s_add_u32 s47, s47, 9216
s_waitcnt lgkmcnt(3)
v_mfma_f32_16x16x32_bf16 v[232:235], v[68:71], v[216:219], v[232:235]
v_mfma_f32_16x16x32_bf16 v[240:243], v[72:75], v[216:219], v[240:243]
v_mfma_f32_16x16x32_bf16 v[248:251], v[76:79], v[216:219], v[248:251]
ds_read_b128 v[212:215], v8 offset:28672
s_waitcnt lgkmcnt(3)
v_mfma_f32_16x16x32_bf16 v[236:239], v[68:71], v[220:223], v[236:239]
v_mfma_f32_16x16x32_bf16 v[244:247], v[72:75], v[220:223], v[244:247]
v_mfma_f32_16x16x32_bf16 v[252:255], v[76:79], v[220:223], v[252:255]
ds_read_b128 v[216:219], v8 offset:29696
s_waitcnt vmcnt(28) lgkmcnt(3)
v_mfma_f32_16x16x32_bf16 v[232:235], v[80:83], v[224:227], v[232:235]
v_mfma_f32_16x16x32_bf16 v[240:243], v[84:87], v[224:227], v[240:243]
v_mfma_f32_16x16x32_bf16 v[248:251], v[88:91], v[224:227], v[248:251]
ds_read_b128 v[220:223], v8 offset:30720
s_waitcnt lgkmcnt(3)
v_mfma_f32_16x16x32_bf16 v[236:239], v[80:83], v[228:231], v[236:239]
v_mfma_f32_16x16x32_bf16 v[244:247], v[84:87], v[228:231], v[244:247]
v_mfma_f32_16x16x32_bf16 v[252:255], v[88:91], v[228:231], v[252:255]
Lpad4437:
s_cbranch_execz Lback3
ds_read_b128 v[224:227], v8 offset:31744
s_waitcnt vmcnt(26) lgkmcnt(3)
v_mfma_f32_16x16x32_bf16 v[232:235], v[92:95], v[212:215], v[232:235]
v_mfma_f32_16x16x32_bf16 v[240:243], v[96:99], v[212:215], v[240:243]
v_mfma_f32_16x16x32_bf16 v[248:251], v[100:103], v[212:215], v[248:251]
ds_read_b128 v[228:231], v8 offset:32768
ds_read_b128 v[68:71], v22
ds_read_b128 v[72:75], v22 offset:1024
ds_read_b128 v[76:79], v23 offset:8192
s_waitcnt lgkmcnt(6)
v_mfma_f32_16x16x32_bf16 v[236:239], v[92:95], v[216:219], v[236:239]
v_mfma_f32_16x16x32_bf16 v[244:247], v[96:99], v[216:219], v[244:247]
v_mfma_f32_16x16x32_bf16 v[252:255], v[100:103], v[216:219], v[252:255]
ds_read_b128 v[212:215], v8 offset:33792
s_waitcnt vmcnt(24) lgkmcnt(6)
v_mfma_f32_16x16x32_bf16 v[232:235], v[104:107], v[220:223], v[232:235]
v_mfma_f32_16x16x32_bf16 v[240:243], v[108:111], v[220:223], v[240:243]
v_mfma_f32_16x16x32_bf16 v[248:251], v[112:115], v[220:223], v[248:251]
ds_read_b128 v[216:219], v8 offset:34816
buffer_load_dword v3, v5, s[20:23], s54 offen offset:0 sc1
s_waitcnt lgkmcnt(6)
v_mfma_f32_16x16x32_bf16 v[236:239], v[104:107], v[224:227], v[236:239]
v_mfma_f32_16x16x32_bf16 v[244:247], v[108:111], v[224:227], v[244:247]
v_mfma_f32_16x16x32_bf16 v[252:255], v[112:115], v[224:227], v[252:255]
ds_read_b128 v[220:223], v8 offset:35840
s_waitcnt vmcnt(23) lgkmcnt(6)
v_mfma_f32_16x16x32_bf16 v[232:235], v[116:119], v[228:231], v[232:235]
v_mfma_f32_16x16x32_bf16 v[240:243], v[120:123], v[228:231], v[240:243]
v_mfma_f32_16x16x32_bf16 v[248:251], v[124:127], v[228:231], v[248:251]
ds_read_b128 v[224:227], v8 offset:36864
s_waitcnt lgkmcnt(3)
v_mfma_f32_16x16x32_bf16 v[236:239], v[116:119], v[212:215], v[236:239]
v_mfma_f32_16x16x32_bf16 v[244:247], v[120:123], v[212:215], v[244:247]
v_mfma_f32_16x16x32_bf16 v[252:255], v[124:127], v[212:215], v[252:255]
ds_read_b128 v[228:231], v8 offset:37888
s_waitcnt vmcnt(19) lgkmcnt(3)
v_mfma_f32_16x16x32_bf16 v[232:235], v[128:131], v[216:219], v[232:235]
v_mfma_f32_16x16x32_bf16 v[240:243], v[132:135], v[216:219], v[240:243]
v_mfma_f32_16x16x32_bf16 v[248:251], v[136:139], v[216:219], v[248:251]
ds_read_b128 v[212:215], v8 offset:38912
s_waitcnt lgkmcnt(3)
v_mfma_f32_16x16x32_bf16 v[236:239], v[128:131], v[220:223], v[236:239]
v_mfma_f32_16x16x32_bf16 v[244:247], v[132:135], v[220:223], v[244:247]
v_mfma_f32_16x16x32_bf16 v[252:255], v[136:139], v[220:223], v[252:255]
ds_read_b128 v[216:219], v8 offset:39936
s_waitcnt vmcnt(17) lgkmcnt(3)
v_mfma_f32_16x16x32_bf16 v[232:235], v[140:143], v[224:227], v[232:235]
v_mfma_f32_16x16x32_bf16 v[240:243], v[144:147], v[224:227], v[240:243]
v_mfma_f32_16x16x32_bf16 v[248:251], v[148:151], v[224:227], v[248:251]
ds_read_b128 v[220:223], v8 offset:40960
s_waitcnt lgkmcnt(3)
v_mfma_f32_16x16x32_bf16 v[236:239], v[140:143], v[228:231], v[236:239]
v_mfma_f32_16x16x32_bf16 v[244:247], v[144:147], v[228:231], v[244:247]
v_mfma_f32_16x16x32_bf16 v[252:255], v[148:151], v[228:231], v[252:255]
ds_read_b128 v[224:227], v8 offset:41984
s_waitcnt vmcnt(15) lgkmcnt(3)
v_mfma_f32_16x16x32_bf16 v[232:235], v[152:155], v[212:215], v[232:235]
v_mfma_f32_16x16x32_bf16 v[240:243], v[156:159], v[212:215], v[240:243]
v_mfma_f32_16x16x32_bf16 v[248:251], v[160:163], v[212:215], v[248:251]
ds_read_b128 v[228:231], v8 offset:43008
s_waitcnt lgkmcnt(3)
v_mfma_f32_16x16x32_bf16 v[236:239], v[152:155], v[216:219], v[236:239]
v_mfma_f32_16x16x32_bf16 v[244:247], v[156:159], v[216:219], v[244:247]
v_mfma_f32_16x16x32_bf16 v[252:255], v[160:163], v[216:219], v[252:255]
ds_read_b128 v[212:215], v8 offset:44032
s_waitcnt vmcnt(13) lgkmcnt(3)
v_mfma_f32_16x16x32_bf16 v[232:235], v[164:167], v[220:223], v[232:235]
v_lshlrev_b32 v140, 16, v10
v_and_b32 v141, 0xffff0000, v10
v_mfma_f32_16x16x32_bf16 v[240:243], v[168:171], v[220:223], v[240:243]
Lpad4507:
s_cbranch_execz Lback3
v_lshlrev_b32 v142, 16, v11
v_and_b32 v143, 0xffff0000, v11
v_mfma_f32_16x16x32_bf16 v[248:251], v[172:175], v[220:223], v[248:251]
ds_read_b128 v[216:219], v8 offset:45056
s_waitcnt lgkmcnt(3)
v_mfma_f32_16x16x32_bf16 v[236:239], v[164:167], v[224:227], v[236:239]
v_lshlrev_b32 v144, 16, v14
v_and_b32 v145, 0xffff0000, v14
v_mfma_f32_16x16x32_bf16 v[244:247], v[168:171], v[224:227], v[244:247]
v_lshlrev_b32 v146, 16, v15
v_and_b32 v147, 0xffff0000, v15
v_mfma_f32_16x16x32_bf16 v[252:255], v[172:175], v[224:227], v[252:255]
ds_read_b128 v[220:223], v8 offset:46080
s_waitcnt vmcnt(11) lgkmcnt(3)
v_mfma_f32_16x16x32_bf16 v[232:235], v[176:179], v[228:231], v[232:235]
v_lshlrev_b32 v148, 16, v12
v_and_b32 v149, 0xffff0000, v12
v_mfma_f32_16x16x32_bf16 v[240:243], v[180:183], v[228:231], v[240:243]
v_lshlrev_b32 v150, 16, v13
v_and_b32 v151, 0xffff0000, v13
v_mfma_f32_16x16x32_bf16 v[248:251], v[184:187], v[228:231], v[248:251]
ds_read_b128 v[224:227], v8 offset:47104
s_waitcnt lgkmcnt(3)
v_mfma_f32_16x16x32_bf16 v[236:239], v[176:179], v[212:215], v[236:239]
v_lshlrev_b32 v152, 16, v16
v_and_b32 v153, 0xffff0000, v16
v_mfma_f32_16x16x32_bf16 v[244:247], v[180:183], v[212:215], v[244:247]
v_lshlrev_b32 v154, 16, v17
v_and_b32 v155, 0xffff0000, v17
v_mfma_f32_16x16x32_bf16 v[252:255], v[184:187], v[212:215], v[252:255]
ds_read_b128 v[228:231], v8 offset:48128
s_waitcnt vmcnt(9) lgkmcnt(3)
v_mfma_f32_16x16x32_bf16 v[232:235], v[188:191], v[216:219], v[232:235]
v_lshlrev_b32 v156, 16, v18
v_and_b32 v157, 0xffff0000, v18
v_mfma_f32_16x16x32_bf16 v[240:243], v[192:195], v[216:219], v[240:243]
v_lshlrev_b32 v158, 16, v19
v_and_b32 v159, 0xffff0000, v19
v_mfma_f32_16x16x32_bf16 v[248:251], v[196:199], v[216:219], v[248:251]
ds_read_b128 v[212:215], v8 offset:49152
s_waitcnt vmcnt(0)
Lp31:
v_cmp_ne_u32 vcc, s59, v3
s_cbranch_vccz Lq32
buffer_load_dword v3, v5, s[20:23], s54 offen offset:0 sc1
s_waitcnt vmcnt(0)
s_add_u32 s60, s60, 1
s_cmp_lt_u32 s60, 131072
s_cbranch_scc1 Lp31
Lq32:
s_cmp_lg_u32 s58, 0
s_cbranch_scc1 Lz36
buffer_load_dwordx4 v[88:91], v8, s[20:23], s85 offen sc1
buffer_load_dwordx4 v[100:103], v8, s[20:23], s87 offen sc1
buffer_load_dwordx4 v[112:115], v8, s[20:23], s89 offen sc1
Lz36:
buffer_load_dwordx4 v[80:83], v26, s[20:23], s84 offen sc1
buffer_load_dwordx4 v[84:87], v26, s[20:23], s84 offen offset:1024 sc1
buffer_load_dwordx4 v[92:95], v26, s[20:23], s86 offen sc1
buffer_load_dwordx4 v[96:99], v26, s[20:23], s86 offen offset:1024 sc1
buffer_load_dwordx4 v[104:107], v26, s[20:23], s88 offen sc1
buffer_load_dwordx4 v[108:111], v26, s[20:23], s88 offen offset:1024 sc1
s_waitcnt lgkmcnt(3)
v_mfma_f32_16x16x32_bf16 v[236:239], v[188:191], v[220:223], v[236:239]
v_lshlrev_b32 v160, 16, v20
v_and_b32 v161, 0xffff0000, v20
v_mfma_f32_16x16x32_bf16 v[244:247], v[192:195], v[220:223], v[244:247]
v_lshlrev_b32 v162, 16, v21
v_and_b32 v163, 0xffff0000, v21
v_mfma_f32_16x16x32_bf16 v[252:255], v[196:199], v[220:223], v[252:255]
ds_read_b128 v[216:219], v8 offset:50176
s_waitcnt lgkmcnt(3)
v_mfma_f32_16x16x32_bf16 v[232:235], v[200:203], v[224:227], v[232:235]
v_lshlrev_b32 v116, 16, v68
v_and_b32 v117, 0xffff0000, v68
v_mfma_f32_16x16x32_bf16 v[240:243], v[204:207], v[224:227], v[240:243]
v_lshlrev_b32 v118, 16, v69
v_and_b32 v119, 0xffff0000, v69
v_mfma_f32_16x16x32_bf16 v[248:251], v[208:211], v[224:227], v[248:251]
ds_read_b64 v[220:221], v27 offset:0
Lpad4587:
s_cbranch_execz Lback3
ds_read_b64 v[222:223], v27 offset:256
s_waitcnt lgkmcnt(4)
v_mfma_f32_16x16x32_bf16 v[236:239], v[200:203], v[228:231], v[236:239]
v_lshlrev_b32 v120, 16, v70
v_and_b32 v121, 0xffff0000, v70
v_mfma_f32_16x16x32_bf16 v[244:247], v[204:207], v[228:231], v[244:247]
v_lshlrev_b32 v122, 16, v71
v_and_b32 v123, 0xffff0000, v71
v_mfma_f32_16x16x32_bf16 v[252:255], v[208:211], v[228:231], v[252:255]
ds_read_b64 v[224:225], v27 offset:64
ds_read_b64 v[226:227], v27 offset:320
s_waitcnt lgkmcnt(5)
v_mfma_f32_16x16x32_bf16 v[232:235], v[32:35], v[212:215], v[232:235]
v_lshlrev_b32 v124, 16, v72
v_and_b32 v125, 0xffff0000, v72
v_mfma_f32_16x16x32_bf16 v[240:243], v[36:39], v[212:215], v[240:243]
v_lshlrev_b32 v126, 16, v73
v_and_b32 v127, 0xffff0000, v73
v_mfma_f32_16x16x32_bf16 v[248:251], v[40:43], v[212:215], v[248:251]
ds_read_b64 v[228:229], v27 offset:2048
ds_read_b64 v[230:231], v27 offset:2304
s_waitcnt lgkmcnt(6)
v_mfma_f32_16x16x32_bf16 v[236:239], v[32:35], v[216:219], v[236:239]
v_lshlrev_b32 v128, 16, v74
v_and_b32 v129, 0xffff0000, v74
v_mfma_f32_16x16x32_bf16 v[244:247], v[36:39], v[216:219], v[244:247]
v_lshlrev_b32 v130, 16, v75
v_and_b32 v131, 0xffff0000, v75
v_mfma_f32_16x16x32_bf16 v[252:255], v[40:43], v[216:219], v[252:255]
ds_read_b64 v[212:213], v27 offset:2112
ds_read_b64 v[214:215], v27 offset:2368
s_waitcnt lgkmcnt(6)
v_mfma_f32_16x16x32_bf16 v[232:235], v[44:47], v[220:223], v[232:235]
v_lshlrev_b32 v132, 16, v76
v_and_b32 v133, 0xffff0000, v76
v_mfma_f32_16x16x32_bf16 v[240:243], v[48:51], v[220:223], v[240:243]
v_lshlrev_b32 v134, 16, v77
v_and_b32 v135, 0xffff0000, v77
v_mfma_f32_16x16x32_bf16 v[248:251], v[52:55], v[220:223], v[248:251]
s_waitcnt lgkmcnt(4)
v_mfma_f32_16x16x32_bf16 v[236:239], v[44:47], v[224:227], v[236:239]
v_lshlrev_b32 v136, 16, v78
v_and_b32 v137, 0xffff0000, v78
v_mfma_f32_16x16x32_bf16 v[244:247], v[48:51], v[224:227], v[244:247]
v_lshlrev_b32 v138, 16, v79
v_and_b32 v139, 0xffff0000, v79
v_mfma_f32_16x16x32_bf16 v[252:255], v[52:55], v[224:227], v[252:255]
s_waitcnt lgkmcnt(2)
v_mfma_f32_16x16x32_bf16 v[232:235], v[56:59], v[228:231], v[232:235]
v_mfma_f32_16x16x32_bf16 v[240:243], v[60:63], v[228:231], v[240:243]
v_mfma_f32_16x16x32_bf16 v[248:251], v[64:67], v[228:231], v[248:251]
s_waitcnt lgkmcnt(0)
v_mfma_f32_16x16x32_bf16 v[236:239], v[56:59], v[212:215], v[236:239]
v_mfma_f32_16x16x32_bf16 v[244:247], v[60:63], v[212:215], v[244:247]
v_mfma_f32_16x16x32_bf16 v[252:255], v[64:67], v[212:215], v[252:255]
s_mov_b32 s47, 0xbfb8aa3b
s_mov_b32 s44, 0x00003f80
s_mov_b32 s45, 0x3f800000
s_waitcnt vmcnt(4)
v_dot2c_f32_bf16 v116, s44, v80
v_dot2c_f32_bf16 v117, s45, v80
v_dot2c_f32_bf16 v118, s44, v81
v_dot2c_f32_bf16 v119, s45, v81
v_dot2c_f32_bf16 v120, s44, v82
v_dot2c_f32_bf16 v121, s45, v82
v_dot2c_f32_bf16 v122, s44, v83
v_dot2c_f32_bf16 v123, s45, v83
v_dot2c_f32_bf16 v124, s44, v84
v_dot2c_f32_bf16 v125, s45, v84
v_dot2c_f32_bf16 v126, s44, v85
v_dot2c_f32_bf16 v127, s45, v85
v_dot2c_f32_bf16 v128, s44, v86
v_dot2c_f32_bf16 v129, s45, v86
v_dot2c_f32_bf16 v130, s44, v87
v_dot2c_f32_bf16 v131, s45, v87
v_dot2c_f32_bf16 v132, s44, v88
v_dot2c_f32_bf16 v133, s45, v88
v_dot2c_f32_bf16 v134, s44, v89
v_dot2c_f32_bf16 v135, s45, v89
v_dot2c_f32_bf16 v136, s44, v90
v_dot2c_f32_bf16 v137, s45, v90
v_dot2c_f32_bf16 v138, s44, v91
v_dot2c_f32_bf16 v139, s45, v91
s_waitcnt vmcnt(2)
v_dot2c_f32_bf16 v116, s44, v92
v_dot2c_f32_bf16 v117, s45, v92
v_dot2c_f32_bf16 v118, s44, v93
Lpad4674:
s_cbranch_execz Lback3
v_dot2c_f32_bf16 v119, s45, v93
v_dot2c_f32_bf16 v120, s44, v94
v_dot2c_f32_bf16 v121, s45, v94
v_dot2c_f32_bf16 v122, s44, v95
v_dot2c_f32_bf16 v123, s45, v95
v_dot2c_f32_bf16 v124, s44, v96
v_dot2c_f32_bf16 v125, s45, v96
v_dot2c_f32_bf16 v126, s44, v97
v_dot2c_f32_bf16 v127, s45, v97
v_dot2c_f32_bf16 v128, s44, v98
v_dot2c_f32_bf16 v129, s45, v98
v_dot2c_f32_bf16 v130, s44, v99
v_dot2c_f32_bf16 v131, s45, v99
v_dot2c_f32_bf16 v132, s44, v100
v_dot2c_f32_bf16 v133, s45, v100
v_dot2c_f32_bf16 v134, s44, v101
v_dot2c_f32_bf16 v135, s45, v101
v_dot2c_f32_bf16 v136, s44, v102
v_dot2c_f32_bf16 v137, s45, v102
v_dot2c_f32_bf16 v138, s44, v103
v_dot2c_f32_bf16 v139, s45, v103
s_waitcnt vmcnt(0)
v_dot2c_f32_bf16 v116, s44, v104
v_dot2c_f32_bf16 v117, s45, v104
v_dot2c_f32_bf16 v118, s44, v105
v_dot2c_f32_bf16 v119, s45, v105
v_dot2c_f32_bf16 v120, s44, v106
v_dot2c_f32_bf16 v121, s45, v106
v_dot2c_f32_bf16 v122, s44, v107
v_dot2c_f32_bf16 v123, s45, v107
v_dot2c_f32_bf16 v124, s44, v108
v_dot2c_f32_bf16 v125, s45, v108
v_dot2c_f32_bf16 v126, s44, v109
v_dot2c_f32_bf16 v127, s45, v109
v_dot2c_f32_bf16 v128, s44, v110
v_dot2c_f32_bf16 v129, s45, v110
v_dot2c_f32_bf16 v130, s44, v111
v_dot2c_f32_bf16 v131, s45, v111
v_dot2c_f32_bf16 v132, s44, v112
v_dot2c_f32_bf16 v133, s45, v112
v_dot2c_f32_bf16 v134, s44, v113
v_dot2c_f32_bf16 v135, s45, v113
v_dot2c_f32_bf16 v136, s44, v114
v_dot2c_f32_bf16 v137, s45, v114
v_dot2c_f32_bf16 v138, s44, v115
v_dot2c_f32_bf16 v139, s45, v115
v_pk_mul_f32 v[184:185], v[116:117], s[46:47] op_sel:[0,1] op_sel_hi:[1,1]
v_pk_mul_f32 v[186:187], v[118:119], s[46:47] op_sel:[0,1] op_sel_hi:[1,1]
v_pk_mul_f32 v[192:193], v[124:125], s[46:47] op_sel:[0,1] op_sel_hi:[1,1]
v_pk_mul_f32 v[194:195], v[126:127], s[46:47] op_sel:[0,1] op_sel_hi:[1,1]
v_pk_mul_f32 v[200:201], v[132:133], s[46:47] op_sel:[0,1] op_sel_hi:[1,1]
v_pk_mul_f32 v[202:203], v[134:135], s[46:47] op_sel:[0,1] op_sel_hi:[1,1]
v_exp_f32 v184, v184
v_exp_f32 v185, v185
v_exp_f32 v186, v186
v_exp_f32 v187, v187
v_exp_f32 v192, v192
v_exp_f32 v193, v193
v_exp_f32 v194, v194
v_exp_f32 v195, v195
v_exp_f32 v200, v200
v_exp_f32 v201, v201
v_exp_f32 v202, v202
v_exp_f32 v203, v203
v_pk_add_f32 v[184:185], v[184:185], 1.0 op_sel_hi:[1,0]
v_pk_mul_f32 v[116:117], v[116:117], v[232:233]
v_pk_add_f32 v[186:187], v[186:187], 1.0 op_sel_hi:[1,0]
v_pk_mul_f32 v[118:119], v[118:119], v[234:235]
v_pk_add_f32 v[192:193], v[192:193], 1.0 op_sel_hi:[1,0]
v_pk_mul_f32 v[124:125], v[124:125], v[240:241]
v_pk_add_f32 v[194:195], v[194:195], 1.0 op_sel_hi:[1,0]
v_pk_mul_f32 v[126:127], v[126:127], v[242:243]
v_pk_add_f32 v[200:201], v[200:201], 1.0 op_sel_hi:[1,0]
v_pk_mul_f32 v[132:133], v[132:133], v[248:249]
v_pk_add_f32 v[202:203], v[202:203], 1.0 op_sel_hi:[1,0]
v_pk_mul_f32 v[134:135], v[134:135], v[250:251]
v_rcp_f32 v184, v184
v_rcp_f32 v185, v185
v_rcp_f32 v186, v186
v_rcp_f32 v187, v187
v_rcp_f32 v192, v192
v_rcp_f32 v193, v193
v_rcp_f32 v194, v194
v_rcp_f32 v195, v195
v_rcp_f32 v200, v200
v_rcp_f32 v201, v201
v_rcp_f32 v202, v202
v_rcp_f32 v203, v203
v_pk_fma_f32 v[116:117], v[116:117], v[184:185], v[140:141]
v_pk_fma_f32 v[118:119], v[118:119], v[186:187], v[142:143]
v_pk_fma_f32 v[124:125], v[124:125], v[192:193], v[148:149]
v_pk_fma_f32 v[126:127], v[126:127], v[194:195], v[150:151]
v_pk_fma_f32 v[132:133], v[132:133], v[200:201], v[156:157]
v_pk_fma_f32 v[134:135], v[134:135], v[202:203], v[158:159]
v_cvt_pk_bf16_f32 v170, v116, v117
v_cvt_pk_bf16_f32 v171, v118, v119
v_cvt_pk_bf16_f32 v172, v124, v125
v_cvt_pk_bf16_f32 v173, v126, v127
v_cvt_pk_bf16_f32 v178, v132, v133
Lpad4773:
s_cbranch_execz Lback3
v_cvt_pk_bf16_f32 v179, v134, v135
buffer_store_dwordx4 v[170:173], v29, s[24:27], s50 offen nt
s_cmp_lg_u32 s58, 0
s_cbranch_scc1 Lz37
buffer_store_dwordx2 v[178:179], v30, s[24:27], s52 offen nt
Lz37:
v_pk_mul_f32 v[188:189], v[120:121], s[46:47] op_sel:[0,1] op_sel_hi:[1,1]
v_pk_mul_f32 v[190:191], v[122:123], s[46:47] op_sel:[0,1] op_sel_hi:[1,1]
v_pk_mul_f32 v[196:197], v[128:129], s[46:47] op_sel:[0,1] op_sel_hi:[1,1]
v_pk_mul_f32 v[198:199], v[130:131], s[46:47] op_sel:[0,1] op_sel_hi:[1,1]
v_pk_mul_f32 v[204:205], v[136:137], s[46:47] op_sel:[0,1] op_sel_hi:[1,1]
v_pk_mul_f32 v[206:207], v[138:139], s[46:47] op_sel:[0,1] op_sel_hi:[1,1]
v_exp_f32 v188, v188
v_exp_f32 v189, v189
v_exp_f32 v190, v190
v_exp_f32 v191, v191
v_exp_f32 v196, v196
v_exp_f32 v197, v197
v_exp_f32 v198, v198
v_exp_f32 v199, v199
v_exp_f32 v204, v204
v_exp_f32 v205, v205
v_exp_f32 v206, v206
v_exp_f32 v207, v207
v_pk_add_f32 v[188:189], v[188:189], 1.0 op_sel_hi:[1,0]
v_pk_mul_f32 v[120:121], v[120:121], v[236:237]
v_pk_add_f32 v[190:191], v[190:191], 1.0 op_sel_hi:[1,0]
v_pk_mul_f32 v[122:123], v[122:123], v[238:239]
v_pk_add_f32 v[196:197], v[196:197], 1.0 op_sel_hi:[1,0]
v_pk_mul_f32 v[128:129], v[128:129], v[244:245]
v_pk_add_f32 v[198:199], v[198:199], 1.0 op_sel_hi:[1,0]
v_pk_mul_f32 v[130:131], v[130:131], v[246:247]
v_pk_add_f32 v[204:205], v[204:205], 1.0 op_sel_hi:[1,0]
v_pk_mul_f32 v[136:137], v[136:137], v[252:253]
v_pk_add_f32 v[206:207], v[206:207], 1.0 op_sel_hi:[1,0]
v_pk_mul_f32 v[138:139], v[138:139], v[254:255]
v_rcp_f32 v188, v188
v_rcp_f32 v189, v189
v_rcp_f32 v190, v190
v_rcp_f32 v191, v191
v_rcp_f32 v196, v196
v_rcp_f32 v197, v197
v_rcp_f32 v198, v198
v_rcp_f32 v199, v199
v_rcp_f32 v204, v204
v_rcp_f32 v205, v205
v_rcp_f32 v206, v206
v_rcp_f32 v207, v207
v_pk_fma_f32 v[120:121], v[120:121], v[188:189], v[144:145]
v_pk_fma_f32 v[122:123], v[122:123], v[190:191], v[146:147]
v_pk_fma_f32 v[128:129], v[128:129], v[196:197], v[152:153]
v_pk_fma_f32 v[130:131], v[130:131], v[198:199], v[154:155]
v_pk_fma_f32 v[136:137], v[136:137], v[204:205], v[160:161]
v_pk_fma_f32 v[138:139], v[138:139], v[206:207], v[162:163]
v_cvt_pk_bf16_f32 v174, v120, v121
v_cvt_pk_bf16_f32 v175, v122, v123
v_cvt_pk_bf16_f32 v176, v128, v129
v_cvt_pk_bf16_f32 v177, v130, v131
v_cvt_pk_bf16_f32 v180, v136, v137
v_cvt_pk_bf16_f32 v181, v138, v139
buffer_store_dwordx4 v[174:177], v29, s[24:27], s51 offen nt
s_cmp_lg_u32 s58, 0
s_cbranch_scc1 Lz38
buffer_store_dwordx2 v[180:181], v30, s[24:27], s53 offen nt
Lz38:
s_or_b32 s62, s2, s58
s_mov_b32 s63, 44212224
s_cmp_eq_u32 s62, 0
s_cselect_b32 s62, s63, 0x40000000
v_mov_b32 v3, 0
v_mov_b32 v4, s59
s_mov_b64 exec, 1
buffer_store_dword v4, v3, s[20:23], s62 offen sc1
s_mov_b64 exec, -1
LH_TF:
L_end:
s_endpgm
L_mfma2:
s_barrier
v_add_u32 v8, 0, v10
ds_read_b128 v[16:19], v8 offset:0
ds_read_b128 v[20:23], v8 offset:2048
ds_read_b64_tr_b16 v[232:233], v3 offset:16384
ds_read_b64_tr_b16 v[234:235], v3 offset:20992
ds_read_b64_tr_b16 v[236:237], v3 offset:16416
ds_read_b64_tr_b16 v[238:239], v3 offset:21024
ds_read_b64_tr_b16 v[240:241], v3 offset:16448
Lpad4860:
s_cbranch_execz Lpad4931
ds_read_b64_tr_b16 v[242:243], v3 offset:21056
ds_read_b64_tr_b16 v[244:245], v3 offset:16480
ds_read_b64_tr_b16 v[246:247], v3 offset:21088
v_xor_b32 v9, 64, v8
ds_read_b128 v[24:27], v9 offset:0
ds_read_b64_tr_b16 v[248:249], v3 offset:16512
ds_read_b64_tr_b16 v[250:251], v3 offset:21120
s_waitcnt lgkmcnt(9)
v_mfma_f32_16x16x32_bf16 v[160:163], v[16:19], v[232:235], 0
ds_read_b64_tr_b16 v[252:253], v3 offset:16544
v_mfma_f32_16x16x32_bf16 v[164:167], v[20:23], v[232:235], 0
ds_read_b64_tr_b16 v[254:255], v3 offset:21152
s_waitcnt lgkmcnt(9)
v_mfma_f32_16x16x32_bf16 v[168:171], v[16:19], v[236:239], 0
ds_read_b128 v[28:31], v9 offset:2048
ds_read_b64_tr_b16 v[232:233], v3 offset:16576
v_mfma_f32_16x16x32_bf16 v[172:175], v[20:23], v[236:239], 0
ds_read_b64_tr_b16 v[234:235], v3 offset:21184
s_waitcnt lgkmcnt(10)
v_mfma_f32_16x16x32_bf16 v[176:179], v[16:19], v[240:243], 0
ds_read_b64_tr_b16 v[236:237], v3 offset:16608
v_mfma_f32_16x16x32_bf16 v[180:183], v[20:23], v[240:243], 0
ds_read_b64_tr_b16 v[238:239], v3 offset:21216
s_waitcnt lgkmcnt(10)
v_mfma_f32_16x16x32_bf16 v[184:187], v[16:19], v[244:247], 0
ds_read_b64_tr_b16 v[240:241], v3 offset:16640
v_mfma_f32_16x16x32_bf16 v[188:191], v[20:23], v[244:247], 0
ds_read_b64_tr_b16 v[242:243], v3 offset:21248
s_waitcnt lgkmcnt(9)
v_mfma_f32_16x16x32_bf16 v[192:195], v[16:19], v[248:251], 0
ds_read_b64_tr_b16 v[244:245], v3 offset:25600
v_mfma_f32_16x16x32_bf16 v[196:199], v[20:23], v[248:251], 0
ds_read_b64_tr_b16 v[246:247], v3 offset:30208
s_waitcnt lgkmcnt(9)
v_mfma_f32_16x16x32_bf16 v[200:203], v[16:19], v[252:255], 0
ds_read_b64_tr_b16 v[248:249], v3 offset:25632
v_mfma_f32_16x16x32_bf16 v[204:207], v[20:23], v[252:255], 0
ds_read_b64_tr_b16 v[250:251], v3 offset:30240
s_waitcnt lgkmcnt(8)
v_mfma_f32_16x16x32_bf16 v[208:211], v[16:19], v[232:235], 0
ds_read_b64_tr_b16 v[252:253], v3 offset:25664
v_mfma_f32_16x16x32_bf16 v[212:215], v[20:23], v[232:235], 0
ds_read_b64_tr_b16 v[254:255], v3 offset:30272
s_waitcnt lgkmcnt(8)
v_mfma_f32_16x16x32_bf16 v[216:219], v[16:19], v[236:239], 0
ds_read_b64_tr_b16 v[232:233], v3 offset:25696
v_mfma_f32_16x16x32_bf16 v[220:223], v[20:23], v[236:239], 0
ds_read_b64_tr_b16 v[234:235], v3 offset:30304
s_waitcnt lgkmcnt(8)
v_mfma_f32_16x16x32_bf16 v[224:227], v[16:19], v[240:243], 0
ds_read_b64_tr_b16 v[236:237], v3 offset:25728
v_mfma_f32_16x16x32_bf16 v[228:231], v[20:23], v[240:243], 0
ds_read_b64_tr_b16 v[238:239], v3 offset:30336
s_waitcnt lgkmcnt(8)
v_mfma_f32_16x16x32_bf16 v[160:163], v[24:27], v[244:247], v[160:163]
ds_read_b64_tr_b16 v[240:241], v3 offset:25760
v_mfma_f32_16x16x32_bf16 v[164:167], v[28:31], v[244:247], v[164:167]
ds_read_b64_tr_b16 v[242:243], v3 offset:30368
s_waitcnt lgkmcnt(8)
v_mfma_f32_16x16x32_bf16 v[168:171], v[24:27], v[248:251], v[168:171]
ds_read_b64_tr_b16 v[244:245], v3 offset:25792
v_mfma_f32_16x16x32_bf16 v[172:175], v[28:31], v[248:251], v[172:175]
ds_read_b64_tr_b16 v[246:247], v3 offset:30400
s_waitcnt lgkmcnt(8)
v_mfma_f32_16x16x32_bf16 v[176:179], v[24:27], v[252:255], v[176:179]
ds_read_b64_tr_b16 v[248:249], v3 offset:25824
v_mfma_f32_16x16x32_bf16 v[180:183], v[28:31], v[252:255], v[180:183]
ds_read_b64_tr_b16 v[250:251], v3 offset:30432
s_waitcnt lgkmcnt(8)
v_mfma_f32_16x16x32_bf16 v[184:187], v[24:27], v[232:235], v[184:187]
ds_read_b64_tr_b16 v[252:253], v3 offset:25856
Lpad4931:
s_cbranch_execz Lpad5001
v_mfma_f32_16x16x32_bf16 v[188:191], v[28:31], v[232:235], v[188:191]
ds_read_b64_tr_b16 v[254:255], v3 offset:30464
s_waitcnt lgkmcnt(8)
s_barrier
v_mfma_f32_16x16x32_bf16 v[192:195], v[24:27], v[236:239], v[192:195]
v_add_u32 v8, 34816, v10
ds_read_b128 v[32:35], v8 offset:0
ds_read_b128 v[36:39], v8 offset:2048
v_mfma_f32_16x16x32_bf16 v[196:199], v[28:31], v[236:239], v[196:199]
ds_read_b64_tr_b16 v[232:233], v3 offset:51200
ds_read_b64_tr_b16 v[234:235], v3 offset:55808
s_waitcnt lgkmcnt(10)
v_mfma_f32_16x16x32_bf16 v[200:203], v[24:27], v[240:243], v[200:203]
ds_read_b64_tr_b16 v[236:237], v3 offset:51232
ds_read_b64_tr_b16 v[238:239], v3 offset:55840
v_mfma_f32_16x16x32_bf16 v[204:207], v[28:31], v[240:243], v[204:207]
ds_read_b32 v145, v149
s_waitcnt lgkmcnt(11)
v_mfma_f32_16x16x32_bf16 v[208:211], v[24:27], v[244:247], v[208:211]
ds_read_b64_tr_b16 v[240:241], v3 offset:51264
v_mfma_f32_16x16x32_bf16 v[212:215], v[28:31], v[244:247], v[212:215]
ds_read_b64_tr_b16 v[242:243], v3 offset:55872
s_waitcnt lgkmcnt(11)
v_mfma_f32_16x16x32_bf16 v[216:219], v[24:27], v[248:251], v[216:219]
ds_read_b64_tr_b16 v[244:245], v3 offset:51296
v_mfma_f32_16x16x32_bf16 v[220:223], v[28:31], v[248:251], v[220:223]
ds_read_b64_tr_b16 v[246:247], v3 offset:55904
s_waitcnt lgkmcnt(11)
v_mfma_f32_16x16x32_bf16 v[224:227], v[24:27], v[252:255], v[224:227]
v_xor_b32 v9, 64, v8
ds_read_b128 v[40:43], v9 offset:0
v_mfma_f32_16x16x32_bf16 v[228:231], v[28:31], v[252:255], v[228:231]
ds_read_b64_tr_b16 v[248:249], v3 offset:51328
ds_read_b64_tr_b16 v[250:251], v3 offset:55936
s_waitcnt lgkmcnt(10)
v_mfma_f32_16x16x32_bf16 v[160:163], v[32:35], v[232:235], v[160:163]
ds_read_b64_tr_b16 v[252:253], v3 offset:51360
v_mfma_f32_16x16x32_bf16 v[164:167], v[36:39], v[232:235], v[164:167]
ds_read_b64_tr_b16 v[254:255], v3 offset:55968
s_waitcnt lgkmcnt(10)
v_mfma_f32_16x16x32_bf16 v[168:171], v[32:35], v[236:239], v[168:171]
ds_read_b128 v[44:47], v9 offset:2048
ds_read_b64_tr_b16 v[232:233], v3 offset:51392
v_mfma_f32_16x16x32_bf16 v[172:175], v[36:39], v[236:239], v[172:175]
ds_read_b64_tr_b16 v[234:235], v3 offset:56000
s_waitcnt lgkmcnt(10)
v_mfma_f32_16x16x32_bf16 v[176:179], v[32:35], v[240:243], v[176:179]
ds_read_b64_tr_b16 v[236:237], v3 offset:51424
v_mfma_f32_16x16x32_bf16 v[180:183], v[36:39], v[240:243], v[180:183]
ds_read_b64_tr_b16 v[238:239], v3 offset:56032
s_waitcnt lgkmcnt(10)
v_mfma_f32_16x16x32_bf16 v[184:187], v[32:35], v[244:247], v[184:187]
ds_read_b64_tr_b16 v[240:241], v3 offset:51456
v_mfma_f32_16x16x32_bf16 v[188:191], v[36:39], v[244:247], v[188:191]
ds_read_b64_tr_b16 v[242:243], v3 offset:56064
s_waitcnt lgkmcnt(9)
v_mfma_f32_16x16x32_bf16 v[192:195], v[32:35], v[248:251], v[192:195]
ds_read_b64_tr_b16 v[244:245], v4 offset:3072
v_mfma_f32_16x16x32_bf16 v[196:199], v[36:39], v[248:251], v[196:199]
ds_read_b64_tr_b16 v[246:247], v4 offset:7680
s_waitcnt lgkmcnt(9)
v_mfma_f32_16x16x32_bf16 v[200:203], v[32:35], v[252:255], v[200:203]
ds_read_b64_tr_b16 v[248:249], v4 offset:3104
v_mfma_f32_16x16x32_bf16 v[204:207], v[36:39], v[252:255], v[204:207]
ds_read_b64_tr_b16 v[250:251], v4 offset:7712
s_waitcnt lgkmcnt(8)
v_mfma_f32_16x16x32_bf16 v[208:211], v[32:35], v[232:235], v[208:211]
ds_read_b64_tr_b16 v[252:253], v4 offset:3136
ds_read_b64_tr_b16 v[254:255], v4 offset:7744
v_mfma_f32_16x16x32_bf16 v[212:215], v[36:39], v[232:235], v[212:215]
Lpad5001:
s_cbranch_execz Lpad5074
v_readfirstlane_b32 s59, v145
v_mov_b32 v147, v145
s_mov_b64 exec, s[78:79]
buffer_store_dwordx4 v[144:147], v148, s[20:23], s75 offen sc1
s_mov_b64 exec, -1
s_waitcnt lgkmcnt(8)
v_mfma_f32_16x16x32_bf16 v[216:219], v[32:35], v[236:239], v[216:219]
ds_read_b64_tr_b16 v[232:233], v4 offset:3168
v_mfma_f32_16x16x32_bf16 v[220:223], v[36:39], v[236:239], v[220:223]
ds_read_b64_tr_b16 v[234:235], v4 offset:7776
s_waitcnt lgkmcnt(8)
v_mfma_f32_16x16x32_bf16 v[224:227], v[32:35], v[240:243], v[224:227]
ds_read_b64_tr_b16 v[236:237], v4 offset:3200
v_mfma_f32_16x16x32_bf16 v[228:231], v[36:39], v[240:243], v[228:231]
ds_read_b64_tr_b16 v[238:239], v4 offset:7808
s_waitcnt lgkmcnt(8)
v_mfma_f32_16x16x32_bf16 v[160:163], v[40:43], v[244:247], v[160:163]
ds_read_b64_tr_b16 v[240:241], v4 offset:3232
v_mfma_f32_16x16x32_bf16 v[164:167], v[44:47], v[244:247], v[164:167]
ds_read_b64_tr_b16 v[242:243], v4 offset:7840
s_waitcnt lgkmcnt(8)
v_mfma_f32_16x16x32_bf16 v[168:171], v[40:43], v[248:251], v[168:171]
ds_read_b64_tr_b16 v[244:245], v4 offset:3264
v_mfma_f32_16x16x32_bf16 v[172:175], v[44:47], v[248:251], v[172:175]
ds_read_b64_tr_b16 v[246:247], v4 offset:7872
s_waitcnt lgkmcnt(8)
v_mfma_f32_16x16x32_bf16 v[176:179], v[40:43], v[252:255], v[176:179]
ds_read_b64_tr_b16 v[248:249], v4 offset:3296
v_mfma_f32_16x16x32_bf16 v[180:183], v[44:47], v[252:255], v[180:183]
ds_read_b64_tr_b16 v[250:251], v4 offset:7904
s_waitcnt lgkmcnt(8)
v_mfma_f32_16x16x32_bf16 v[184:187], v[40:43], v[232:235], v[184:187]
ds_read_b64_tr_b16 v[252:253], v4 offset:3328
v_mfma_f32_16x16x32_bf16 v[188:191], v[44:47], v[232:235], v[188:191]
ds_read_b64_tr_b16 v[254:255], v4 offset:7936
s_waitcnt lgkmcnt(8)
s_barrier
v_mfma_f32_16x16x32_bf16 v[192:195], v[40:43], v[236:239], v[192:195]
v_add_u32 v8, 69632, v10
ds_read_b128 v[48:51], v8 offset:0
ds_read_b128 v[52:55], v8 offset:2048
v_mfma_f32_16x16x32_bf16 v[196:199], v[44:47], v[236:239], v[196:199]
ds_read_b64_tr_b16 v[232:233], v4 offset:28672
ds_read_b64_tr_b16 v[234:235], v4 offset:33280
s_waitcnt lgkmcnt(10)
v_mfma_f32_16x16x32_bf16 v[200:203], v[40:43], v[240:243], v[200:203]
ds_read_b64_tr_b16 v[236:237], v4 offset:28704
v_mfma_f32_16x16x32_bf16 v[204:207], v[44:47], v[240:243], v[204:207]
ds_read_b64_tr_b16 v[238:239], v4 offset:33312
s_waitcnt lgkmcnt(10)
v_mfma_f32_16x16x32_bf16 v[208:211], v[40:43], v[244:247], v[208:211]
ds_read_b64_tr_b16 v[240:241], v4 offset:28736
v_mfma_f32_16x16x32_bf16 v[212:215], v[44:47], v[244:247], v[212:215]
ds_read_b64_tr_b16 v[242:243], v4 offset:33344
s_waitcnt lgkmcnt(10)
v_mfma_f32_16x16x32_bf16 v[216:219], v[40:43], v[248:251], v[216:219]
ds_read_b64_tr_b16 v[244:245], v4 offset:28768
v_mfma_f32_16x16x32_bf16 v[220:223], v[44:47], v[248:251], v[220:223]
ds_read_b64_tr_b16 v[246:247], v4 offset:33376
s_waitcnt lgkmcnt(10)
v_mfma_f32_16x16x32_bf16 v[224:227], v[40:43], v[252:255], v[224:227]
v_xor_b32 v9, 64, v8
ds_read_b128 v[56:59], v9 offset:0
v_mfma_f32_16x16x32_bf16 v[228:231], v[44:47], v[252:255], v[228:231]
ds_read_b64_tr_b16 v[248:249], v4 offset:28800
ds_read_b64_tr_b16 v[250:251], v4 offset:33408
s_waitcnt lgkmcnt(9)
v_mfma_f32_16x16x32_bf16 v[160:163], v[48:51], v[232:235], v[160:163]
ds_read_b64_tr_b16 v[252:253], v4 offset:28832
v_mfma_f32_16x16x32_bf16 v[164:167], v[52:55], v[232:235], v[164:167]
ds_read_b64_tr_b16 v[254:255], v4 offset:33440
s_waitcnt lgkmcnt(9)
v_mfma_f32_16x16x32_bf16 v[168:171], v[48:51], v[236:239], v[168:171]
Lpad5074:
s_cbranch_execz Lback4
ds_read_b128 v[60:63], v9 offset:2048
ds_read_b64_tr_b16 v[232:233], v4 offset:28864
v_mfma_f32_16x16x32_bf16 v[172:175], v[52:55], v[236:239], v[172:175]
ds_read_b64_tr_b16 v[234:235], v4 offset:33472
s_waitcnt lgkmcnt(10)
v_mfma_f32_16x16x32_bf16 v[176:179], v[48:51], v[240:243], v[176:179]
ds_read_b64_tr_b16 v[236:237], v4 offset:28896
v_mfma_f32_16x16x32_bf16 v[180:183], v[52:55], v[240:243], v[180:183]
ds_read_b64_tr_b16 v[238:239], v4 offset:33504
s_waitcnt lgkmcnt(10)
v_mfma_f32_16x16x32_bf16 v[184:187], v[48:51], v[244:247], v[184:187]
ds_read_b64_tr_b16 v[240:241], v4 offset:28928
v_mfma_f32_16x16x32_bf16 v[188:191], v[52:55], v[244:247], v[188:191]
ds_read_b64_tr_b16 v[242:243], v4 offset:33536
s_waitcnt lgkmcnt(9)
v_mfma_f32_16x16x32_bf16 v[192:195], v[48:51], v[248:251], v[192:195]
ds_read_b64_tr_b16 v[244:245], v4 offset:37888
v_mfma_f32_16x16x32_bf16 v[196:199], v[52:55], v[248:251], v[196:199]
ds_read_b64_tr_b16 v[246:247], v4 offset:42496
s_waitcnt lgkmcnt(9)
v_mfma_f32_16x16x32_bf16 v[200:203], v[48:51], v[252:255], v[200:203]
ds_read_b64_tr_b16 v[248:249], v4 offset:37920
v_mfma_f32_16x16x32_bf16 v[204:207], v[52:55], v[252:255], v[204:207]
ds_read_b64_tr_b16 v[250:251], v4 offset:42528
s_waitcnt lgkmcnt(8)
v_mfma_f32_16x16x32_bf16 v[208:211], v[48:51], v[232:235], v[208:211]
ds_read_b64_tr_b16 v[252:253], v4 offset:37952
v_mfma_f32_16x16x32_bf16 v[212:215], v[52:55], v[232:235], v[212:215]
ds_read_b64_tr_b16 v[254:255], v4 offset:42560
s_waitcnt lgkmcnt(8)
v_mfma_f32_16x16x32_bf16 v[216:219], v[48:51], v[236:239], v[216:219]
ds_read_b64_tr_b16 v[232:233], v4 offset:37984
v_mfma_f32_16x16x32_bf16 v[220:223], v[52:55], v[236:239], v[220:223]
ds_read_b64_tr_b16 v[234:235], v4 offset:42592
s_waitcnt lgkmcnt(8)
v_mfma_f32_16x16x32_bf16 v[224:227], v[48:51], v[240:243], v[224:227]
ds_read_b64_tr_b16 v[236:237], v4 offset:38016
v_mfma_f32_16x16x32_bf16 v[228:231], v[52:55], v[240:243], v[228:231]
ds_read_b64_tr_b16 v[238:239], v4 offset:42624
s_waitcnt lgkmcnt(8)
v_mfma_f32_16x16x32_bf16 v[160:163], v[56:59], v[244:247], v[160:163]
ds_read_b64_tr_b16 v[240:241], v4 offset:38048
v_mfma_f32_16x16x32_bf16 v[164:167], v[60:63], v[244:247], v[164:167]
ds_read_b64_tr_b16 v[242:243], v4 offset:42656
s_waitcnt lgkmcnt(8)
v_mfma_f32_16x16x32_bf16 v[168:171], v[56:59], v[248:251], v[168:171]
ds_read_b64_tr_b16 v[244:245], v4 offset:38080
v_mfma_f32_16x16x32_bf16 v[172:175], v[60:63], v[248:251], v[172:175]
ds_read_b64_tr_b16 v[246:247], v4 offset:42688
s_waitcnt lgkmcnt(8)
v_mfma_f32_16x16x32_bf16 v[176:179], v[56:59], v[252:255], v[176:179]
ds_read_b64_tr_b16 v[248:249], v4 offset:38112
v_mfma_f32_16x16x32_bf16 v[180:183], v[60:63], v[252:255], v[180:183]
ds_read_b64_tr_b16 v[250:251], v4 offset:42720
s_waitcnt lgkmcnt(8)
v_mfma_f32_16x16x32_bf16 v[184:187], v[56:59], v[232:235], v[184:187]
ds_read_b64_tr_b16 v[252:253], v4 offset:38144
v_mfma_f32_16x16x32_bf16 v[188:191], v[60:63], v[232:235], v[188:191]
ds_read_b64_tr_b16 v[254:255], v4 offset:42752
s_waitcnt lgkmcnt(8)
s_barrier
v_mfma_f32_16x16x32_bf16 v[192:195], v[56:59], v[236:239], v[192:195]
v_add_u32 v8, 104448, v10
ds_read_b128 v[64:67], v8 offset:0
ds_read_b128 v[68:71], v8 offset:2048
v_mfma_f32_16x16x32_bf16 v[196:199], v[60:63], v[236:239], v[196:199]
ds_read_b64_tr_b16 v[232:233], v5 offset:6144
ds_read_b64_tr_b16 v[234:235], v5 offset:10752
s_waitcnt lgkmcnt(10)
v_mfma_f32_16x16x32_bf16 v[200:203], v[56:59], v[240:243], v[200:203]
ds_read_b64_tr_b16 v[236:237], v5 offset:6176
Lpad5145:
s_cbranch_execz Lpad5215
v_mfma_f32_16x16x32_bf16 v[204:207], v[60:63], v[240:243], v[204:207]
ds_read_b64_tr_b16 v[238:239], v5 offset:10784
s_waitcnt lgkmcnt(10)
v_mfma_f32_16x16x32_bf16 v[208:211], v[56:59], v[244:247], v[208:211]
ds_read_b64_tr_b16 v[240:241], v5 offset:6208
v_mfma_f32_16x16x32_bf16 v[212:215], v[60:63], v[244:247], v[212:215]
ds_read_b64_tr_b16 v[242:243], v5 offset:10816
s_waitcnt lgkmcnt(10)
v_mfma_f32_16x16x32_bf16 v[216:219], v[56:59], v[248:251], v[216:219]
ds_read_b64_tr_b16 v[244:245], v5 offset:6240
v_mfma_f32_16x16x32_bf16 v[220:223], v[60:63], v[248:251], v[220:223]
ds_read_b64_tr_b16 v[246:247], v5 offset:10848
s_waitcnt lgkmcnt(10)
v_mfma_f32_16x16x32_bf16 v[224:227], v[56:59], v[252:255], v[224:227]
v_xor_b32 v9, 64, v8
ds_read_b128 v[72:75], v9 offset:0
v_mfma_f32_16x16x32_bf16 v[228:231], v[60:63], v[252:255], v[228:231]
ds_read_b64_tr_b16 v[248:249], v5 offset:6272
ds_read_b64_tr_b16 v[250:251], v5 offset:10880
s_waitcnt lgkmcnt(9)
v_mfma_f32_16x16x32_bf16 v[160:163], v[64:67], v[232:235], v[160:163]
ds_read_b64_tr_b16 v[252:253], v5 offset:6304
v_mfma_f32_16x16x32_bf16 v[164:167], v[68:71], v[232:235], v[164:167]
ds_read_b64_tr_b16 v[254:255], v5 offset:10912
s_waitcnt lgkmcnt(9)
v_mfma_f32_16x16x32_bf16 v[168:171], v[64:67], v[236:239], v[168:171]
ds_read_b128 v[76:79], v9 offset:2048
ds_read_b64_tr_b16 v[232:233], v5 offset:6336
v_mfma_f32_16x16x32_bf16 v[172:175], v[68:71], v[236:239], v[172:175]
ds_read_b64_tr_b16 v[234:235], v5 offset:10944
s_waitcnt lgkmcnt(10)
v_mfma_f32_16x16x32_bf16 v[176:179], v[64:67], v[240:243], v[176:179]
ds_read_b64_tr_b16 v[236:237], v5 offset:6368
v_mfma_f32_16x16x32_bf16 v[180:183], v[68:71], v[240:243], v[180:183]
ds_read_b64_tr_b16 v[238:239], v5 offset:10976
s_waitcnt lgkmcnt(10)
v_mfma_f32_16x16x32_bf16 v[184:187], v[64:67], v[244:247], v[184:187]
ds_read_b64_tr_b16 v[240:241], v5 offset:6400
v_mfma_f32_16x16x32_bf16 v[188:191], v[68:71], v[244:247], v[188:191]
ds_read_b64_tr_b16 v[242:243], v5 offset:11008
s_waitcnt lgkmcnt(9)
v_mfma_f32_16x16x32_bf16 v[192:195], v[64:67], v[248:251], v[192:195]
ds_read_b64_tr_b16 v[244:245], v5 offset:15360
v_mfma_f32_16x16x32_bf16 v[196:199], v[68:71], v[248:251], v[196:199]
ds_read_b64_tr_b16 v[246:247], v5 offset:19968
s_waitcnt lgkmcnt(9)
v_mfma_f32_16x16x32_bf16 v[200:203], v[64:67], v[252:255], v[200:203]
ds_read_b64_tr_b16 v[248:249], v5 offset:15392
v_mfma_f32_16x16x32_bf16 v[204:207], v[68:71], v[252:255], v[204:207]
ds_read_b64_tr_b16 v[250:251], v5 offset:20000
s_waitcnt lgkmcnt(8)
v_mfma_f32_16x16x32_bf16 v[208:211], v[64:67], v[232:235], v[208:211]
ds_read_b64_tr_b16 v[252:253], v5 offset:15424
v_mfma_f32_16x16x32_bf16 v[212:215], v[68:71], v[232:235], v[212:215]
ds_read_b64_tr_b16 v[254:255], v5 offset:20032
s_waitcnt lgkmcnt(8)
v_mfma_f32_16x16x32_bf16 v[216:219], v[64:67], v[236:239], v[216:219]
ds_read_b64_tr_b16 v[232:233], v5 offset:15456
v_mfma_f32_16x16x32_bf16 v[220:223], v[68:71], v[236:239], v[220:223]
ds_read_b64_tr_b16 v[234:235], v5 offset:20064
s_waitcnt lgkmcnt(8)
v_mfma_f32_16x16x32_bf16 v[224:227], v[64:67], v[240:243], v[224:227]
ds_read_b64_tr_b16 v[236:237], v5 offset:15488
v_mfma_f32_16x16x32_bf16 v[228:231], v[68:71], v[240:243], v[228:231]
ds_read_b64_tr_b16 v[238:239], v5 offset:20096
s_waitcnt lgkmcnt(8)
v_mfma_f32_16x16x32_bf16 v[160:163], v[72:75], v[244:247], v[160:163]
ds_read_b64_tr_b16 v[240:241], v5 offset:15520
v_mfma_f32_16x16x32_bf16 v[164:167], v[76:79], v[244:247], v[164:167]
ds_read_b64_tr_b16 v[242:243], v5 offset:20128
Lpad5215:
s_cbranch_execz Lpad5287
s_waitcnt lgkmcnt(8)
v_mfma_f32_16x16x32_bf16 v[168:171], v[72:75], v[248:251], v[168:171]
ds_read_b64_tr_b16 v[244:245], v5 offset:15552
v_mfma_f32_16x16x32_bf16 v[172:175], v[76:79], v[248:251], v[172:175]
ds_read_b64_tr_b16 v[246:247], v5 offset:20160
s_waitcnt lgkmcnt(8)
v_mfma_f32_16x16x32_bf16 v[176:179], v[72:75], v[252:255], v[176:179]
ds_read_b64_tr_b16 v[248:249], v5 offset:15584
v_mfma_f32_16x16x32_bf16 v[180:183], v[76:79], v[252:255], v[180:183]
ds_read_b64_tr_b16 v[250:251], v5 offset:20192
s_waitcnt lgkmcnt(8)
v_mfma_f32_16x16x32_bf16 v[184:187], v[72:75], v[232:235], v[184:187]
ds_read_b64_tr_b16 v[252:253], v5 offset:15616
v_mfma_f32_16x16x32_bf16 v[188:191], v[76:79], v[232:235], v[188:191]
ds_read_b64_tr_b16 v[254:255], v5 offset:20224
s_waitcnt lgkmcnt(8)
s_barrier
v_mfma_f32_16x16x32_bf16 v[192:195], v[72:75], v[236:239], v[192:195]
v_add_u32 v8, 0, v10
ds_read_b128 v[80:83], v8 offset:0
ds_read_b128 v[84:87], v8 offset:2048
v_mfma_f32_16x16x32_bf16 v[196:199], v[76:79], v[236:239], v[196:199]
ds_read_b64_tr_b16 v[232:233], v3 offset:16384
ds_read_b64_tr_b16 v[234:235], v3 offset:20992
s_waitcnt lgkmcnt(10)
v_mfma_f32_16x16x32_bf16 v[200:203], v[72:75], v[240:243], v[200:203]
ds_read_b64_tr_b16 v[236:237], v3 offset:16416
v_mfma_f32_16x16x32_bf16 v[204:207], v[76:79], v[240:243], v[204:207]
ds_read_b64_tr_b16 v[238:239], v3 offset:21024
s_waitcnt lgkmcnt(10)
v_mfma_f32_16x16x32_bf16 v[208:211], v[72:75], v[244:247], v[208:211]
ds_read_b64_tr_b16 v[240:241], v3 offset:16448
v_mfma_f32_16x16x32_bf16 v[212:215], v[76:79], v[244:247], v[212:215]
ds_read_b64_tr_b16 v[242:243], v3 offset:21056
s_waitcnt lgkmcnt(10)
v_mfma_f32_16x16x32_bf16 v[216:219], v[72:75], v[248:251], v[216:219]
ds_read_b64_tr_b16 v[244:245], v3 offset:16480
v_mfma_f32_16x16x32_bf16 v[220:223], v[76:79], v[248:251], v[220:223]
ds_read_b64_tr_b16 v[246:247], v3 offset:21088
s_waitcnt lgkmcnt(10)
v_mfma_f32_16x16x32_bf16 v[224:227], v[72:75], v[252:255], v[224:227]
v_xor_b32 v9, 64, v8
ds_read_b128 v[88:91], v9 offset:0
v_mfma_f32_16x16x32_bf16 v[228:231], v[76:79], v[252:255], v[228:231]
ds_read_b64_tr_b16 v[248:249], v3 offset:16512
ds_read_b64_tr_b16 v[250:251], v3 offset:21120
s_waitcnt lgkmcnt(9)
v_mfma_f32_16x16x32_bf16 v[160:163], v[80:83], v[232:235], v[160:163]
ds_read_b64_tr_b16 v[252:253], v3 offset:16544
v_mfma_f32_16x16x32_bf16 v[164:167], v[84:87], v[232:235], v[164:167]
ds_read_b64_tr_b16 v[254:255], v3 offset:21152
s_waitcnt lgkmcnt(9)
v_mfma_f32_16x16x32_bf16 v[168:171], v[80:83], v[236:239], v[168:171]
ds_read_b128 v[92:95], v9 offset:2048
ds_read_b64_tr_b16 v[232:233], v3 offset:16576
v_mfma_f32_16x16x32_bf16 v[172:175], v[84:87], v[236:239], v[172:175]
ds_read_b64_tr_b16 v[234:235], v3 offset:21184
s_waitcnt lgkmcnt(10)
v_mfma_f32_16x16x32_bf16 v[176:179], v[80:83], v[240:243], v[176:179]
ds_read_b64_tr_b16 v[236:237], v3 offset:16608
v_mfma_f32_16x16x32_bf16 v[180:183], v[84:87], v[240:243], v[180:183]
ds_read_b64_tr_b16 v[238:239], v3 offset:21216
s_waitcnt lgkmcnt(10)
v_mfma_f32_16x16x32_bf16 v[184:187], v[80:83], v[244:247], v[184:187]
ds_read_b64_tr_b16 v[240:241], v3 offset:16640
v_mfma_f32_16x16x32_bf16 v[188:191], v[84:87], v[244:247], v[188:191]
ds_read_b64_tr_b16 v[242:243], v3 offset:21248
s_waitcnt lgkmcnt(9)
v_mfma_f32_16x16x32_bf16 v[192:195], v[80:83], v[248:251], v[192:195]
ds_read_b64_tr_b16 v[244:245], v3 offset:25600
v_mfma_f32_16x16x32_bf16 v[196:199], v[84:87], v[248:251], v[196:199]
ds_read_b64_tr_b16 v[246:247], v3 offset:30208
Lpad5287:
s_cbranch_execz Lback4
s_waitcnt lgkmcnt(9)
v_mfma_f32_16x16x32_bf16 v[200:203], v[80:83], v[252:255], v[200:203]
ds_read_b64_tr_b16 v[248:249], v3 offset:25632
v_mfma_f32_16x16x32_bf16 v[204:207], v[84:87], v[252:255], v[204:207]
ds_read_b64_tr_b16 v[250:251], v3 offset:30240
s_waitcnt lgkmcnt(8)
v_mfma_f32_16x16x32_bf16 v[208:211], v[80:83], v[232:235], v[208:211]
ds_read_b64_tr_b16 v[252:253], v3 offset:25664
v_mfma_f32_16x16x32_bf16 v[212:215], v[84:87], v[232:235], v[212:215]
ds_read_b64_tr_b16 v[254:255], v3 offset:30272
s_waitcnt lgkmcnt(8)
v_mfma_f32_16x16x32_bf16 v[216:219], v[80:83], v[236:239], v[216:219]
ds_read_b64_tr_b16 v[232:233], v3 offset:25696
v_mfma_f32_16x16x32_bf16 v[220:223], v[84:87], v[236:239], v[220:223]
ds_read_b64_tr_b16 v[234:235], v3 offset:30304
s_waitcnt lgkmcnt(8)
v_mfma_f32_16x16x32_bf16 v[224:227], v[80:83], v[240:243], v[224:227]
ds_read_b64_tr_b16 v[236:237], v3 offset:25728
v_mfma_f32_16x16x32_bf16 v[228:231], v[84:87], v[240:243], v[228:231]
ds_read_b64_tr_b16 v[238:239], v3 offset:30336
s_waitcnt lgkmcnt(8)
v_mfma_f32_16x16x32_bf16 v[160:163], v[88:91], v[244:247], v[160:163]
ds_read_b64_tr_b16 v[240:241], v3 offset:25760
v_mfma_f32_16x16x32_bf16 v[164:167], v[92:95], v[244:247], v[164:167]
ds_read_b64_tr_b16 v[242:243], v3 offset:30368
s_waitcnt lgkmcnt(8)
v_mfma_f32_16x16x32_bf16 v[168:171], v[88:91], v[248:251], v[168:171]
ds_read_b64_tr_b16 v[244:245], v3 offset:25792
v_mfma_f32_16x16x32_bf16 v[172:175], v[92:95], v[248:251], v[172:175]
ds_read_b64_tr_b16 v[246:247], v3 offset:30400
s_waitcnt lgkmcnt(8)
v_mfma_f32_16x16x32_bf16 v[176:179], v[88:91], v[252:255], v[176:179]
ds_read_b64_tr_b16 v[248:249], v3 offset:25824
v_mfma_f32_16x16x32_bf16 v[180:183], v[92:95], v[252:255], v[180:183]
ds_read_b64_tr_b16 v[250:251], v3 offset:30432
s_waitcnt lgkmcnt(8)
v_mfma_f32_16x16x32_bf16 v[184:187], v[88:91], v[232:235], v[184:187]
ds_read_b64_tr_b16 v[252:253], v3 offset:25856
v_mfma_f32_16x16x32_bf16 v[188:191], v[92:95], v[232:235], v[188:191]
ds_read_b64_tr_b16 v[254:255], v3 offset:30464
s_waitcnt lgkmcnt(8)
s_barrier
v_mfma_f32_16x16x32_bf16 v[192:195], v[88:91], v[236:239], v[192:195]
v_add_u32 v8, 34816, v10
ds_read_b128 v[96:99], v8 offset:0
ds_read_b128 v[100:103], v8 offset:2048
v_mfma_f32_16x16x32_bf16 v[196:199], v[92:95], v[236:239], v[196:199]
ds_read_b64_tr_b16 v[232:233], v3 offset:51200
ds_read_b64_tr_b16 v[234:235], v3 offset:55808
s_waitcnt lgkmcnt(10)
v_mfma_f32_16x16x32_bf16 v[200:203], v[88:91], v[240:243], v[200:203]
ds_read_b64_tr_b16 v[236:237], v3 offset:51232
v_mfma_f32_16x16x32_bf16 v[204:207], v[92:95], v[240:243], v[204:207]
ds_read_b64_tr_b16 v[238:239], v3 offset:55840
s_waitcnt lgkmcnt(10)
v_mfma_f32_16x16x32_bf16 v[208:211], v[88:91], v[244:247], v[208:211]
ds_read_b64_tr_b16 v[240:241], v3 offset:51264
v_mfma_f32_16x16x32_bf16 v[212:215], v[92:95], v[244:247], v[212:215]
ds_read_b64_tr_b16 v[242:243], v3 offset:55872
s_waitcnt lgkmcnt(10)
v_mfma_f32_16x16x32_bf16 v[216:219], v[88:91], v[248:251], v[216:219]
ds_read_b64_tr_b16 v[244:245], v3 offset:51296
v_mfma_f32_16x16x32_bf16 v[220:223], v[92:95], v[248:251], v[220:223]
ds_read_b64_tr_b16 v[246:247], v3 offset:55904
s_waitcnt lgkmcnt(10)
v_mfma_f32_16x16x32_bf16 v[224:227], v[88:91], v[252:255], v[224:227]
v_xor_b32 v9, 64, v8
ds_read_b128 v[104:107], v9 offset:0
v_mfma_f32_16x16x32_bf16 v[228:231], v[92:95], v[252:255], v[228:231]
ds_read_b64_tr_b16 v[248:249], v3 offset:51328
ds_read_b64_tr_b16 v[250:251], v3 offset:55936
Lpad5358:
s_cbranch_execz Lpad5429
s_waitcnt lgkmcnt(9)
v_mfma_f32_16x16x32_bf16 v[160:163], v[96:99], v[232:235], v[160:163]
ds_read_b64_tr_b16 v[252:253], v3 offset:51360
v_mfma_f32_16x16x32_bf16 v[164:167], v[100:103], v[232:235], v[164:167]
ds_read_b64_tr_b16 v[254:255], v3 offset:55968
s_waitcnt lgkmcnt(9)
v_mfma_f32_16x16x32_bf16 v[168:171], v[96:99], v[236:239], v[168:171]
ds_read_b128 v[108:111], v9 offset:2048
ds_read_b64_tr_b16 v[232:233], v3 offset:51392
v_mfma_f32_16x16x32_bf16 v[172:175], v[100:103], v[236:239], v[172:175]
ds_read_b64_tr_b16 v[234:235], v3 offset:56000
s_waitcnt lgkmcnt(10)
v_mfma_f32_16x16x32_bf16 v[176:179], v[96:99], v[240:243], v[176:179]
ds_read_b64_tr_b16 v[236:237], v3 offset:51424
v_mfma_f32_16x16x32_bf16 v[180:183], v[100:103], v[240:243], v[180:183]
ds_read_b64_tr_b16 v[238:239], v3 offset:56032
s_waitcnt lgkmcnt(10)
v_mfma_f32_16x16x32_bf16 v[184:187], v[96:99], v[244:247], v[184:187]
ds_read_b64_tr_b16 v[240:241], v3 offset:51456
v_mfma_f32_16x16x32_bf16 v[188:191], v[100:103], v[244:247], v[188:191]
ds_read_b64_tr_b16 v[242:243], v3 offset:56064
s_waitcnt lgkmcnt(9)
v_mfma_f32_16x16x32_bf16 v[192:195], v[96:99], v[248:251], v[192:195]
ds_read_b64_tr_b16 v[244:245], v4 offset:3072
v_mfma_f32_16x16x32_bf16 v[196:199], v[100:103], v[248:251], v[196:199]
ds_read_b64_tr_b16 v[246:247], v4 offset:7680
s_waitcnt lgkmcnt(9)
v_mfma_f32_16x16x32_bf16 v[200:203], v[96:99], v[252:255], v[200:203]
ds_read_b64_tr_b16 v[248:249], v4 offset:3104
v_mfma_f32_16x16x32_bf16 v[204:207], v[100:103], v[252:255], v[204:207]
ds_read_b64_tr_b16 v[250:251], v4 offset:7712
s_waitcnt lgkmcnt(8)
v_mfma_f32_16x16x32_bf16 v[208:211], v[96:99], v[232:235], v[208:211]
ds_read_b64_tr_b16 v[252:253], v4 offset:3136
v_mfma_f32_16x16x32_bf16 v[212:215], v[100:103], v[232:235], v[212:215]
ds_read_b64_tr_b16 v[254:255], v4 offset:7744
s_waitcnt lgkmcnt(8)
v_mfma_f32_16x16x32_bf16 v[216:219], v[96:99], v[236:239], v[216:219]
ds_read_b64_tr_b16 v[232:233], v4 offset:3168
v_mfma_f32_16x16x32_bf16 v[220:223], v[100:103], v[236:239], v[220:223]
ds_read_b64_tr_b16 v[234:235], v4 offset:7776
s_waitcnt lgkmcnt(8)
v_mfma_f32_16x16x32_bf16 v[224:227], v[96:99], v[240:243], v[224:227]
ds_read_b64_tr_b16 v[236:237], v4 offset:3200
v_mfma_f32_16x16x32_bf16 v[228:231], v[100:103], v[240:243], v[228:231]
ds_read_b64_tr_b16 v[238:239], v4 offset:7808
s_waitcnt lgkmcnt(8)
v_mfma_f32_16x16x32_bf16 v[160:163], v[104:107], v[244:247], v[160:163]
ds_read_b64_tr_b16 v[240:241], v4 offset:3232
v_mfma_f32_16x16x32_bf16 v[164:167], v[108:111], v[244:247], v[164:167]
ds_read_b64_tr_b16 v[242:243], v4 offset:7840
s_waitcnt lgkmcnt(8)
v_mfma_f32_16x16x32_bf16 v[168:171], v[104:107], v[248:251], v[168:171]
ds_read_b64_tr_b16 v[244:245], v4 offset:3264
v_mfma_f32_16x16x32_bf16 v[172:175], v[108:111], v[248:251], v[172:175]
ds_read_b64_tr_b16 v[246:247], v4 offset:7872
s_waitcnt lgkmcnt(8)
v_mfma_f32_16x16x32_bf16 v[176:179], v[104:107], v[252:255], v[176:179]
ds_read_b64_tr_b16 v[248:249], v4 offset:3296
v_mfma_f32_16x16x32_bf16 v[180:183], v[108:111], v[252:255], v[180:183]
ds_read_b64_tr_b16 v[250:251], v4 offset:7904
s_waitcnt lgkmcnt(8)
v_mfma_f32_16x16x32_bf16 v[184:187], v[104:107], v[232:235], v[184:187]
ds_read_b64_tr_b16 v[252:253], v4 offset:3328
v_mfma_f32_16x16x32_bf16 v[188:191], v[108:111], v[232:235], v[188:191]
ds_read_b64_tr_b16 v[254:255], v4 offset:7936
s_waitcnt lgkmcnt(8)
s_barrier
v_mfma_f32_16x16x32_bf16 v[192:195], v[104:107], v[236:239], v[192:195]
v_add_u32 v8, 69632, v10
ds_read_b128 v[112:115], v8 offset:0
Lpad5429:
s_cbranch_execz Lpad5499
ds_read_b128 v[116:119], v8 offset:2048
v_mfma_f32_16x16x32_bf16 v[196:199], v[108:111], v[236:239], v[196:199]
ds_read_b64_tr_b16 v[232:233], v4 offset:28672
ds_read_b64_tr_b16 v[234:235], v4 offset:33280
s_waitcnt lgkmcnt(10)
v_mfma_f32_16x16x32_bf16 v[200:203], v[104:107], v[240:243], v[200:203]
ds_read_b64_tr_b16 v[236:237], v4 offset:28704
v_mfma_f32_16x16x32_bf16 v[204:207], v[108:111], v[240:243], v[204:207]
ds_read_b64_tr_b16 v[238:239], v4 offset:33312
s_waitcnt lgkmcnt(10)
v_mfma_f32_16x16x32_bf16 v[208:211], v[104:107], v[244:247], v[208:211]
ds_read_b64_tr_b16 v[240:241], v4 offset:28736
v_mfma_f32_16x16x32_bf16 v[212:215], v[108:111], v[244:247], v[212:215]
ds_read_b64_tr_b16 v[242:243], v4 offset:33344
s_waitcnt lgkmcnt(10)
v_mfma_f32_16x16x32_bf16 v[216:219], v[104:107], v[248:251], v[216:219]
ds_read_b64_tr_b16 v[244:245], v4 offset:28768
v_mfma_f32_16x16x32_bf16 v[220:223], v[108:111], v[248:251], v[220:223]
ds_read_b64_tr_b16 v[246:247], v4 offset:33376
s_waitcnt lgkmcnt(10)
v_mfma_f32_16x16x32_bf16 v[224:227], v[104:107], v[252:255], v[224:227]
v_xor_b32 v9, 64, v8
ds_read_b128 v[120:123], v9 offset:0
v_mfma_f32_16x16x32_bf16 v[228:231], v[108:111], v[252:255], v[228:231]
ds_read_b64_tr_b16 v[248:249], v4 offset:28800
ds_read_b64_tr_b16 v[250:251], v4 offset:33408
s_waitcnt lgkmcnt(9)
v_mfma_f32_16x16x32_bf16 v[160:163], v[112:115], v[232:235], v[160:163]
ds_read_b64_tr_b16 v[252:253], v4 offset:28832
v_mfma_f32_16x16x32_bf16 v[164:167], v[116:119], v[232:235], v[164:167]
ds_read_b64_tr_b16 v[254:255], v4 offset:33440
s_waitcnt lgkmcnt(9)
v_mfma_f32_16x16x32_bf16 v[168:171], v[112:115], v[236:239], v[168:171]
ds_read_b128 v[124:127], v9 offset:2048
ds_read_b64_tr_b16 v[232:233], v4 offset:28864
v_mfma_f32_16x16x32_bf16 v[172:175], v[116:119], v[236:239], v[172:175]
ds_read_b64_tr_b16 v[234:235], v4 offset:33472
s_waitcnt lgkmcnt(10)
v_mfma_f32_16x16x32_bf16 v[176:179], v[112:115], v[240:243], v[176:179]
ds_read_b64_tr_b16 v[236:237], v4 offset:28896
v_mfma_f32_16x16x32_bf16 v[180:183], v[116:119], v[240:243], v[180:183]
ds_read_b64_tr_b16 v[238:239], v4 offset:33504
s_waitcnt lgkmcnt(10)
v_mfma_f32_16x16x32_bf16 v[184:187], v[112:115], v[244:247], v[184:187]
ds_read_b64_tr_b16 v[240:241], v4 offset:28928
v_mfma_f32_16x16x32_bf16 v[188:191], v[116:119], v[244:247], v[188:191]
ds_read_b64_tr_b16 v[242:243], v4 offset:33536
s_waitcnt lgkmcnt(9)
v_mfma_f32_16x16x32_bf16 v[192:195], v[112:115], v[248:251], v[192:195]
ds_read_b64_tr_b16 v[244:245], v4 offset:37888
v_mfma_f32_16x16x32_bf16 v[196:199], v[116:119], v[248:251], v[196:199]
ds_read_b64_tr_b16 v[246:247], v4 offset:42496
s_waitcnt lgkmcnt(9)
v_mfma_f32_16x16x32_bf16 v[200:203], v[112:115], v[252:255], v[200:203]
ds_read_b64_tr_b16 v[248:249], v4 offset:37920
v_mfma_f32_16x16x32_bf16 v[204:207], v[116:119], v[252:255], v[204:207]
ds_read_b64_tr_b16 v[250:251], v4 offset:42528
s_waitcnt lgkmcnt(8)
v_mfma_f32_16x16x32_bf16 v[208:211], v[112:115], v[232:235], v[208:211]
ds_read_b64_tr_b16 v[252:253], v4 offset:37952
v_mfma_f32_16x16x32_bf16 v[212:215], v[116:119], v[232:235], v[212:215]
ds_read_b64_tr_b16 v[254:255], v4 offset:42560
s_waitcnt lgkmcnt(8)
v_mfma_f32_16x16x32_bf16 v[216:219], v[112:115], v[236:239], v[216:219]
ds_read_b64_tr_b16 v[232:233], v4 offset:37984
v_mfma_f32_16x16x32_bf16 v[220:223], v[116:119], v[236:239], v[220:223]
ds_read_b64_tr_b16 v[234:235], v4 offset:42592
s_waitcnt lgkmcnt(8)
v_mfma_f32_16x16x32_bf16 v[224:227], v[112:115], v[240:243], v[224:227]
ds_read_b64_tr_b16 v[236:237], v4 offset:38016
Lpad5499:
s_cbranch_execz Lpad5570
v_mfma_f32_16x16x32_bf16 v[228:231], v[116:119], v[240:243], v[228:231]
ds_read_b64_tr_b16 v[238:239], v4 offset:42624
s_waitcnt lgkmcnt(8)
v_mfma_f32_16x16x32_bf16 v[160:163], v[120:123], v[244:247], v[160:163]
ds_read_b64_tr_b16 v[240:241], v4 offset:38048
v_mfma_f32_16x16x32_bf16 v[164:167], v[124:127], v[244:247], v[164:167]
ds_read_b64_tr_b16 v[242:243], v4 offset:42656
s_waitcnt lgkmcnt(8)
v_mfma_f32_16x16x32_bf16 v[168:171], v[120:123], v[248:251], v[168:171]
ds_read_b64_tr_b16 v[244:245], v4 offset:38080
v_mfma_f32_16x16x32_bf16 v[172:175], v[124:127], v[248:251], v[172:175]
ds_read_b64_tr_b16 v[246:247], v4 offset:42688
s_waitcnt lgkmcnt(8)
v_mfma_f32_16x16x32_bf16 v[176:179], v[120:123], v[252:255], v[176:179]
ds_read_b64_tr_b16 v[248:249], v4 offset:38112
v_mfma_f32_16x16x32_bf16 v[180:183], v[124:127], v[252:255], v[180:183]
ds_read_b64_tr_b16 v[250:251], v4 offset:42720
s_waitcnt lgkmcnt(8)
v_mfma_f32_16x16x32_bf16 v[184:187], v[120:123], v[232:235], v[184:187]
ds_read_b64_tr_b16 v[252:253], v4 offset:38144
v_mfma_f32_16x16x32_bf16 v[188:191], v[124:127], v[232:235], v[188:191]
ds_read_b64_tr_b16 v[254:255], v4 offset:42752
s_waitcnt lgkmcnt(8)
s_barrier
v_mfma_f32_16x16x32_bf16 v[192:195], v[120:123], v[236:239], v[192:195]
v_add_u32 v8, 104448, v10
ds_read_b128 v[128:131], v8 offset:0
ds_read_b128 v[132:135], v8 offset:2048
v_mfma_f32_16x16x32_bf16 v[196:199], v[124:127], v[236:239], v[196:199]
ds_read_b64_tr_b16 v[232:233], v5 offset:6144
ds_read_b64_tr_b16 v[234:235], v5 offset:10752
s_waitcnt lgkmcnt(10)
v_mfma_f32_16x16x32_bf16 v[200:203], v[120:123], v[240:243], v[200:203]
ds_read_b64_tr_b16 v[236:237], v5 offset:6176
v_mfma_f32_16x16x32_bf16 v[204:207], v[124:127], v[240:243], v[204:207]
ds_read_b64_tr_b16 v[238:239], v5 offset:10784
s_waitcnt lgkmcnt(10)
v_mfma_f32_16x16x32_bf16 v[208:211], v[120:123], v[244:247], v[208:211]
ds_read_b64_tr_b16 v[240:241], v5 offset:6208
v_mfma_f32_16x16x32_bf16 v[212:215], v[124:127], v[244:247], v[212:215]
ds_read_b64_tr_b16 v[242:243], v5 offset:10816
s_waitcnt lgkmcnt(10)
v_mfma_f32_16x16x32_bf16 v[216:219], v[120:123], v[248:251], v[216:219]
ds_read_b64_tr_b16 v[244:245], v5 offset:6240
v_mfma_f32_16x16x32_bf16 v[220:223], v[124:127], v[248:251], v[220:223]
ds_read_b64_tr_b16 v[246:247], v5 offset:10848
s_waitcnt lgkmcnt(10)
v_mfma_f32_16x16x32_bf16 v[224:227], v[120:123], v[252:255], v[224:227]
v_xor_b32 v9, 64, v8
ds_read_b128 v[136:139], v9 offset:0
v_mfma_f32_16x16x32_bf16 v[228:231], v[124:127], v[252:255], v[228:231]
ds_read_b64_tr_b16 v[248:249], v5 offset:6272
ds_read_b64_tr_b16 v[250:251], v5 offset:10880
s_waitcnt lgkmcnt(9)
v_mfma_f32_16x16x32_bf16 v[160:163], v[128:131], v[232:235], v[160:163]
ds_read_b64_tr_b16 v[252:253], v5 offset:6304
v_mfma_f32_16x16x32_bf16 v[164:167], v[132:135], v[232:235], v[164:167]
ds_read_b64_tr_b16 v[254:255], v5 offset:10912
s_waitcnt lgkmcnt(9)
v_mfma_f32_16x16x32_bf16 v[168:171], v[128:131], v[236:239], v[168:171]
ds_read_b128 v[140:143], v9 offset:2048
ds_read_b64_tr_b16 v[232:233], v5 offset:6336
v_mfma_f32_16x16x32_bf16 v[172:175], v[132:135], v[236:239], v[172:175]
ds_read_b64_tr_b16 v[234:235], v5 offset:10944
s_waitcnt lgkmcnt(10)
v_mfma_f32_16x16x32_bf16 v[176:179], v[128:131], v[240:243], v[176:179]
ds_read_b64_tr_b16 v[236:237], v5 offset:6368
v_mfma_f32_16x16x32_bf16 v[180:183], v[132:135], v[240:243], v[180:183]
ds_read_b64_tr_b16 v[238:239], v5 offset:10976
s_waitcnt lgkmcnt(10)
v_mfma_f32_16x16x32_bf16 v[184:187], v[128:131], v[244:247], v[184:187]
Lpad5570:
s_cbranch_execz Lback4
ds_read_b64_tr_b16 v[240:241], v5 offset:6400
v_mfma_f32_16x16x32_bf16 v[188:191], v[132:135], v[244:247], v[188:191]
ds_read_b64_tr_b16 v[242:243], v5 offset:11008
s_waitcnt lgkmcnt(9)
v_mfma_f32_16x16x32_bf16 v[192:195], v[128:131], v[248:251], v[192:195]
ds_read_b64_tr_b16 v[244:245], v5 offset:15360
v_mfma_f32_16x16x32_bf16 v[196:199], v[132:135], v[248:251], v[196:199]
ds_read_b64_tr_b16 v[246:247], v5 offset:19968
s_waitcnt lgkmcnt(9)
v_mfma_f32_16x16x32_bf16 v[200:203], v[128:131], v[252:255], v[200:203]
ds_read_b64_tr_b16 v[248:249], v5 offset:15392
v_mfma_f32_16x16x32_bf16 v[204:207], v[132:135], v[252:255], v[204:207]
ds_read_b64_tr_b16 v[250:251], v5 offset:20000
s_waitcnt lgkmcnt(8)
v_mfma_f32_16x16x32_bf16 v[208:211], v[128:131], v[232:235], v[208:211]
ds_read_b64_tr_b16 v[252:253], v5 offset:15424
v_mfma_f32_16x16x32_bf16 v[212:215], v[132:135], v[232:235], v[212:215]
ds_read_b64_tr_b16 v[254:255], v5 offset:20032
s_waitcnt lgkmcnt(8)
v_mfma_f32_16x16x32_bf16 v[216:219], v[128:131], v[236:239], v[216:219]
ds_read_b64_tr_b16 v[232:233], v5 offset:15456
v_mfma_f32_16x16x32_bf16 v[220:223], v[132:135], v[236:239], v[220:223]
ds_read_b64_tr_b16 v[234:235], v5 offset:20064
s_waitcnt lgkmcnt(8)
v_mfma_f32_16x16x32_bf16 v[224:227], v[128:131], v[240:243], v[224:227]
ds_read_b64_tr_b16 v[236:237], v5 offset:15488
v_mfma_f32_16x16x32_bf16 v[228:231], v[132:135], v[240:243], v[228:231]
ds_read_b64_tr_b16 v[238:239], v5 offset:20096
s_waitcnt lgkmcnt(8)
v_mfma_f32_16x16x32_bf16 v[160:163], v[136:139], v[244:247], v[160:163]
ds_read_b64_tr_b16 v[240:241], v5 offset:15520
v_mfma_f32_16x16x32_bf16 v[164:167], v[140:143], v[244:247], v[164:167]
ds_read_b64_tr_b16 v[242:243], v5 offset:20128
s_waitcnt lgkmcnt(8)
v_mfma_f32_16x16x32_bf16 v[168:171], v[136:139], v[248:251], v[168:171]
ds_read_b64_tr_b16 v[244:245], v5 offset:15552
v_mfma_f32_16x16x32_bf16 v[172:175], v[140:143], v[248:251], v[172:175]
ds_read_b64_tr_b16 v[246:247], v5 offset:20160
s_waitcnt lgkmcnt(8)
v_mfma_f32_16x16x32_bf16 v[176:179], v[136:139], v[252:255], v[176:179]
ds_read_b64_tr_b16 v[248:249], v5 offset:15584
v_mfma_f32_16x16x32_bf16 v[180:183], v[140:143], v[252:255], v[180:183]
ds_read_b64_tr_b16 v[250:251], v5 offset:20192
s_waitcnt lgkmcnt(8)
v_mfma_f32_16x16x32_bf16 v[184:187], v[136:139], v[232:235], v[184:187]
ds_read_b64_tr_b16 v[252:253], v5 offset:15616
v_mfma_f32_16x16x32_bf16 v[188:191], v[140:143], v[232:235], v[188:191]
ds_read_b64_tr_b16 v[254:255], v5 offset:20224
s_waitcnt lgkmcnt(8)
s_barrier
v_mfma_f32_16x16x32_bf16 v[192:195], v[136:139], v[236:239], v[192:195]
v_add_u32 v8, 0, v10
ds_read_b128 v[144:147], v8 offset:0
ds_read_b128 v[148:151], v8 offset:2048
v_mfma_f32_16x16x32_bf16 v[196:199], v[140:143], v[236:239], v[196:199]
ds_read_b64_tr_b16 v[232:233], v3 offset:16384
ds_read_b64_tr_b16 v[234:235], v3 offset:20992
s_waitcnt lgkmcnt(10)
v_mfma_f32_16x16x32_bf16 v[200:203], v[136:139], v[240:243], v[200:203]
ds_read_b64_tr_b16 v[236:237], v3 offset:16416
v_mfma_f32_16x16x32_bf16 v[204:207], v[140:143], v[240:243], v[204:207]
ds_read_b64_tr_b16 v[238:239], v3 offset:21024
s_waitcnt lgkmcnt(10)
v_mfma_f32_16x16x32_bf16 v[208:211], v[136:139], v[244:247], v[208:211]
ds_read_b64_tr_b16 v[240:241], v3 offset:16448
v_mfma_f32_16x16x32_bf16 v[212:215], v[140:143], v[244:247], v[212:215]
ds_read_b64_tr_b16 v[242:243], v3 offset:21056
s_waitcnt lgkmcnt(10)
v_mfma_f32_16x16x32_bf16 v[216:219], v[136:139], v[248:251], v[216:219]
ds_read_b64_tr_b16 v[244:245], v3 offset:16480
v_mfma_f32_16x16x32_bf16 v[220:223], v[140:143], v[248:251], v[220:223]
Lpad5641:
s_cbranch_execz Lpad5712
ds_read_b64_tr_b16 v[246:247], v3 offset:21088
s_waitcnt lgkmcnt(10)
v_mfma_f32_16x16x32_bf16 v[224:227], v[136:139], v[252:255], v[224:227]
v_xor_b32 v9, 64, v8
ds_read_b128 v[152:155], v9 offset:0
v_mfma_f32_16x16x32_bf16 v[228:231], v[140:143], v[252:255], v[228:231]
ds_read_b64_tr_b16 v[248:249], v3 offset:16512
ds_read_b64_tr_b16 v[250:251], v3 offset:21120
s_waitcnt lgkmcnt(9)
v_mfma_f32_16x16x32_bf16 v[160:163], v[144:147], v[232:235], v[160:163]
ds_read_b64_tr_b16 v[252:253], v3 offset:16544
v_mfma_f32_16x16x32_bf16 v[164:167], v[148:151], v[232:235], v[164:167]
ds_read_b64_tr_b16 v[254:255], v3 offset:21152
s_waitcnt lgkmcnt(9)
v_mfma_f32_16x16x32_bf16 v[168:171], v[144:147], v[236:239], v[168:171]
ds_read_b128 v[156:159], v9 offset:2048
ds_read_b64_tr_b16 v[232:233], v3 offset:16576
v_mfma_f32_16x16x32_bf16 v[172:175], v[148:151], v[236:239], v[172:175]
ds_read_b64_tr_b16 v[234:235], v3 offset:21184
s_waitcnt lgkmcnt(10)
v_mfma_f32_16x16x32_bf16 v[176:179], v[144:147], v[240:243], v[176:179]
ds_read_b64_tr_b16 v[236:237], v3 offset:16608
v_mfma_f32_16x16x32_bf16 v[180:183], v[148:151], v[240:243], v[180:183]
ds_read_b64_tr_b16 v[238:239], v3 offset:21216
s_waitcnt lgkmcnt(10)
v_mfma_f32_16x16x32_bf16 v[184:187], v[144:147], v[244:247], v[184:187]
ds_read_b64_tr_b16 v[240:241], v3 offset:16640
v_mfma_f32_16x16x32_bf16 v[188:191], v[148:151], v[244:247], v[188:191]
ds_read_b64_tr_b16 v[242:243], v3 offset:21248
s_waitcnt lgkmcnt(9)
v_mfma_f32_16x16x32_bf16 v[192:195], v[144:147], v[248:251], v[192:195]
ds_read_b64_tr_b16 v[244:245], v3 offset:25600
v_mfma_f32_16x16x32_bf16 v[196:199], v[148:151], v[248:251], v[196:199]
ds_read_b64_tr_b16 v[246:247], v3 offset:30208
s_waitcnt lgkmcnt(9)
v_mfma_f32_16x16x32_bf16 v[200:203], v[144:147], v[252:255], v[200:203]
ds_read_b64_tr_b16 v[248:249], v3 offset:25632
v_mfma_f32_16x16x32_bf16 v[204:207], v[148:151], v[252:255], v[204:207]
ds_read_b64_tr_b16 v[250:251], v3 offset:30240
s_waitcnt lgkmcnt(8)
v_mfma_f32_16x16x32_bf16 v[208:211], v[144:147], v[232:235], v[208:211]
ds_read_b64_tr_b16 v[252:253], v3 offset:25664
v_mfma_f32_16x16x32_bf16 v[212:215], v[148:151], v[232:235], v[212:215]
ds_read_b64_tr_b16 v[254:255], v3 offset:30272
s_waitcnt lgkmcnt(8)
v_mfma_f32_16x16x32_bf16 v[216:219], v[144:147], v[236:239], v[216:219]
ds_read_b64_tr_b16 v[232:233], v3 offset:25696
v_mfma_f32_16x16x32_bf16 v[220:223], v[148:151], v[236:239], v[220:223]
ds_read_b64_tr_b16 v[234:235], v3 offset:30304
s_waitcnt lgkmcnt(8)
v_mfma_f32_16x16x32_bf16 v[224:227], v[144:147], v[240:243], v[224:227]
ds_read_b64_tr_b16 v[236:237], v3 offset:25728
v_mfma_f32_16x16x32_bf16 v[228:231], v[148:151], v[240:243], v[228:231]
ds_read_b64_tr_b16 v[238:239], v3 offset:30336
s_waitcnt lgkmcnt(8)
v_mfma_f32_16x16x32_bf16 v[160:163], v[152:155], v[244:247], v[160:163]
ds_read_b64_tr_b16 v[240:241], v3 offset:25760
v_mfma_f32_16x16x32_bf16 v[164:167], v[156:159], v[244:247], v[164:167]
ds_read_b64_tr_b16 v[242:243], v3 offset:30368
s_waitcnt lgkmcnt(8)
v_mfma_f32_16x16x32_bf16 v[168:171], v[152:155], v[248:251], v[168:171]
ds_read_b64_tr_b16 v[244:245], v3 offset:25792
v_mfma_f32_16x16x32_bf16 v[172:175], v[156:159], v[248:251], v[172:175]
ds_read_b64_tr_b16 v[246:247], v3 offset:30400
s_waitcnt lgkmcnt(8)
v_mfma_f32_16x16x32_bf16 v[176:179], v[152:155], v[252:255], v[176:179]
ds_read_b64_tr_b16 v[248:249], v3 offset:25824
v_mfma_f32_16x16x32_bf16 v[180:183], v[156:159], v[252:255], v[180:183]
ds_read_b64_tr_b16 v[250:251], v3 offset:30432
s_waitcnt lgkmcnt(8)
v_mfma_f32_16x16x32_bf16 v[184:187], v[152:155], v[232:235], v[184:187]
Lpad5712:
s_cbranch_execz Lpad5791
ds_read_b64_tr_b16 v[252:253], v3 offset:25856
v_mfma_f32_16x16x32_bf16 v[188:191], v[156:159], v[232:235], v[188:191]
ds_read_b64_tr_b16 v[254:255], v3 offset:30464
s_waitcnt lgkmcnt(8)
s_barrier
v_mfma_f32_16x16x32_bf16 v[192:195], v[152:155], v[236:239], v[192:195]
v_and_b32 v5, 15, v2
v_lshlrev_b32 v5, 3, v5
v_add_u32 v5, 150528, v5
v_lshlrev_b32 v10, 4, v2
v_add_u32 v10, s68, v10
v_lshlrev_b32 v11, 3, v2
v_mfma_f32_16x16x32_bf16 v[196:199], v[156:159], v[236:239], v[196:199]
v_add_u32 v11, s68, v11
ds_read_b128 v[12:15], v10
ds_read_b64 v[8:9], v11 offset:1024
v_mov_b32 v10, 0
v_mov_b32 v11, 0
ds_read2_b64 v[232:235], v5 offset0:0 offset1:0
s_waitcnt lgkmcnt(9)
v_mfma_f32_16x16x32_bf16 v[200:203], v[152:155], v[240:243], v[200:203]
ds_read2_b64 v[236:239], v5 offset0:16 offset1:16
v_mfma_f32_16x16x32_bf16 v[204:207], v[156:159], v[240:243], v[204:207]
s_waitcnt lgkmcnt(8)
v_mfma_f32_16x16x32_bf16 v[208:211], v[152:155], v[244:247], v[208:211]
ds_read2_b64 v[240:243], v5 offset0:32 offset1:32
v_mfma_f32_16x16x32_bf16 v[212:215], v[156:159], v[244:247], v[212:215]
s_waitcnt lgkmcnt(7)
v_mfma_f32_16x16x32_bf16 v[216:219], v[152:155], v[248:251], v[216:219]
ds_read2_b64 v[244:247], v5 offset0:48 offset1:48
v_mfma_f32_16x16x32_bf16 v[220:223], v[156:159], v[248:251], v[220:223]
s_waitcnt lgkmcnt(6)
v_mfma_f32_16x16x32_bf16 v[224:227], v[152:155], v[252:255], v[224:227]
ds_read2_b64 v[248:251], v5 offset0:64 offset1:64
v_mfma_f32_16x16x32_bf16 v[228:231], v[156:159], v[252:255], v[228:231]
s_waitcnt lgkmcnt(4)
v_mfma_f32_16x16x32_bf16 v[160:163], v[8:11], v[232:235], v[160:163]
ds_read2_b64 v[252:255], v5 offset0:80 offset1:80
v_mfma_f32_16x16x32_bf16 v[164:167], v[10:13], v[232:235], v[164:167]
s_waitcnt lgkmcnt(4)
v_mfma_f32_16x16x32_bf16 v[168:171], v[8:11], v[236:239], v[168:171]
ds_read2_b64 v[232:235], v5 offset0:96 offset1:96
v_mfma_f32_16x16x32_bf16 v[172:175], v[10:13], v[236:239], v[172:175]
s_waitcnt lgkmcnt(4)
v_mfma_f32_16x16x32_bf16 v[176:179], v[8:11], v[240:243], v[176:179]
ds_read2_b64 v[236:239], v5 offset0:112 offset1:112
v_mfma_f32_16x16x32_bf16 v[180:183], v[10:13], v[240:243], v[180:183]
s_waitcnt lgkmcnt(4)
v_mfma_f32_16x16x32_bf16 v[184:187], v[8:11], v[244:247], v[184:187]
ds_read2_b64 v[240:243], v5 offset0:128 offset1:128
v_mfma_f32_16x16x32_bf16 v[188:191], v[10:13], v[244:247], v[188:191]
s_waitcnt lgkmcnt(4)
v_mfma_f32_16x16x32_bf16 v[192:195], v[8:11], v[248:251], v[192:195]
v_mfma_f32_16x16x32_bf16 v[196:199], v[10:13], v[248:251], v[196:199]
s_waitcnt lgkmcnt(3)
v_mfma_f32_16x16x32_bf16 v[200:203], v[8:11], v[252:255], v[200:203]
v_mfma_f32_16x16x32_bf16 v[204:207], v[10:13], v[252:255], v[204:207]
s_waitcnt lgkmcnt(2)
v_mfma_f32_16x16x32_bf16 v[208:211], v[8:11], v[232:235], v[208:211]
v_mfma_f32_16x16x32_bf16 v[212:215], v[10:13], v[232:235], v[212:215]
s_waitcnt lgkmcnt(1)
v_mfma_f32_16x16x32_bf16 v[216:219], v[8:11], v[236:239], v[216:219]
v_mfma_f32_16x16x32_bf16 v[220:223], v[10:13], v[236:239], v[220:223]
s_waitcnt lgkmcnt(0)
v_mfma_f32_16x16x32_bf16 v[224:227], v[8:11], v[240:243], v[224:227]
v_mfma_f32_16x16x32_bf16 v[228:231], v[10:13], v[240:243], v[228:231]
s_barrier
L_gz:
v_lshrrev_b32 v8, 4, v2
v_lshlrev_b32 v8, 4, v8
v_add_u32 v8, s68, v8
ds_read_b128 v[232:235], v8 offset:1536
ds_read_b128 v[236:239], v8 offset:1600
v_mov_b32 v10, 0xc0135761
s_waitcnt lgkmcnt(0)
v_pk_mul_f32 v[160:161], v[160:161], v[232:233]
v_pk_mul_f32 v[8:9], v[160:161], v[160:161]
v_pk_fma_f32 v[8:9], v[8:9], s[72:73], v[10:11] op_sel_hi:[1,1,0]
v_pk_mul_f32 v[8:9], v[8:9], v[160:161]
Lpad5791:
s_cbranch_execz Lback4
v_exp_f32 v8, v8
v_pk_mul_f32 v[162:163], v[162:163], v[234:235]
v_exp_f32 v9, v9
v_pk_mul_f32 v[12:13], v[162:163], v[162:163]
v_pk_fma_f32 v[12:13], v[12:13], s[72:73], v[10:11] op_sel_hi:[1,1,0]
v_pk_add_f32 v[8:9], v[8:9], 1.0 op_sel_hi:[1,0]
v_pk_mul_f32 v[12:13], v[12:13], v[162:163]
v_exp_f32 v12, v12
v_pk_mul_f32 v[164:165], v[164:165], v[236:237]
v_exp_f32 v13, v13
v_pk_mul_f32 v[14:15], v[164:165], v[164:165]
v_rcp_f32 v8, v8
v_pk_fma_f32 v[14:15], v[14:15], s[72:73], v[10:11] op_sel_hi:[1,1,0]
v_rcp_f32 v9, v9
v_pk_add_f32 v[12:13], v[12:13], 1.0 op_sel_hi:[1,0]
v_pk_mul_f32 v[14:15], v[14:15], v[164:165]
v_pk_mul_f32 v[160:161], v[160:161], v[8:9]
v_exp_f32 v14, v14
v_pk_mul_f32 v[166:167], v[166:167], v[238:239]
v_pk_mul_f32 v[248:249], v[160:161], v[160:161]
v_exp_f32 v15, v15
v_pk_mul_f32 v[8:9], v[166:167], v[166:167]
v_pk_mov_b32 v[240:241], v[160:161], v[160:161] op_sel:[0,1]
v_rcp_f32 v12, v12
v_pk_fma_f32 v[8:9], v[8:9], s[72:73], v[10:11] op_sel_hi:[1,1,0]
v_cvt_pk_bf16_f32 v160, v160, v161
v_rcp_f32 v13, v13
v_pk_add_f32 v[14:15], v[14:15], 1.0 op_sel_hi:[1,0]
v_pk_mul_f32 v[8:9], v[8:9], v[166:167]
v_pk_mul_f32 v[162:163], v[162:163], v[12:13]
v_exp_f32 v8, v8
v_pk_mul_f32 v[168:169], v[168:169], v[232:233]
v_pk_mul_f32 v[250:251], v[162:163], v[162:163]
v_exp_f32 v9, v9
v_pk_mul_f32 v[12:13], v[168:169], v[168:169]
v_pk_mov_b32 v[242:243], v[162:163], v[162:163] op_sel:[0,1]
v_rcp_f32 v14, v14
v_pk_fma_f32 v[12:13], v[12:13], s[72:73], v[10:11] op_sel_hi:[1,1,0]
v_cvt_pk_bf16_f32 v161, v162, v163
v_rcp_f32 v15, v15
v_pk_add_f32 v[8:9], v[8:9], 1.0 op_sel_hi:[1,0]
v_pk_mul_f32 v[12:13], v[12:13], v[168:169]
v_pk_mul_f32 v[164:165], v[164:165], v[14:15]
v_exp_f32 v12, v12
v_pk_mul_f32 v[170:171], v[170:171], v[234:235]
v_pk_mul_f32 v[252:253], v[164:165], v[164:165]
v_exp_f32 v13, v13
v_pk_mul_f32 v[14:15], v[170:171], v[170:171]
v_pk_mov_b32 v[244:245], v[164:165], v[164:165] op_sel:[0,1]
v_rcp_f32 v8, v8
v_pk_fma_f32 v[14:15], v[14:15], s[72:73], v[10:11] op_sel_hi:[1,1,0]
v_cvt_pk_bf16_f32 v162, v164, v165
v_rcp_f32 v9, v9
v_pk_add_f32 v[12:13], v[12:13], 1.0 op_sel_hi:[1,0]
v_pk_mul_f32 v[14:15], v[14:15], v[170:171]
v_pk_mul_f32 v[166:167], v[166:167], v[8:9]
v_exp_f32 v14, v14
v_pk_mul_f32 v[172:173], v[172:173], v[236:237]
v_pk_mul_f32 v[254:255], v[166:167], v[166:167]
v_exp_f32 v15, v15
v_pk_mul_f32 v[8:9], v[172:173], v[172:173]
v_pk_mov_b32 v[246:247], v[166:167], v[166:167] op_sel:[0,1]
v_rcp_f32 v12, v12
v_pk_fma_f32 v[8:9], v[8:9], s[72:73], v[10:11] op_sel_hi:[1,1,0]
v_cvt_pk_bf16_f32 v163, v166, v167
v_rcp_f32 v13, v13
v_pk_add_f32 v[14:15], v[14:15], 1.0 op_sel_hi:[1,0]
v_pk_mul_f32 v[8:9], v[8:9], v[172:173]
ds_write_b128 v0, v[160:163] offset:0
v_pk_mul_f32 v[168:169], v[168:169], v[12:13]
v_exp_f32 v8, v8
v_pk_mul_f32 v[174:175], v[174:175], v[238:239]
v_pk_fma_f32 v[248:249], v[168:169], v[168:169], v[248:249]
v_exp_f32 v9, v9
v_pk_mul_f32 v[12:13], v[174:175], v[174:175]
Lpad5866:
s_cbranch_execz Lpad5941
v_pk_add_f32 v[240:241], v[240:241], v[168:169]
v_rcp_f32 v14, v14
v_pk_fma_f32 v[12:13], v[12:13], s[72:73], v[10:11] op_sel_hi:[1,1,0]
v_cvt_pk_bf16_f32 v168, v168, v169
v_rcp_f32 v15, v15
v_pk_add_f32 v[8:9], v[8:9], 1.0 op_sel_hi:[1,0]
v_pk_mul_f32 v[12:13], v[12:13], v[174:175]
v_pk_mul_f32 v[170:171], v[170:171], v[14:15]
v_exp_f32 v12, v12
v_pk_mul_f32 v[176:177], v[176:177], v[232:233]
v_pk_fma_f32 v[250:251], v[170:171], v[170:171], v[250:251]
v_exp_f32 v13, v13
v_pk_mul_f32 v[14:15], v[176:177], v[176:177]
v_pk_add_f32 v[242:243], v[242:243], v[170:171]
v_rcp_f32 v8, v8
v_pk_fma_f32 v[14:15], v[14:15], s[72:73], v[10:11] op_sel_hi:[1,1,0]
v_cvt_pk_bf16_f32 v169, v170, v171
v_rcp_f32 v9, v9
v_pk_add_f32 v[12:13], v[12:13], 1.0 op_sel_hi:[1,0]
v_pk_mul_f32 v[14:15], v[14:15], v[176:177]
v_pk_mul_f32 v[172:173], v[172:173], v[8:9]
v_exp_f32 v14, v14
v_pk_mul_f32 v[178:179], v[178:179], v[234:235]
v_pk_fma_f32 v[252:253], v[172:173], v[172:173], v[252:253]
v_exp_f32 v15, v15
v_pk_mul_f32 v[8:9], v[178:179], v[178:179]
v_pk_add_f32 v[244:245], v[244:245], v[172:173]
v_rcp_f32 v12, v12
v_pk_fma_f32 v[8:9], v[8:9], s[72:73], v[10:11] op_sel_hi:[1,1,0]
v_cvt_pk_bf16_f32 v170, v172, v173
v_rcp_f32 v13, v13
v_pk_add_f32 v[14:15], v[14:15], 1.0 op_sel_hi:[1,0]
v_pk_mul_f32 v[8:9], v[8:9], v[178:179]
v_pk_mul_f32 v[174:175], v[174:175], v[12:13]
v_exp_f32 v8, v8
v_pk_mul_f32 v[180:181], v[180:181], v[236:237]
v_pk_fma_f32 v[254:255], v[174:175], v[174:175], v[254:255]
v_exp_f32 v9, v9
v_pk_mul_f32 v[12:13], v[180:181], v[180:181]
v_pk_add_f32 v[246:247], v[246:247], v[174:175]
v_rcp_f32 v14, v14
v_pk_fma_f32 v[12:13], v[12:13], s[72:73], v[10:11] op_sel_hi:[1,1,0]
v_cvt_pk_bf16_f32 v171, v174, v175
v_rcp_f32 v15, v15
v_pk_add_f32 v[8:9], v[8:9], 1.0 op_sel_hi:[1,0]
v_pk_mul_f32 v[12:13], v[12:13], v[180:181]
ds_write_b128 v0, v[168:171] offset:1024
v_pk_mul_f32 v[176:177], v[176:177], v[14:15]
v_exp_f32 v12, v12
v_pk_mul_f32 v[182:183], v[182:183], v[238:239]
v_pk_fma_f32 v[248:249], v[176:177], v[176:177], v[248:249]
v_exp_f32 v13, v13
v_pk_mul_f32 v[14:15], v[182:183], v[182:183]
v_pk_add_f32 v[240:241], v[240:241], v[176:177]
v_rcp_f32 v8, v8
v_pk_fma_f32 v[14:15], v[14:15], s[72:73], v[10:11] op_sel_hi:[1,1,0]
v_cvt_pk_bf16_f32 v176, v176, v177
v_rcp_f32 v9, v9
v_pk_add_f32 v[12:13], v[12:13], 1.0 op_sel_hi:[1,0]
v_pk_mul_f32 v[14:15], v[14:15], v[182:183]
v_pk_mul_f32 v[178:179], v[178:179], v[8:9]
v_exp_f32 v14, v14
v_pk_mul_f32 v[184:185], v[184:185], v[232:233]
v_pk_fma_f32 v[250:251], v[178:179], v[178:179], v[250:251]
v_exp_f32 v15, v15
v_pk_mul_f32 v[8:9], v[184:185], v[184:185]
v_pk_add_f32 v[242:243], v[242:243], v[178:179]
v_rcp_f32 v12, v12
v_pk_fma_f32 v[8:9], v[8:9], s[72:73], v[10:11] op_sel_hi:[1,1,0]
v_cvt_pk_bf16_f32 v177, v178, v179
v_rcp_f32 v13, v13
v_pk_add_f32 v[14:15], v[14:15], 1.0 op_sel_hi:[1,0]
v_pk_mul_f32 v[8:9], v[8:9], v[184:185]
v_pk_mul_f32 v[180:181], v[180:181], v[12:13]
v_exp_f32 v8, v8
Lpad5941:
s_cbranch_execz Lpad6016
v_pk_mul_f32 v[186:187], v[186:187], v[234:235]
v_pk_fma_f32 v[252:253], v[180:181], v[180:181], v[252:253]
v_exp_f32 v9, v9
v_pk_mul_f32 v[12:13], v[186:187], v[186:187]
v_pk_add_f32 v[244:245], v[244:245], v[180:181]
v_rcp_f32 v14, v14
v_pk_fma_f32 v[12:13], v[12:13], s[72:73], v[10:11] op_sel_hi:[1,1,0]
v_cvt_pk_bf16_f32 v178, v180, v181
v_rcp_f32 v15, v15
v_pk_add_f32 v[8:9], v[8:9], 1.0 op_sel_hi:[1,0]
v_pk_mul_f32 v[12:13], v[12:13], v[186:187]
v_pk_mul_f32 v[182:183], v[182:183], v[14:15]
v_exp_f32 v12, v12
v_pk_mul_f32 v[188:189], v[188:189], v[236:237]
v_pk_fma_f32 v[254:255], v[182:183], v[182:183], v[254:255]
v_exp_f32 v13, v13
v_pk_mul_f32 v[14:15], v[188:189], v[188:189]
v_pk_add_f32 v[246:247], v[246:247], v[182:183]
v_rcp_f32 v8, v8
v_pk_fma_f32 v[14:15], v[14:15], s[72:73], v[10:11] op_sel_hi:[1,1,0]
v_cvt_pk_bf16_f32 v179, v182, v183
v_rcp_f32 v9, v9
v_pk_add_f32 v[12:13], v[12:13], 1.0 op_sel_hi:[1,0]
v_pk_mul_f32 v[14:15], v[14:15], v[188:189]
ds_write_b128 v0, v[176:179] offset:2048
v_pk_mul_f32 v[184:185], v[184:185], v[8:9]
v_exp_f32 v14, v14
v_pk_mul_f32 v[190:191], v[190:191], v[238:239]
v_pk_fma_f32 v[248:249], v[184:185], v[184:185], v[248:249]
v_exp_f32 v15, v15
v_pk_mul_f32 v[8:9], v[190:191], v[190:191]
v_pk_add_f32 v[240:241], v[240:241], v[184:185]
v_rcp_f32 v12, v12
v_pk_fma_f32 v[8:9], v[8:9], s[72:73], v[10:11] op_sel_hi:[1,1,0]
v_cvt_pk_bf16_f32 v184, v184, v185
v_rcp_f32 v13, v13
v_pk_add_f32 v[14:15], v[14:15], 1.0 op_sel_hi:[1,0]
v_pk_mul_f32 v[8:9], v[8:9], v[190:191]
v_pk_mul_f32 v[186:187], v[186:187], v[12:13]
v_exp_f32 v8, v8
v_pk_mul_f32 v[192:193], v[192:193], v[232:233]
v_pk_fma_f32 v[250:251], v[186:187], v[186:187], v[250:251]
v_exp_f32 v9, v9
v_pk_mul_f32 v[12:13], v[192:193], v[192:193]
v_pk_add_f32 v[242:243], v[242:243], v[186:187]
v_rcp_f32 v14, v14
v_pk_fma_f32 v[12:13], v[12:13], s[72:73], v[10:11] op_sel_hi:[1,1,0]
v_cvt_pk_bf16_f32 v185, v186, v187
v_rcp_f32 v15, v15
v_pk_add_f32 v[8:9], v[8:9], 1.0 op_sel_hi:[1,0]
v_pk_mul_f32 v[12:13], v[12:13], v[192:193]
v_pk_mul_f32 v[188:189], v[188:189], v[14:15]
v_exp_f32 v12, v12
v_pk_mul_f32 v[194:195], v[194:195], v[234:235]
v_pk_fma_f32 v[252:253], v[188:189], v[188:189], v[252:253]
v_exp_f32 v13, v13
v_pk_mul_f32 v[14:15], v[194:195], v[194:195]
v_pk_add_f32 v[244:245], v[244:245], v[188:189]
v_rcp_f32 v8, v8
v_pk_fma_f32 v[14:15], v[14:15], s[72:73], v[10:11] op_sel_hi:[1,1,0]
v_cvt_pk_bf16_f32 v186, v188, v189
v_rcp_f32 v9, v9
v_pk_add_f32 v[12:13], v[12:13], 1.0 op_sel_hi:[1,0]
v_pk_mul_f32 v[14:15], v[14:15], v[194:195]
v_pk_mul_f32 v[190:191], v[190:191], v[8:9]
v_exp_f32 v14, v14
v_pk_mul_f32 v[196:197], v[196:197], v[236:237]
v_pk_fma_f32 v[254:255], v[190:191], v[190:191], v[254:255]
v_exp_f32 v15, v15
v_pk_mul_f32 v[8:9], v[196:197], v[196:197]
v_pk_add_f32 v[246:247], v[246:247], v[190:191]
v_rcp_f32 v12, v12
v_pk_fma_f32 v[8:9], v[8:9], s[72:73], v[10:11] op_sel_hi:[1,1,0]
v_cvt_pk_bf16_f32 v187, v190, v191
v_rcp_f32 v13, v13
Lpad6016:
s_cbranch_execz Lpad6091
v_pk_add_f32 v[14:15], v[14:15], 1.0 op_sel_hi:[1,0]
v_pk_mul_f32 v[8:9], v[8:9], v[196:197]
ds_write_b128 v0, v[184:187] offset:3072
v_pk_mul_f32 v[192:193], v[192:193], v[12:13]
v_exp_f32 v8, v8
v_pk_mul_f32 v[198:199], v[198:199], v[238:239]
v_pk_fma_f32 v[248:249], v[192:193], v[192:193], v[248:249]
v_exp_f32 v9, v9
v_pk_mul_f32 v[12:13], v[198:199], v[198:199]
v_pk_add_f32 v[240:241], v[240:241], v[192:193]
v_rcp_f32 v14, v14
v_pk_fma_f32 v[12:13], v[12:13], s[72:73], v[10:11] op_sel_hi:[1,1,0]
v_cvt_pk_bf16_f32 v192, v192, v193
v_rcp_f32 v15, v15
v_pk_add_f32 v[8:9], v[8:9], 1.0 op_sel_hi:[1,0]
v_pk_mul_f32 v[12:13], v[12:13], v[198:199]
v_pk_mul_f32 v[194:195], v[194:195], v[14:15]
v_exp_f32 v12, v12
v_pk_mul_f32 v[200:201], v[200:201], v[232:233]
v_pk_fma_f32 v[250:251], v[194:195], v[194:195], v[250:251]
v_exp_f32 v13, v13
v_pk_mul_f32 v[14:15], v[200:201], v[200:201]
v_pk_add_f32 v[242:243], v[242:243], v[194:195]
v_rcp_f32 v8, v8
v_pk_fma_f32 v[14:15], v[14:15], s[72:73], v[10:11] op_sel_hi:[1,1,0]
v_cvt_pk_bf16_f32 v193, v194, v195
v_rcp_f32 v9, v9
v_pk_add_f32 v[12:13], v[12:13], 1.0 op_sel_hi:[1,0]
v_pk_mul_f32 v[14:15], v[14:15], v[200:201]
v_pk_mul_f32 v[196:197], v[196:197], v[8:9]
v_exp_f32 v14, v14
v_pk_mul_f32 v[202:203], v[202:203], v[234:235]
v_pk_fma_f32 v[252:253], v[196:197], v[196:197], v[252:253]
v_exp_f32 v15, v15
v_pk_mul_f32 v[8:9], v[202:203], v[202:203]
v_pk_add_f32 v[244:245], v[244:245], v[196:197]
v_rcp_f32 v12, v12
v_pk_fma_f32 v[8:9], v[8:9], s[72:73], v[10:11] op_sel_hi:[1,1,0]
v_cvt_pk_bf16_f32 v194, v196, v197
v_rcp_f32 v13, v13
v_pk_add_f32 v[14:15], v[14:15], 1.0 op_sel_hi:[1,0]
v_pk_mul_f32 v[8:9], v[8:9], v[202:203]
v_pk_mul_f32 v[198:199], v[198:199], v[12:13]
v_exp_f32 v8, v8
v_pk_mul_f32 v[204:205], v[204:205], v[236:237]
v_pk_fma_f32 v[254:255], v[198:199], v[198:199], v[254:255]
v_exp_f32 v9, v9
v_pk_mul_f32 v[12:13], v[204:205], v[204:205]
v_pk_add_f32 v[246:247], v[246:247], v[198:199]
v_rcp_f32 v14, v14
v_pk_fma_f32 v[12:13], v[12:13], s[72:73], v[10:11] op_sel_hi:[1,1,0]
v_cvt_pk_bf16_f32 v195, v198, v199
v_rcp_f32 v15, v15
v_pk_add_f32 v[8:9], v[8:9], 1.0 op_sel_hi:[1,0]
v_pk_mul_f32 v[12:13], v[12:13], v[204:205]
ds_write_b128 v0, v[192:195] offset:4096
v_pk_mul_f32 v[200:201], v[200:201], v[14:15]
v_exp_f32 v12, v12
v_pk_mul_f32 v[206:207], v[206:207], v[238:239]
v_pk_fma_f32 v[248:249], v[200:201], v[200:201], v[248:249]
v_exp_f32 v13, v13
v_pk_mul_f32 v[14:15], v[206:207], v[206:207]
v_pk_add_f32 v[240:241], v[240:241], v[200:201]
v_rcp_f32 v8, v8
v_pk_fma_f32 v[14:15], v[14:15], s[72:73], v[10:11] op_sel_hi:[1,1,0]
v_cvt_pk_bf16_f32 v200, v200, v201
v_rcp_f32 v9, v9
v_pk_add_f32 v[12:13], v[12:13], 1.0 op_sel_hi:[1,0]
v_pk_mul_f32 v[14:15], v[14:15], v[206:207]
v_pk_mul_f32 v[202:203], v[202:203], v[8:9]
v_exp_f32 v14, v14
v_pk_mul_f32 v[208:209], v[208:209], v[232:233]
v_pk_fma_f32 v[250:251], v[202:203], v[202:203], v[250:251]
v_exp_f32 v15, v15
v_pk_mul_f32 v[8:9], v[208:209], v[208:209]
Lpad6091:
s_cbranch_execz Lback4
v_pk_add_f32 v[242:243], v[242:243], v[202:203]
v_rcp_f32 v12, v12
v_pk_fma_f32 v[8:9], v[8:9], s[72:73], v[10:11] op_sel_hi:[1,1,0]
v_cvt_pk_bf16_f32 v201, v202, v203
v_rcp_f32 v13, v13
v_pk_add_f32 v[14:15], v[14:15], 1.0 op_sel_hi:[1,0]
v_pk_mul_f32 v[8:9], v[8:9], v[208:209]
v_pk_mul_f32 v[204:205], v[204:205], v[12:13]
v_exp_f32 v8, v8
v_pk_mul_f32 v[210:211], v[210:211], v[234:235]
v_pk_fma_f32 v[252:253], v[204:205], v[204:205], v[252:253]
v_exp_f32 v9, v9
v_pk_mul_f32 v[12:13], v[210:211], v[210:211]
v_pk_add_f32 v[244:245], v[244:245], v[204:205]
v_rcp_f32 v14, v14
v_pk_fma_f32 v[12:13], v[12:13], s[72:73], v[10:11] op_sel_hi:[1,1,0]
v_cvt_pk_bf16_f32 v202, v204, v205
v_rcp_f32 v15, v15
v_pk_add_f32 v[8:9], v[8:9], 1.0 op_sel_hi:[1,0]
v_pk_mul_f32 v[12:13], v[12:13], v[210:211]
v_pk_mul_f32 v[206:207], v[206:207], v[14:15]
v_exp_f32 v12, v12
v_pk_mul_f32 v[212:213], v[212:213], v[236:237]
v_pk_fma_f32 v[254:255], v[206:207], v[206:207], v[254:255]
v_exp_f32 v13, v13
v_pk_mul_f32 v[14:15], v[212:213], v[212:213]
v_pk_add_f32 v[246:247], v[246:247], v[206:207]
v_rcp_f32 v8, v8
v_pk_fma_f32 v[14:15], v[14:15], s[72:73], v[10:11] op_sel_hi:[1,1,0]
v_cvt_pk_bf16_f32 v203, v206, v207
v_rcp_f32 v9, v9
v_pk_add_f32 v[12:13], v[12:13], 1.0 op_sel_hi:[1,0]
v_pk_mul_f32 v[14:15], v[14:15], v[212:213]
ds_write_b128 v0, v[200:203] offset:5120
v_pk_mul_f32 v[208:209], v[208:209], v[8:9]
v_exp_f32 v14, v14
v_pk_mul_f32 v[214:215], v[214:215], v[238:239]
v_pk_fma_f32 v[248:249], v[208:209], v[208:209], v[248:249]
v_exp_f32 v15, v15
v_pk_mul_f32 v[8:9], v[214:215], v[214:215]
v_pk_add_f32 v[240:241], v[240:241], v[208:209]
v_rcp_f32 v12, v12
v_pk_fma_f32 v[8:9], v[8:9], s[72:73], v[10:11] op_sel_hi:[1,1,0]
v_cvt_pk_bf16_f32 v208, v208, v209
v_rcp_f32 v13, v13
v_pk_add_f32 v[14:15], v[14:15], 1.0 op_sel_hi:[1,0]
v_pk_mul_f32 v[8:9], v[8:9], v[214:215]
v_pk_mul_f32 v[210:211], v[210:211], v[12:13]
v_exp_f32 v8, v8
v_pk_mul_f32 v[216:217], v[216:217], v[232:233]
v_pk_fma_f32 v[250:251], v[210:211], v[210:211], v[250:251]
v_exp_f32 v9, v9
v_pk_mul_f32 v[12:13], v[216:217], v[216:217]
v_pk_add_f32 v[242:243], v[242:243], v[210:211]
v_rcp_f32 v14, v14
v_pk_fma_f32 v[12:13], v[12:13], s[72:73], v[10:11] op_sel_hi:[1,1,0]
v_cvt_pk_bf16_f32 v209, v210, v211
v_rcp_f32 v15, v15
v_pk_add_f32 v[8:9], v[8:9], 1.0 op_sel_hi:[1,0]
v_pk_mul_f32 v[12:13], v[12:13], v[216:217]
v_pk_mul_f32 v[212:213], v[212:213], v[14:15]
v_exp_f32 v12, v12
v_pk_mul_f32 v[218:219], v[218:219], v[234:235]
v_pk_fma_f32 v[252:253], v[212:213], v[212:213], v[252:253]
v_exp_f32 v13, v13
v_pk_mul_f32 v[14:15], v[218:219], v[218:219]
v_pk_add_f32 v[244:245], v[244:245], v[212:213]
v_rcp_f32 v8, v8
v_pk_fma_f32 v[14:15], v[14:15], s[72:73], v[10:11] op_sel_hi:[1,1,0]
v_cvt_pk_bf16_f32 v210, v212, v213
v_rcp_f32 v9, v9
v_pk_add_f32 v[12:13], v[12:13], 1.0 op_sel_hi:[1,0]
v_pk_mul_f32 v[14:15], v[14:15], v[218:219]
v_pk_mul_f32 v[214:215], v[214:215], v[8:9]
Lpad6165:
s_cbranch_execz Lpad6240
v_exp_f32 v14, v14
v_pk_mul_f32 v[220:221], v[220:221], v[236:237]
v_pk_fma_f32 v[254:255], v[214:215], v[214:215], v[254:255]
v_exp_f32 v15, v15
v_pk_mul_f32 v[8:9], v[220:221], v[220:221]
v_pk_add_f32 v[246:247], v[246:247], v[214:215]
v_rcp_f32 v12, v12
v_pk_fma_f32 v[8:9], v[8:9], s[72:73], v[10:11] op_sel_hi:[1,1,0]
v_cvt_pk_bf16_f32 v211, v214, v215
v_rcp_f32 v13, v13
v_pk_add_f32 v[14:15], v[14:15], 1.0 op_sel_hi:[1,0]
v_pk_mul_f32 v[8:9], v[8:9], v[220:221]
ds_write_b128 v0, v[208:211] offset:6144
v_pk_mul_f32 v[216:217], v[216:217], v[12:13]
v_exp_f32 v8, v8
v_pk_mul_f32 v[222:223], v[222:223], v[238:239]
v_pk_fma_f32 v[248:249], v[216:217], v[216:217], v[248:249]
v_exp_f32 v9, v9
v_pk_mul_f32 v[12:13], v[222:223], v[222:223]
v_pk_add_f32 v[240:241], v[240:241], v[216:217]
v_rcp_f32 v14, v14
v_pk_fma_f32 v[12:13], v[12:13], s[72:73], v[10:11] op_sel_hi:[1,1,0]
v_cvt_pk_bf16_f32 v216, v216, v217
v_rcp_f32 v15, v15
v_pk_add_f32 v[8:9], v[8:9], 1.0 op_sel_hi:[1,0]
v_pk_mul_f32 v[12:13], v[12:13], v[222:223]
v_pk_mul_f32 v[218:219], v[218:219], v[14:15]
v_exp_f32 v12, v12
v_pk_mul_f32 v[224:225], v[224:225], v[232:233]
v_pk_fma_f32 v[250:251], v[218:219], v[218:219], v[250:251]
v_exp_f32 v13, v13
v_pk_mul_f32 v[14:15], v[224:225], v[224:225]
v_pk_add_f32 v[242:243], v[242:243], v[218:219]
v_rcp_f32 v8, v8
v_pk_fma_f32 v[14:15], v[14:15], s[72:73], v[10:11] op_sel_hi:[1,1,0]
v_cvt_pk_bf16_f32 v217, v218, v219
v_rcp_f32 v9, v9
v_pk_add_f32 v[12:13], v[12:13], 1.0 op_sel_hi:[1,0]
v_pk_mul_f32 v[14:15], v[14:15], v[224:225]
v_pk_mul_f32 v[220:221], v[220:221], v[8:9]
v_exp_f32 v14, v14
v_pk_mul_f32 v[226:227], v[226:227], v[234:235]
v_pk_fma_f32 v[252:253], v[220:221], v[220:221], v[252:253]
v_exp_f32 v15, v15
v_pk_mul_f32 v[8:9], v[226:227], v[226:227]
v_pk_add_f32 v[244:245], v[244:245], v[220:221]
v_rcp_f32 v12, v12
v_pk_fma_f32 v[8:9], v[8:9], s[72:73], v[10:11] op_sel_hi:[1,1,0]
v_cvt_pk_bf16_f32 v218, v220, v221
v_rcp_f32 v13, v13
v_pk_add_f32 v[14:15], v[14:15], 1.0 op_sel_hi:[1,0]
v_pk_mul_f32 v[8:9], v[8:9], v[226:227]
v_pk_mul_f32 v[222:223], v[222:223], v[12:13]
v_exp_f32 v8, v8
v_pk_mul_f32 v[228:229], v[228:229], v[236:237]
v_pk_fma_f32 v[254:255], v[222:223], v[222:223], v[254:255]
v_exp_f32 v9, v9
v_pk_mul_f32 v[12:13], v[228:229], v[228:229]
v_pk_add_f32 v[246:247], v[246:247], v[222:223]
v_rcp_f32 v14, v14
v_pk_fma_f32 v[12:13], v[12:13], s[72:73], v[10:11] op_sel_hi:[1,1,0]
v_cvt_pk_bf16_f32 v219, v222, v223
v_rcp_f32 v15, v15
v_pk_add_f32 v[8:9], v[8:9], 1.0 op_sel_hi:[1,0]
v_pk_mul_f32 v[12:13], v[12:13], v[228:229]
ds_write_b128 v0, v[216:219] offset:7168
v_pk_mul_f32 v[224:225], v[224:225], v[14:15]
v_exp_f32 v12, v12
v_pk_mul_f32 v[230:231], v[230:231], v[238:239]
v_pk_fma_f32 v[248:249], v[224:225], v[224:225], v[248:249]
v_exp_f32 v13, v13
v_pk_mul_f32 v[14:15], v[230:231], v[230:231]
v_pk_add_f32 v[240:241], v[240:241], v[224:225]
v_rcp_f32 v8, v8
v_pk_fma_f32 v[14:15], v[14:15], s[72:73], v[10:11] op_sel_hi:[1,1,0]
Lpad6240:
s_cbranch_execz Lpad6313
v_cvt_pk_bf16_f32 v224, v224, v225
v_rcp_f32 v9, v9
v_pk_add_f32 v[12:13], v[12:13], 1.0 op_sel_hi:[1,0]
v_pk_mul_f32 v[14:15], v[14:15], v[230:231]
v_pk_mul_f32 v[226:227], v[226:227], v[8:9]
v_exp_f32 v14, v14
v_pk_fma_f32 v[250:251], v[226:227], v[226:227], v[250:251]
v_exp_f32 v15, v15
v_pk_add_f32 v[242:243], v[242:243], v[226:227]
v_rcp_f32 v12, v12
v_cvt_pk_bf16_f32 v225, v226, v227
v_rcp_f32 v13, v13
v_pk_add_f32 v[14:15], v[14:15], 1.0 op_sel_hi:[1,0]
v_pk_mul_f32 v[228:229], v[228:229], v[12:13]
v_pk_fma_f32 v[252:253], v[228:229], v[228:229], v[252:253]
v_pk_add_f32 v[244:245], v[244:245], v[228:229]
v_rcp_f32 v14, v14
v_cvt_pk_bf16_f32 v226, v228, v229
v_rcp_f32 v15, v15
s_nop 0
v_pk_mul_f32 v[230:231], v[230:231], v[14:15]
v_pk_fma_f32 v[254:255], v[230:231], v[230:231], v[254:255]
v_pk_add_f32 v[246:247], v[246:247], v[230:231]
v_cvt_pk_bf16_f32 v227, v230, v231
ds_write_b128 v0, v[224:227] offset:8192
v_and_b32 v8, 3, v2
v_cmp_eq_u32 s[74:75], 1, v8
v_cmp_eq_u32 s[76:77], 2, v8
v_cmp_eq_u32 vcc, 3, v8
v_lshrrev_b32 v8, 4, v2
v_lshlrev_b32 v8, 7, v8
v_and_b32 v9, 7, v2
v_lshl_add_u32 v8, v9, 4, v8
v_and_b32 v9, 8, v2
v_add_u32 v8, v8, v9
v_add_f32_dpp v240, v240, v240 row_ror:8 row_mask:0xf bank_mask:0x3
v_add_f32_dpp v241, v241, v241 row_ror:8 row_mask:0xf bank_mask:0x3
v_add_f32_dpp v242, v242, v242 row_ror:8 row_mask:0xf bank_mask:0x3
v_add_f32_dpp v243, v243, v243 row_ror:8 row_mask:0xf bank_mask:0x3
v_add_f32_dpp v244, v244, v244 row_ror:8 row_mask:0xf bank_mask:0x3
v_add_f32_dpp v245, v245, v245 row_ror:8 row_mask:0xf bank_mask:0x3
v_add_f32_dpp v246, v246, v246 row_ror:8 row_mask:0xf bank_mask:0x3
v_add_f32_dpp v247, v247, v247 row_ror:8 row_mask:0xf bank_mask:0x3
v_add_f32_dpp v240, v248, v248 row_ror:8 row_mask:0xf bank_mask:0xc
v_add_f32_dpp v241, v249, v249 row_ror:8 row_mask:0xf bank_mask:0xc
v_add_f32_dpp v242, v250, v250 row_ror:8 row_mask:0xf bank_mask:0xc
v_add_f32_dpp v243, v251, v251 row_ror:8 row_mask:0xf bank_mask:0xc
v_add_f32_dpp v244, v252, v252 row_ror:8 row_mask:0xf bank_mask:0xc
v_add_f32_dpp v245, v253, v253 row_ror:8 row_mask:0xf bank_mask:0xc
v_add_f32_dpp v246, v254, v254 row_ror:8 row_mask:0xf bank_mask:0xc
v_add_f32_dpp v247, v255, v255 row_ror:8 row_mask:0xf bank_mask:0xc
v_add_f32_dpp v240, v240, v240 row_shl:4 row_mask:0xf bank_mask:0x5
v_add_f32_dpp v241, v241, v241 row_shl:4 row_mask:0xf bank_mask:0x5
v_add_f32_dpp v242, v242, v242 row_shl:4 row_mask:0xf bank_mask:0x5
v_add_f32_dpp v243, v243, v243 row_shl:4 row_mask:0xf bank_mask:0x5
v_add_f32_dpp v240, v244, v244 row_shr:4 row_mask:0xf bank_mask:0xa
v_add_f32_dpp v241, v245, v245 row_shr:4 row_mask:0xf bank_mask:0xa
v_add_f32_dpp v242, v246, v246 row_shr:4 row_mask:0xf bank_mask:0xa
v_add_f32_dpp v243, v247, v247 row_shr:4 row_mask:0xf bank_mask:0xa
v_add_f32_dpp v240, v240, v240 quad_perm:[1,0,3,2] row_mask:0xf bank_mask:0xf
v_add_f32_dpp v241, v241, v241 quad_perm:[1,0,3,2] row_mask:0xf bank_mask:0xf
v_add_f32_dpp v242, v242, v242 quad_perm:[1,0,3,2] row_mask:0xf bank_mask:0xf
v_add_f32_dpp v243, v243, v243 quad_perm:[1,0,3,2] row_mask:0xf bank_mask:0xf
v_add_f32_dpp v240, v240, v240 quad_perm:[2,3,0,1] row_mask:0xf bank_mask:0xf
v_add_f32_dpp v241, v241, v241 quad_perm:[2,3,0,1] row_mask:0xf bank_mask:0xf
v_add_f32_dpp v242, v242, v242 quad_perm:[2,3,0,1] row_mask:0xf bank_mask:0xf
v_add_f32_dpp v243, v243, v243 quad_perm:[2,3,0,1] row_mask:0xf bank_mask:0xf
v_cndmask_b32 v240, v240, v241, s[74:75]
v_cndmask_b32 v242, v242, v243, vcc
s_or_b64 vcc, vcc, s[76:77]
v_cndmask_b32 v164, v240, v242, vcc
v_mov_b32 v165, s59
buffer_store_dwordx2 v[164:165], v8, s[20:23], s69 offen sc1
Lpad6313:
s_cbranch_execz Lback4
v_lshlrev_b32 v10, 4, v2
v_add_u32 v10, s68, v10
v_lshlrev_b32 v11, 3, v2
v_add_u32 v11, s68, v11
ds_read_b128 v[12:15], v10
ds_read_b64 v[8:9], v11 offset:1024
v_mov_b32 v10, 0
v_mov_b32 v11, 0
s_waitcnt lgkmcnt(2)
L_gy:
s_barrier
ds_read_b64_tr_b16 v[232:233], v6 offset:38912
ds_read_b64_tr_b16 v[234:235], v6 offset:42496
ds_read_b64_tr_b16 v[236:237], v6 offset:38944
ds_read_b64_tr_b16 v[238:239], v6 offset:42528
ds_read_b64_tr_b16 v[240:241], v6 offset:38976
ds_read_b64_tr_b16 v[242:243], v6 offset:42560
ds_read_b64_tr_b16 v[244:245], v6 offset:39008
ds_read_b64_tr_b16 v[246:247], v6 offset:42592
ds_read_b64_tr_b16 v[248:249], v6 offset:39040
ds_read_b64_tr_b16 v[250:251], v6 offset:42624
s_waitcnt lgkmcnt(8)
v_mfma_f32_16x16x32_bf16 v[160:163], v[232:235], v[16:19], 0
ds_read_b64_tr_b16 v[252:253], v6 offset:39072
v_mfma_f32_16x16x32_bf16 v[164:167], v[232:235], v[20:23], 0
ds_read_b64_tr_b16 v[254:255], v6 offset:42656
s_waitcnt lgkmcnt(8)
v_mfma_f32_16x16x32_bf16 v[168:171], v[236:239], v[16:19], 0
ds_read_b64_tr_b16 v[232:233], v6 offset:39104
v_mfma_f32_16x16x32_bf16 v[172:175], v[236:239], v[20:23], 0
ds_read_b64_tr_b16 v[234:235], v6 offset:42688
s_waitcnt lgkmcnt(8)
v_mfma_f32_16x16x32_bf16 v[176:179], v[240:243], v[16:19], 0
ds_read_b64_tr_b16 v[236:237], v6 offset:46080
v_mfma_f32_16x16x32_bf16 v[180:183], v[240:243], v[20:23], 0
ds_read_b64_tr_b16 v[238:239], v6 offset:49664
s_waitcnt lgkmcnt(8)
v_mfma_f32_16x16x32_bf16 v[184:187], v[244:247], v[16:19], 0
ds_read_b64_tr_b16 v[240:241], v6 offset:46112
v_mfma_f32_16x16x32_bf16 v[188:191], v[244:247], v[20:23], 0
ds_read_b64_tr_b16 v[242:243], v6 offset:49696
s_waitcnt lgkmcnt(8)
v_mfma_f32_16x16x32_bf16 v[192:195], v[248:251], v[16:19], 0
ds_read_b64_tr_b16 v[244:245], v6 offset:46144
v_mfma_f32_16x16x32_bf16 v[196:199], v[248:251], v[20:23], 0
ds_read_b64_tr_b16 v[246:247], v6 offset:49728
s_waitcnt lgkmcnt(8)
v_mfma_f32_16x16x32_bf16 v[200:203], v[252:255], v[16:19], 0
ds_read_b64_tr_b16 v[248:249], v6 offset:46176
v_mfma_f32_16x16x32_bf16 v[204:207], v[252:255], v[20:23], 0
ds_read_b64_tr_b16 v[250:251], v6 offset:49760
s_waitcnt lgkmcnt(8)
v_mfma_f32_16x16x32_bf16 v[208:211], v[232:235], v[16:19], 0
ds_read_b64_tr_b16 v[252:253], v6 offset:46208
v_mfma_f32_16x16x32_bf16 v[212:215], v[232:235], v[20:23], 0
ds_read_b64_tr_b16 v[254:255], v6 offset:49792
s_waitcnt lgkmcnt(8)
v_mfma_f32_16x16x32_bf16 v[160:163], v[236:239], v[24:27], v[160:163]
ds_read_b64_tr_b16 v[232:233], v6 offset:46240
v_mfma_f32_16x16x32_bf16 v[164:167], v[236:239], v[28:31], v[164:167]
ds_read_b64_tr_b16 v[234:235], v6 offset:49824
s_waitcnt lgkmcnt(8)
v_mfma_f32_16x16x32_bf16 v[168:171], v[240:243], v[24:27], v[168:171]
ds_read_b64_tr_b16 v[236:237], v6 offset:46272
v_mfma_f32_16x16x32_bf16 v[172:175], v[240:243], v[28:31], v[172:175]
ds_read_b64_tr_b16 v[238:239], v6 offset:49856
s_waitcnt lgkmcnt(8)
s_barrier
v_mfma_f32_16x16x32_bf16 v[176:179], v[244:247], v[24:27], v[176:179]
ds_read_b64_tr_b16 v[240:241], v6 offset:55296
v_mfma_f32_16x16x32_bf16 v[180:183], v[244:247], v[28:31], v[180:183]
ds_read_b64_tr_b16 v[242:243], v7 offset:1536
s_waitcnt lgkmcnt(8)
v_mfma_f32_16x16x32_bf16 v[184:187], v[248:251], v[24:27], v[184:187]
ds_read_b64_tr_b16 v[244:245], v6 offset:55328
Lpad6388:
s_cbranch_execz Lpad6459
v_mfma_f32_16x16x32_bf16 v[188:191], v[248:251], v[28:31], v[188:191]
ds_read_b64_tr_b16 v[246:247], v7 offset:1568
s_waitcnt lgkmcnt(8)
v_mfma_f32_16x16x32_bf16 v[192:195], v[252:255], v[24:27], v[192:195]
ds_read_b64_tr_b16 v[248:249], v6 offset:55360
v_mfma_f32_16x16x32_bf16 v[196:199], v[252:255], v[28:31], v[196:199]
ds_read_b64_tr_b16 v[250:251], v7 offset:1600
s_waitcnt lgkmcnt(8)
v_mfma_f32_16x16x32_bf16 v[200:203], v[232:235], v[24:27], v[200:203]
ds_read_b64_tr_b16 v[252:253], v6 offset:55392
v_mfma_f32_16x16x32_bf16 v[204:207], v[232:235], v[28:31], v[204:207]
ds_read_b64_tr_b16 v[254:255], v7 offset:1632
s_waitcnt lgkmcnt(8)
v_mfma_f32_16x16x32_bf16 v[208:211], v[236:239], v[24:27], v[208:211]
ds_read_b64_tr_b16 v[232:233], v6 offset:55424
v_mfma_f32_16x16x32_bf16 v[212:215], v[236:239], v[28:31], v[212:215]
ds_read_b64_tr_b16 v[234:235], v7 offset:1664
s_waitcnt lgkmcnt(8)
v_mfma_f32_16x16x32_bf16 v[160:163], v[240:243], v[32:35], v[160:163]
ds_read_b64_tr_b16 v[236:237], v6 offset:55456
v_mfma_f32_16x16x32_bf16 v[164:167], v[240:243], v[36:39], v[164:167]
ds_read_b64_tr_b16 v[238:239], v7 offset:1696
s_waitcnt lgkmcnt(8)
v_mfma_f32_16x16x32_bf16 v[168:171], v[244:247], v[32:35], v[168:171]
ds_read_b64_tr_b16 v[240:241], v6 offset:55488
v_mfma_f32_16x16x32_bf16 v[172:175], v[244:247], v[36:39], v[172:175]
ds_read_b64_tr_b16 v[242:243], v7 offset:1728
s_waitcnt lgkmcnt(8)
v_mfma_f32_16x16x32_bf16 v[176:179], v[248:251], v[32:35], v[176:179]
ds_read_b64_tr_b16 v[244:245], v7 offset:5120
v_mfma_f32_16x16x32_bf16 v[180:183], v[248:251], v[36:39], v[180:183]
ds_read_b64_tr_b16 v[246:247], v7 offset:8704
s_waitcnt lgkmcnt(8)
v_mfma_f32_16x16x32_bf16 v[184:187], v[252:255], v[32:35], v[184:187]
ds_read_b64_tr_b16 v[248:249], v7 offset:5152
v_mfma_f32_16x16x32_bf16 v[188:191], v[252:255], v[36:39], v[188:191]
ds_read_b64_tr_b16 v[250:251], v7 offset:8736
s_waitcnt lgkmcnt(8)
v_mfma_f32_16x16x32_bf16 v[192:195], v[232:235], v[32:35], v[192:195]
ds_read_b64_tr_b16 v[252:253], v7 offset:5184
v_mfma_f32_16x16x32_bf16 v[196:199], v[232:235], v[36:39], v[196:199]
ds_read_b64_tr_b16 v[254:255], v7 offset:8768
s_waitcnt lgkmcnt(8)
v_mfma_f32_16x16x32_bf16 v[200:203], v[236:239], v[32:35], v[200:203]
ds_read_b64_tr_b16 v[232:233], v7 offset:5216
v_mfma_f32_16x16x32_bf16 v[204:207], v[236:239], v[36:39], v[204:207]
ds_read_b64_tr_b16 v[234:235], v7 offset:8800
s_waitcnt lgkmcnt(8)
v_mfma_f32_16x16x32_bf16 v[208:211], v[240:243], v[32:35], v[208:211]
ds_read_b64_tr_b16 v[236:237], v7 offset:5248
v_mfma_f32_16x16x32_bf16 v[212:215], v[240:243], v[36:39], v[212:215]
ds_read_b64_tr_b16 v[238:239], v7 offset:8832
s_waitcnt lgkmcnt(8)
v_mfma_f32_16x16x32_bf16 v[160:163], v[244:247], v[40:43], v[160:163]
ds_read_b64_tr_b16 v[240:241], v7 offset:5280
v_mfma_f32_16x16x32_bf16 v[164:167], v[244:247], v[44:47], v[164:167]
ds_read_b64_tr_b16 v[242:243], v7 offset:8864
s_waitcnt lgkmcnt(8)
v_mfma_f32_16x16x32_bf16 v[168:171], v[248:251], v[40:43], v[168:171]
ds_read_b64_tr_b16 v[244:245], v7 offset:5312
v_mfma_f32_16x16x32_bf16 v[172:175], v[248:251], v[44:47], v[172:175]
ds_read_b64_tr_b16 v[246:247], v7 offset:8896
s_waitcnt lgkmcnt(8)
s_barrier
v_mfma_f32_16x16x32_bf16 v[176:179], v[252:255], v[40:43], v[176:179]
ds_read_b64_tr_b16 v[248:249], v7 offset:16384
v_mfma_f32_16x16x32_bf16 v[180:183], v[252:255], v[44:47], v[180:183]
ds_read_b64_tr_b16 v[250:251], v7 offset:19968
s_waitcnt lgkmcnt(8)
v_mfma_f32_16x16x32_bf16 v[184:187], v[232:235], v[40:43], v[184:187]
ds_read_b64_tr_b16 v[252:253], v7 offset:16416
Lpad6459:
s_cbranch_execz Lpad6530
v_mfma_f32_16x16x32_bf16 v[188:191], v[232:235], v[44:47], v[188:191]
ds_read_b64_tr_b16 v[254:255], v7 offset:20000
s_waitcnt lgkmcnt(8)
v_mfma_f32_16x16x32_bf16 v[192:195], v[236:239], v[40:43], v[192:195]
ds_read_b64_tr_b16 v[232:233], v7 offset:16448
v_mfma_f32_16x16x32_bf16 v[196:199], v[236:239], v[44:47], v[196:199]
ds_read_b64_tr_b16 v[234:235], v7 offset:20032
s_waitcnt lgkmcnt(8)
v_mfma_f32_16x16x32_bf16 v[200:203], v[240:243], v[40:43], v[200:203]
ds_read_b64_tr_b16 v[236:237], v7 offset:16480
v_mfma_f32_16x16x32_bf16 v[204:207], v[240:243], v[44:47], v[204:207]
ds_read_b64_tr_b16 v[238:239], v7 offset:20064
s_waitcnt lgkmcnt(8)
v_mfma_f32_16x16x32_bf16 v[208:211], v[244:247], v[40:43], v[208:211]
ds_read_b64_tr_b16 v[240:241], v7 offset:16512
v_mfma_f32_16x16x32_bf16 v[212:215], v[244:247], v[44:47], v[212:215]
ds_read_b64_tr_b16 v[242:243], v7 offset:20096
s_waitcnt lgkmcnt(8)
v_mfma_f32_16x16x32_bf16 v[160:163], v[248:251], v[48:51], v[160:163]
ds_read_b64_tr_b16 v[244:245], v7 offset:16544
v_mfma_f32_16x16x32_bf16 v[164:167], v[248:251], v[52:55], v[164:167]
ds_read_b64_tr_b16 v[246:247], v7 offset:20128
s_waitcnt lgkmcnt(8)
v_mfma_f32_16x16x32_bf16 v[168:171], v[252:255], v[48:51], v[168:171]
ds_read_b64_tr_b16 v[248:249], v7 offset:16576
v_mfma_f32_16x16x32_bf16 v[172:175], v[252:255], v[52:55], v[172:175]
ds_read_b64_tr_b16 v[250:251], v7 offset:20160
s_waitcnt lgkmcnt(8)
v_mfma_f32_16x16x32_bf16 v[176:179], v[232:235], v[48:51], v[176:179]
ds_read_b64_tr_b16 v[252:253], v7 offset:23552
v_mfma_f32_16x16x32_bf16 v[180:183], v[232:235], v[52:55], v[180:183]
ds_read_b64_tr_b16 v[254:255], v7 offset:27136
s_waitcnt lgkmcnt(8)
v_mfma_f32_16x16x32_bf16 v[184:187], v[236:239], v[48:51], v[184:187]
ds_read_b64_tr_b16 v[232:233], v7 offset:23584
v_mfma_f32_16x16x32_bf16 v[188:191], v[236:239], v[52:55], v[188:191]
ds_read_b64_tr_b16 v[234:235], v7 offset:27168
s_waitcnt lgkmcnt(8)
v_mfma_f32_16x16x32_bf16 v[192:195], v[240:243], v[48:51], v[192:195]
ds_read_b64_tr_b16 v[236:237], v7 offset:23616
v_mfma_f32_16x16x32_bf16 v[196:199], v[240:243], v[52:55], v[196:199]
ds_read_b64_tr_b16 v[238:239], v7 offset:27200
s_waitcnt lgkmcnt(8)
v_mfma_f32_16x16x32_bf16 v[200:203], v[244:247], v[48:51], v[200:203]
ds_read_b64_tr_b16 v[240:241], v7 offset:23648
v_mfma_f32_16x16x32_bf16 v[204:207], v[244:247], v[52:55], v[204:207]
ds_read_b64_tr_b16 v[242:243], v7 offset:27232
s_waitcnt lgkmcnt(8)
v_mfma_f32_16x16x32_bf16 v[208:211], v[248:251], v[48:51], v[208:211]
ds_read_b64_tr_b16 v[244:245], v7 offset:23680
v_mfma_f32_16x16x32_bf16 v[212:215], v[248:251], v[52:55], v[212:215]
ds_read_b64_tr_b16 v[246:247], v7 offset:27264
s_waitcnt lgkmcnt(8)
v_mfma_f32_16x16x32_bf16 v[160:163], v[252:255], v[56:59], v[160:163]
ds_read_b64_tr_b16 v[248:249], v7 offset:23712
v_mfma_f32_16x16x32_bf16 v[164:167], v[252:255], v[60:63], v[164:167]
ds_read_b64_tr_b16 v[250:251], v7 offset:27296
s_waitcnt lgkmcnt(8)
v_mfma_f32_16x16x32_bf16 v[168:171], v[232:235], v[56:59], v[168:171]
ds_read_b64_tr_b16 v[252:253], v7 offset:23744
v_mfma_f32_16x16x32_bf16 v[172:175], v[232:235], v[60:63], v[172:175]
ds_read_b64_tr_b16 v[254:255], v7 offset:27328
s_waitcnt lgkmcnt(8)
s_barrier
v_mfma_f32_16x16x32_bf16 v[176:179], v[236:239], v[56:59], v[176:179]
ds_read_b64_tr_b16 v[232:233], v7 offset:32768
v_mfma_f32_16x16x32_bf16 v[180:183], v[236:239], v[60:63], v[180:183]
ds_read_b64_tr_b16 v[234:235], v7 offset:36352
s_waitcnt lgkmcnt(8)
v_mfma_f32_16x16x32_bf16 v[184:187], v[240:243], v[56:59], v[184:187]
ds_read_b64_tr_b16 v[236:237], v7 offset:32800
Lpad6530:
s_cbranch_execz Lpad6601
v_mfma_f32_16x16x32_bf16 v[188:191], v[240:243], v[60:63], v[188:191]
ds_read_b64_tr_b16 v[238:239], v7 offset:36384
s_waitcnt lgkmcnt(8)
v_mfma_f32_16x16x32_bf16 v[192:195], v[244:247], v[56:59], v[192:195]
ds_read_b64_tr_b16 v[240:241], v7 offset:32832
v_mfma_f32_16x16x32_bf16 v[196:199], v[244:247], v[60:63], v[196:199]
ds_read_b64_tr_b16 v[242:243], v7 offset:36416
s_waitcnt lgkmcnt(8)
v_mfma_f32_16x16x32_bf16 v[200:203], v[248:251], v[56:59], v[200:203]
ds_read_b64_tr_b16 v[244:245], v7 offset:32864
v_mfma_f32_16x16x32_bf16 v[204:207], v[248:251], v[60:63], v[204:207]
ds_read_b64_tr_b16 v[246:247], v7 offset:36448
s_waitcnt lgkmcnt(8)
v_mfma_f32_16x16x32_bf16 v[208:211], v[252:255], v[56:59], v[208:211]
ds_read_b64_tr_b16 v[248:249], v7 offset:32896
v_mfma_f32_16x16x32_bf16 v[212:215], v[252:255], v[60:63], v[212:215]
ds_read_b64_tr_b16 v[250:251], v7 offset:36480
s_waitcnt lgkmcnt(8)
v_mfma_f32_16x16x32_bf16 v[160:163], v[232:235], v[64:67], v[160:163]
ds_read_b64_tr_b16 v[252:253], v7 offset:32928
v_mfma_f32_16x16x32_bf16 v[164:167], v[232:235], v[68:71], v[164:167]
ds_read_b64_tr_b16 v[254:255], v7 offset:36512
s_waitcnt lgkmcnt(8)
v_mfma_f32_16x16x32_bf16 v[168:171], v[236:239], v[64:67], v[168:171]
ds_read_b64_tr_b16 v[232:233], v7 offset:32960
v_mfma_f32_16x16x32_bf16 v[172:175], v[236:239], v[68:71], v[172:175]
ds_read_b64_tr_b16 v[234:235], v7 offset:36544
s_waitcnt lgkmcnt(8)
v_mfma_f32_16x16x32_bf16 v[176:179], v[240:243], v[64:67], v[176:179]
ds_read_b64_tr_b16 v[236:237], v7 offset:39936
v_mfma_f32_16x16x32_bf16 v[180:183], v[240:243], v[68:71], v[180:183]
ds_read_b64_tr_b16 v[238:239], v7 offset:43520
s_waitcnt lgkmcnt(8)
v_mfma_f32_16x16x32_bf16 v[184:187], v[244:247], v[64:67], v[184:187]
ds_read_b64_tr_b16 v[240:241], v7 offset:39968
v_mfma_f32_16x16x32_bf16 v[188:191], v[244:247], v[68:71], v[188:191]
ds_read_b64_tr_b16 v[242:243], v7 offset:43552
s_waitcnt lgkmcnt(8)
v_mfma_f32_16x16x32_bf16 v[192:195], v[248:251], v[64:67], v[192:195]
ds_read_b64_tr_b16 v[244:245], v7 offset:40000
v_mfma_f32_16x16x32_bf16 v[196:199], v[248:251], v[68:71], v[196:199]
ds_read_b64_tr_b16 v[246:247], v7 offset:43584
s_waitcnt lgkmcnt(8)
v_mfma_f32_16x16x32_bf16 v[200:203], v[252:255], v[64:67], v[200:203]
ds_read_b64_tr_b16 v[248:249], v7 offset:40032
v_mfma_f32_16x16x32_bf16 v[204:207], v[252:255], v[68:71], v[204:207]
ds_read_b64_tr_b16 v[250:251], v7 offset:43616
s_waitcnt lgkmcnt(8)
v_mfma_f32_16x16x32_bf16 v[208:211], v[232:235], v[64:67], v[208:211]
ds_read_b64_tr_b16 v[252:253], v7 offset:40064
v_mfma_f32_16x16x32_bf16 v[212:215], v[232:235], v[68:71], v[212:215]
ds_read_b64_tr_b16 v[254:255], v7 offset:43648
s_waitcnt lgkmcnt(8)
v_mfma_f32_16x16x32_bf16 v[160:163], v[236:239], v[72:75], v[160:163]
ds_read_b64_tr_b16 v[232:233], v7 offset:40096
v_mfma_f32_16x16x32_bf16 v[164:167], v[236:239], v[76:79], v[164:167]
ds_read_b64_tr_b16 v[234:235], v7 offset:43680
s_waitcnt lgkmcnt(8)
v_mfma_f32_16x16x32_bf16 v[168:171], v[240:243], v[72:75], v[168:171]
ds_read_b64_tr_b16 v[236:237], v7 offset:40128
v_mfma_f32_16x16x32_bf16 v[172:175], v[240:243], v[76:79], v[172:175]
ds_read_b64_tr_b16 v[238:239], v7 offset:43712
s_waitcnt lgkmcnt(8)
s_barrier
v_mfma_f32_16x16x32_bf16 v[176:179], v[244:247], v[72:75], v[176:179]
ds_read_b64_tr_b16 v[240:241], v6 offset:24576
v_mfma_f32_16x16x32_bf16 v[180:183], v[244:247], v[76:79], v[180:183]
ds_read_b64_tr_b16 v[242:243], v6 offset:28160
s_waitcnt lgkmcnt(8)
v_mfma_f32_16x16x32_bf16 v[184:187], v[248:251], v[72:75], v[184:187]
ds_read_b64_tr_b16 v[244:245], v6 offset:24608
Lpad6601:
s_cbranch_execz Lpad6672
v_mfma_f32_16x16x32_bf16 v[188:191], v[248:251], v[76:79], v[188:191]
ds_read_b64_tr_b16 v[246:247], v6 offset:28192
s_waitcnt lgkmcnt(8)
v_mfma_f32_16x16x32_bf16 v[192:195], v[252:255], v[72:75], v[192:195]
ds_read_b64_tr_b16 v[248:249], v6 offset:24640
v_mfma_f32_16x16x32_bf16 v[196:199], v[252:255], v[76:79], v[196:199]
ds_read_b64_tr_b16 v[250:251], v6 offset:28224
s_waitcnt lgkmcnt(8)
v_mfma_f32_16x16x32_bf16 v[200:203], v[232:235], v[72:75], v[200:203]
ds_read_b64_tr_b16 v[252:253], v6 offset:24672
v_mfma_f32_16x16x32_bf16 v[204:207], v[232:235], v[76:79], v[204:207]
ds_read_b64_tr_b16 v[254:255], v6 offset:28256
s_waitcnt lgkmcnt(8)
v_mfma_f32_16x16x32_bf16 v[208:211], v[236:239], v[72:75], v[208:211]
ds_read_b64_tr_b16 v[232:233], v6 offset:24704
v_mfma_f32_16x16x32_bf16 v[212:215], v[236:239], v[76:79], v[212:215]
ds_read_b64_tr_b16 v[234:235], v6 offset:28288
s_waitcnt lgkmcnt(8)
v_mfma_f32_16x16x32_bf16 v[160:163], v[240:243], v[80:83], v[160:163]
ds_read_b64_tr_b16 v[236:237], v6 offset:24736
v_mfma_f32_16x16x32_bf16 v[164:167], v[240:243], v[84:87], v[164:167]
ds_read_b64_tr_b16 v[238:239], v6 offset:28320
s_waitcnt lgkmcnt(8)
v_mfma_f32_16x16x32_bf16 v[168:171], v[244:247], v[80:83], v[168:171]
ds_read_b64_tr_b16 v[240:241], v6 offset:24768
v_mfma_f32_16x16x32_bf16 v[172:175], v[244:247], v[84:87], v[172:175]
ds_read_b64_tr_b16 v[242:243], v6 offset:28352
s_waitcnt lgkmcnt(8)
v_mfma_f32_16x16x32_bf16 v[176:179], v[248:251], v[80:83], v[176:179]
ds_read_b64_tr_b16 v[244:245], v6 offset:31744
v_mfma_f32_16x16x32_bf16 v[180:183], v[248:251], v[84:87], v[180:183]
ds_read_b64_tr_b16 v[246:247], v6 offset:35328
s_waitcnt lgkmcnt(8)
v_mfma_f32_16x16x32_bf16 v[184:187], v[252:255], v[80:83], v[184:187]
ds_read_b64_tr_b16 v[248:249], v6 offset:31776
v_mfma_f32_16x16x32_bf16 v[188:191], v[252:255], v[84:87], v[188:191]
ds_read_b64_tr_b16 v[250:251], v6 offset:35360
s_waitcnt lgkmcnt(8)
v_mfma_f32_16x16x32_bf16 v[192:195], v[232:235], v[80:83], v[192:195]
ds_read_b64_tr_b16 v[252:253], v6 offset:31808
v_mfma_f32_16x16x32_bf16 v[196:199], v[232:235], v[84:87], v[196:199]
ds_read_b64_tr_b16 v[254:255], v6 offset:35392
s_waitcnt lgkmcnt(8)
v_mfma_f32_16x16x32_bf16 v[200:203], v[236:239], v[80:83], v[200:203]
ds_read_b64_tr_b16 v[232:233], v6 offset:31840
v_mfma_f32_16x16x32_bf16 v[204:207], v[236:239], v[84:87], v[204:207]
ds_read_b64_tr_b16 v[234:235], v6 offset:35424
s_waitcnt lgkmcnt(8)
v_mfma_f32_16x16x32_bf16 v[208:211], v[240:243], v[80:83], v[208:211]
ds_read_b64_tr_b16 v[236:237], v6 offset:31872
v_mfma_f32_16x16x32_bf16 v[212:215], v[240:243], v[84:87], v[212:215]
ds_read_b64_tr_b16 v[238:239], v6 offset:35456
s_waitcnt lgkmcnt(8)
v_mfma_f32_16x16x32_bf16 v[160:163], v[244:247], v[88:91], v[160:163]
ds_read_b64_tr_b16 v[240:241], v6 offset:31904
v_mfma_f32_16x16x32_bf16 v[164:167], v[244:247], v[92:95], v[164:167]
ds_read_b64_tr_b16 v[242:243], v6 offset:35488
s_waitcnt lgkmcnt(8)
v_mfma_f32_16x16x32_bf16 v[168:171], v[248:251], v[88:91], v[168:171]
ds_read_b64_tr_b16 v[244:245], v6 offset:31936
v_mfma_f32_16x16x32_bf16 v[172:175], v[248:251], v[92:95], v[172:175]
ds_read_b64_tr_b16 v[246:247], v6 offset:35520
s_waitcnt lgkmcnt(8)
s_barrier
v_mfma_f32_16x16x32_bf16 v[176:179], v[252:255], v[88:91], v[176:179]
ds_read_b64_tr_b16 v[248:249], v6 offset:38912
v_mfma_f32_16x16x32_bf16 v[180:183], v[252:255], v[92:95], v[180:183]
ds_read_b64_tr_b16 v[250:251], v6 offset:42496
s_waitcnt lgkmcnt(8)
v_mfma_f32_16x16x32_bf16 v[184:187], v[232:235], v[88:91], v[184:187]
ds_read_b64_tr_b16 v[252:253], v6 offset:38944
Lpad6672:
s_cbranch_execz Lpad6743
v_mfma_f32_16x16x32_bf16 v[188:191], v[232:235], v[92:95], v[188:191]
ds_read_b64_tr_b16 v[254:255], v6 offset:42528
s_waitcnt lgkmcnt(8)
v_mfma_f32_16x16x32_bf16 v[192:195], v[236:239], v[88:91], v[192:195]
ds_read_b64_tr_b16 v[232:233], v6 offset:38976
v_mfma_f32_16x16x32_bf16 v[196:199], v[236:239], v[92:95], v[196:199]
ds_read_b64_tr_b16 v[234:235], v6 offset:42560
s_waitcnt lgkmcnt(8)
v_mfma_f32_16x16x32_bf16 v[200:203], v[240:243], v[88:91], v[200:203]
ds_read_b64_tr_b16 v[236:237], v6 offset:39008
v_mfma_f32_16x16x32_bf16 v[204:207], v[240:243], v[92:95], v[204:207]
ds_read_b64_tr_b16 v[238:239], v6 offset:42592
s_waitcnt lgkmcnt(8)
v_mfma_f32_16x16x32_bf16 v[208:211], v[244:247], v[88:91], v[208:211]
ds_read_b64_tr_b16 v[240:241], v6 offset:39040
v_mfma_f32_16x16x32_bf16 v[212:215], v[244:247], v[92:95], v[212:215]
ds_read_b64_tr_b16 v[242:243], v6 offset:42624
s_waitcnt lgkmcnt(8)
v_mfma_f32_16x16x32_bf16 v[160:163], v[248:251], v[96:99], v[160:163]
ds_read_b64_tr_b16 v[244:245], v6 offset:39072
v_mfma_f32_16x16x32_bf16 v[164:167], v[248:251], v[100:103], v[164:167]
ds_read_b64_tr_b16 v[246:247], v6 offset:42656
s_waitcnt lgkmcnt(8)
v_mfma_f32_16x16x32_bf16 v[168:171], v[252:255], v[96:99], v[168:171]
ds_read_b64_tr_b16 v[248:249], v6 offset:39104
v_mfma_f32_16x16x32_bf16 v[172:175], v[252:255], v[100:103], v[172:175]
ds_read_b64_tr_b16 v[250:251], v6 offset:42688
s_waitcnt lgkmcnt(8)
v_mfma_f32_16x16x32_bf16 v[176:179], v[232:235], v[96:99], v[176:179]
ds_read_b64_tr_b16 v[252:253], v6 offset:46080
v_mfma_f32_16x16x32_bf16 v[180:183], v[232:235], v[100:103], v[180:183]
ds_read_b64_tr_b16 v[254:255], v6 offset:49664
s_waitcnt lgkmcnt(8)
v_mfma_f32_16x16x32_bf16 v[184:187], v[236:239], v[96:99], v[184:187]
ds_read_b64_tr_b16 v[232:233], v6 offset:46112
v_mfma_f32_16x16x32_bf16 v[188:191], v[236:239], v[100:103], v[188:191]
ds_read_b64_tr_b16 v[234:235], v6 offset:49696
s_waitcnt lgkmcnt(8)
v_mfma_f32_16x16x32_bf16 v[192:195], v[240:243], v[96:99], v[192:195]
ds_read_b64_tr_b16 v[236:237], v6 offset:46144
v_mfma_f32_16x16x32_bf16 v[196:199], v[240:243], v[100:103], v[196:199]
ds_read_b64_tr_b16 v[238:239], v6 offset:49728
s_waitcnt lgkmcnt(8)
v_mfma_f32_16x16x32_bf16 v[200:203], v[244:247], v[96:99], v[200:203]
ds_read_b64_tr_b16 v[240:241], v6 offset:46176
v_mfma_f32_16x16x32_bf16 v[204:207], v[244:247], v[100:103], v[204:207]
ds_read_b64_tr_b16 v[242:243], v6 offset:49760
s_waitcnt lgkmcnt(8)
v_mfma_f32_16x16x32_bf16 v[208:211], v[248:251], v[96:99], v[208:211]
ds_read_b64_tr_b16 v[244:245], v6 offset:46208
v_mfma_f32_16x16x32_bf16 v[212:215], v[248:251], v[100:103], v[212:215]
ds_read_b64_tr_b16 v[246:247], v6 offset:49792
s_waitcnt lgkmcnt(8)
v_mfma_f32_16x16x32_bf16 v[160:163], v[252:255], v[104:107], v[160:163]
ds_read_b64_tr_b16 v[248:249], v6 offset:46240
v_mfma_f32_16x16x32_bf16 v[164:167], v[252:255], v[108:111], v[164:167]
ds_read_b64_tr_b16 v[250:251], v6 offset:49824
s_waitcnt lgkmcnt(8)
v_mfma_f32_16x16x32_bf16 v[168:171], v[232:235], v[104:107], v[168:171]
ds_read_b64_tr_b16 v[252:253], v6 offset:46272
v_mfma_f32_16x16x32_bf16 v[172:175], v[232:235], v[108:111], v[172:175]
ds_read_b64_tr_b16 v[254:255], v6 offset:49856
s_waitcnt lgkmcnt(8)
s_barrier
v_mfma_f32_16x16x32_bf16 v[176:179], v[236:239], v[104:107], v[176:179]
ds_read_b64_tr_b16 v[232:233], v6 offset:55296
v_mfma_f32_16x16x32_bf16 v[180:183], v[236:239], v[108:111], v[180:183]
ds_read_b64_tr_b16 v[234:235], v7 offset:1536
s_waitcnt lgkmcnt(8)
v_mfma_f32_16x16x32_bf16 v[184:187], v[240:243], v[104:107], v[184:187]
ds_read_b64_tr_b16 v[236:237], v6 offset:55328
Lpad6743:
s_cbranch_execz Lpad6814
v_mfma_f32_16x16x32_bf16 v[188:191], v[240:243], v[108:111], v[188:191]
ds_read_b64_tr_b16 v[238:239], v7 offset:1568
s_waitcnt lgkmcnt(8)
v_mfma_f32_16x16x32_bf16 v[192:195], v[244:247], v[104:107], v[192:195]
ds_read_b64_tr_b16 v[240:241], v6 offset:55360
v_mfma_f32_16x16x32_bf16 v[196:199], v[244:247], v[108:111], v[196:199]
ds_read_b64_tr_b16 v[242:243], v7 offset:1600
s_waitcnt lgkmcnt(8)
v_mfma_f32_16x16x32_bf16 v[200:203], v[248:251], v[104:107], v[200:203]
ds_read_b64_tr_b16 v[244:245], v6 offset:55392
v_mfma_f32_16x16x32_bf16 v[204:207], v[248:251], v[108:111], v[204:207]
ds_read_b64_tr_b16 v[246:247], v7 offset:1632
s_waitcnt lgkmcnt(8)
v_mfma_f32_16x16x32_bf16 v[208:211], v[252:255], v[104:107], v[208:211]
ds_read_b64_tr_b16 v[248:249], v6 offset:55424
v_mfma_f32_16x16x32_bf16 v[212:215], v[252:255], v[108:111], v[212:215]
ds_read_b64_tr_b16 v[250:251], v7 offset:1664
s_waitcnt lgkmcnt(8)
v_mfma_f32_16x16x32_bf16 v[160:163], v[232:235], v[112:115], v[160:163]
ds_read_b64_tr_b16 v[252:253], v6 offset:55456
v_mfma_f32_16x16x32_bf16 v[164:167], v[232:235], v[116:119], v[164:167]
ds_read_b64_tr_b16 v[254:255], v7 offset:1696
s_waitcnt lgkmcnt(8)
v_mfma_f32_16x16x32_bf16 v[168:171], v[236:239], v[112:115], v[168:171]
ds_read_b64_tr_b16 v[232:233], v6 offset:55488
v_mfma_f32_16x16x32_bf16 v[172:175], v[236:239], v[116:119], v[172:175]
ds_read_b64_tr_b16 v[234:235], v7 offset:1728
s_waitcnt lgkmcnt(8)
v_mfma_f32_16x16x32_bf16 v[176:179], v[240:243], v[112:115], v[176:179]
ds_read_b64_tr_b16 v[236:237], v7 offset:5120
v_mfma_f32_16x16x32_bf16 v[180:183], v[240:243], v[116:119], v[180:183]
ds_read_b64_tr_b16 v[238:239], v7 offset:8704
s_waitcnt lgkmcnt(8)
v_mfma_f32_16x16x32_bf16 v[184:187], v[244:247], v[112:115], v[184:187]
ds_read_b64_tr_b16 v[240:241], v7 offset:5152
v_mfma_f32_16x16x32_bf16 v[188:191], v[244:247], v[116:119], v[188:191]
ds_read_b64_tr_b16 v[242:243], v7 offset:8736
s_waitcnt lgkmcnt(8)
v_mfma_f32_16x16x32_bf16 v[192:195], v[248:251], v[112:115], v[192:195]
ds_read_b64_tr_b16 v[244:245], v7 offset:5184
v_mfma_f32_16x16x32_bf16 v[196:199], v[248:251], v[116:119], v[196:199]
ds_read_b64_tr_b16 v[246:247], v7 offset:8768
s_waitcnt lgkmcnt(8)
v_mfma_f32_16x16x32_bf16 v[200:203], v[252:255], v[112:115], v[200:203]
ds_read_b64_tr_b16 v[248:249], v7 offset:5216
v_mfma_f32_16x16x32_bf16 v[204:207], v[252:255], v[116:119], v[204:207]
ds_read_b64_tr_b16 v[250:251], v7 offset:8800
s_waitcnt lgkmcnt(8)
v_mfma_f32_16x16x32_bf16 v[208:211], v[232:235], v[112:115], v[208:211]
ds_read_b64_tr_b16 v[252:253], v7 offset:5248
v_mfma_f32_16x16x32_bf16 v[212:215], v[232:235], v[116:119], v[212:215]
ds_read_b64_tr_b16 v[254:255], v7 offset:8832
s_waitcnt lgkmcnt(8)
v_mfma_f32_16x16x32_bf16 v[160:163], v[236:239], v[120:123], v[160:163]
ds_read_b64_tr_b16 v[232:233], v7 offset:5280
v_mfma_f32_16x16x32_bf16 v[164:167], v[236:239], v[124:127], v[164:167]
ds_read_b64_tr_b16 v[234:235], v7 offset:8864
s_waitcnt lgkmcnt(8)
v_mfma_f32_16x16x32_bf16 v[168:171], v[240:243], v[120:123], v[168:171]
ds_read_b64_tr_b16 v[236:237], v7 offset:5312
v_mfma_f32_16x16x32_bf16 v[172:175], v[240:243], v[124:127], v[172:175]
ds_read_b64_tr_b16 v[238:239], v7 offset:8896
s_waitcnt lgkmcnt(8)
s_barrier
v_mfma_f32_16x16x32_bf16 v[176:179], v[244:247], v[120:123], v[176:179]
ds_read_b64_tr_b16 v[240:241], v7 offset:16384
v_mfma_f32_16x16x32_bf16 v[180:183], v[244:247], v[124:127], v[180:183]
ds_read_b64_tr_b16 v[242:243], v7 offset:19968
s_waitcnt lgkmcnt(8)
v_mfma_f32_16x16x32_bf16 v[184:187], v[248:251], v[120:123], v[184:187]
ds_read_b64_tr_b16 v[244:245], v7 offset:16416
Lpad6814:
s_cbranch_execz Lpad6885
v_mfma_f32_16x16x32_bf16 v[188:191], v[248:251], v[124:127], v[188:191]
ds_read_b64_tr_b16 v[246:247], v7 offset:20000
s_waitcnt lgkmcnt(8)
v_mfma_f32_16x16x32_bf16 v[192:195], v[252:255], v[120:123], v[192:195]
ds_read_b64_tr_b16 v[248:249], v7 offset:16448
v_mfma_f32_16x16x32_bf16 v[196:199], v[252:255], v[124:127], v[196:199]
ds_read_b64_tr_b16 v[250:251], v7 offset:20032
s_waitcnt lgkmcnt(8)
v_mfma_f32_16x16x32_bf16 v[200:203], v[232:235], v[120:123], v[200:203]
ds_read_b64_tr_b16 v[252:253], v7 offset:16480
v_mfma_f32_16x16x32_bf16 v[204:207], v[232:235], v[124:127], v[204:207]
ds_read_b64_tr_b16 v[254:255], v7 offset:20064
s_waitcnt lgkmcnt(8)
v_mfma_f32_16x16x32_bf16 v[208:211], v[236:239], v[120:123], v[208:211]
ds_read_b64_tr_b16 v[232:233], v7 offset:16512
v_mfma_f32_16x16x32_bf16 v[212:215], v[236:239], v[124:127], v[212:215]
ds_read_b64_tr_b16 v[234:235], v7 offset:20096
s_waitcnt lgkmcnt(8)
v_mfma_f32_16x16x32_bf16 v[160:163], v[240:243], v[128:131], v[160:163]
ds_read_b64_tr_b16 v[236:237], v7 offset:16544
v_mfma_f32_16x16x32_bf16 v[164:167], v[240:243], v[132:135], v[164:167]
ds_read_b64_tr_b16 v[238:239], v7 offset:20128
s_waitcnt lgkmcnt(8)
v_mfma_f32_16x16x32_bf16 v[168:171], v[244:247], v[128:131], v[168:171]
ds_read_b64_tr_b16 v[240:241], v7 offset:16576
v_mfma_f32_16x16x32_bf16 v[172:175], v[244:247], v[132:135], v[172:175]
ds_read_b64_tr_b16 v[242:243], v7 offset:20160
s_waitcnt lgkmcnt(8)
v_mfma_f32_16x16x32_bf16 v[176:179], v[248:251], v[128:131], v[176:179]
ds_read_b64_tr_b16 v[244:245], v7 offset:23552
v_mfma_f32_16x16x32_bf16 v[180:183], v[248:251], v[132:135], v[180:183]
ds_read_b64_tr_b16 v[246:247], v7 offset:27136
s_waitcnt lgkmcnt(8)
v_mfma_f32_16x16x32_bf16 v[184:187], v[252:255], v[128:131], v[184:187]
ds_read_b64_tr_b16 v[248:249], v7 offset:23584
v_mfma_f32_16x16x32_bf16 v[188:191], v[252:255], v[132:135], v[188:191]
ds_read_b64_tr_b16 v[250:251], v7 offset:27168
s_waitcnt lgkmcnt(8)
v_mfma_f32_16x16x32_bf16 v[192:195], v[232:235], v[128:131], v[192:195]
ds_read_b64_tr_b16 v[252:253], v7 offset:23616
v_mfma_f32_16x16x32_bf16 v[196:199], v[232:235], v[132:135], v[196:199]
ds_read_b64_tr_b16 v[254:255], v7 offset:27200
s_waitcnt lgkmcnt(8)
v_mfma_f32_16x16x32_bf16 v[200:203], v[236:239], v[128:131], v[200:203]
ds_read_b64_tr_b16 v[232:233], v7 offset:23648
v_mfma_f32_16x16x32_bf16 v[204:207], v[236:239], v[132:135], v[204:207]
ds_read_b64_tr_b16 v[234:235], v7 offset:27232
s_waitcnt lgkmcnt(8)
v_mfma_f32_16x16x32_bf16 v[208:211], v[240:243], v[128:131], v[208:211]
ds_read_b64_tr_b16 v[236:237], v7 offset:23680
v_mfma_f32_16x16x32_bf16 v[212:215], v[240:243], v[132:135], v[212:215]
ds_read_b64_tr_b16 v[238:239], v7 offset:27264
s_waitcnt lgkmcnt(8)
v_mfma_f32_16x16x32_bf16 v[160:163], v[244:247], v[136:139], v[160:163]
ds_read_b64_tr_b16 v[240:241], v7 offset:23712
v_mfma_f32_16x16x32_bf16 v[164:167], v[244:247], v[140:143], v[164:167]
ds_read_b64_tr_b16 v[242:243], v7 offset:27296
s_waitcnt lgkmcnt(8)
v_mfma_f32_16x16x32_bf16 v[168:171], v[248:251], v[136:139], v[168:171]
ds_read_b64_tr_b16 v[244:245], v7 offset:23744
v_mfma_f32_16x16x32_bf16 v[172:175], v[248:251], v[140:143], v[172:175]
ds_read_b64_tr_b16 v[246:247], v7 offset:27328
s_waitcnt lgkmcnt(8)
s_barrier
v_mfma_f32_16x16x32_bf16 v[176:179], v[252:255], v[136:139], v[176:179]
ds_read_b64_tr_b16 v[248:249], v6 offset:0
v_mfma_f32_16x16x32_bf16 v[180:183], v[252:255], v[140:143], v[180:183]
ds_read_b64_tr_b16 v[250:251], v6 offset:3584
s_waitcnt lgkmcnt(8)
v_mfma_f32_16x16x32_bf16 v[184:187], v[232:235], v[136:139], v[184:187]
ds_read_b64_tr_b16 v[252:253], v6 offset:32
Lpad6885:
s_cbranch_execz Lback0
v_mfma_f32_16x16x32_bf16 v[188:191], v[232:235], v[140:143], v[188:191]
ds_read_b64_tr_b16 v[254:255], v6 offset:3616
s_waitcnt lgkmcnt(8)
v_mfma_f32_16x16x32_bf16 v[192:195], v[236:239], v[136:139], v[192:195]
ds_read_b64_tr_b16 v[232:233], v6 offset:64
v_mfma_f32_16x16x32_bf16 v[196:199], v[236:239], v[140:143], v[196:199]
ds_read_b64_tr_b16 v[234:235], v6 offset:3648
s_waitcnt lgkmcnt(8)
v_mfma_f32_16x16x32_bf16 v[200:203], v[240:243], v[136:139], v[200:203]
ds_read_b64_tr_b16 v[236:237], v6 offset:96
v_mfma_f32_16x16x32_bf16 v[204:207], v[240:243], v[140:143], v[204:207]
ds_read_b64_tr_b16 v[238:239], v6 offset:3680
s_waitcnt lgkmcnt(8)
v_mfma_f32_16x16x32_bf16 v[208:211], v[244:247], v[136:139], v[208:211]
ds_read_b64_tr_b16 v[240:241], v6 offset:128
v_mfma_f32_16x16x32_bf16 v[212:215], v[244:247], v[140:143], v[212:215]
ds_read_b64_tr_b16 v[242:243], v6 offset:3712
s_waitcnt lgkmcnt(8)
v_mfma_f32_16x16x32_bf16 v[160:163], v[248:251], v[144:147], v[160:163]
ds_read_b64_tr_b16 v[244:245], v6 offset:160
v_mfma_f32_16x16x32_bf16 v[164:167], v[248:251], v[148:151], v[164:167]
ds_read_b64_tr_b16 v[246:247], v6 offset:3744
s_waitcnt lgkmcnt(8)
v_mfma_f32_16x16x32_bf16 v[168:171], v[252:255], v[144:147], v[168:171]
ds_read_b64_tr_b16 v[248:249], v6 offset:192
v_mfma_f32_16x16x32_bf16 v[172:175], v[252:255], v[148:151], v[172:175]
ds_read_b64_tr_b16 v[250:251], v6 offset:3776
s_waitcnt lgkmcnt(8)
v_mfma_f32_16x16x32_bf16 v[176:179], v[232:235], v[144:147], v[176:179]
ds_read_b64_tr_b16 v[252:253], v6 offset:7168
v_mfma_f32_16x16x32_bf16 v[180:183], v[232:235], v[148:151], v[180:183]
ds_read_b64_tr_b16 v[254:255], v6 offset:10752
s_waitcnt lgkmcnt(8)
v_mfma_f32_16x16x32_bf16 v[184:187], v[236:239], v[144:147], v[184:187]
ds_read_b64_tr_b16 v[232:233], v6 offset:7200
v_mfma_f32_16x16x32_bf16 v[188:191], v[236:239], v[148:151], v[188:191]
ds_read_b64_tr_b16 v[234:235], v6 offset:10784
s_waitcnt lgkmcnt(8)
v_mfma_f32_16x16x32_bf16 v[192:195], v[240:243], v[144:147], v[192:195]
ds_read_b64_tr_b16 v[236:237], v6 offset:7232
v_mfma_f32_16x16x32_bf16 v[196:199], v[240:243], v[148:151], v[196:199]
ds_read_b64_tr_b16 v[238:239], v6 offset:10816
s_waitcnt lgkmcnt(8)
v_mfma_f32_16x16x32_bf16 v[200:203], v[244:247], v[144:147], v[200:203]
ds_read_b64_tr_b16 v[240:241], v6 offset:7264
v_mfma_f32_16x16x32_bf16 v[204:207], v[244:247], v[148:151], v[204:207]
ds_read_b64_tr_b16 v[242:243], v6 offset:10848
s_waitcnt lgkmcnt(8)
v_mfma_f32_16x16x32_bf16 v[208:211], v[248:251], v[144:147], v[208:211]
ds_read_b64_tr_b16 v[244:245], v6 offset:7296
v_mfma_f32_16x16x32_bf16 v[212:215], v[248:251], v[148:151], v[212:215]
ds_read_b64_tr_b16 v[246:247], v6 offset:10880
s_waitcnt lgkmcnt(8)
v_mfma_f32_16x16x32_bf16 v[160:163], v[252:255], v[152:155], v[160:163]
ds_read_b64_tr_b16 v[248:249], v6 offset:7328
v_mfma_f32_16x16x32_bf16 v[164:167], v[252:255], v[156:159], v[164:167]
ds_read_b64_tr_b16 v[250:251], v6 offset:10912
s_waitcnt lgkmcnt(8)
v_mfma_f32_16x16x32_bf16 v[168:171], v[232:235], v[152:155], v[168:171]
ds_read_b64_tr_b16 v[252:253], v6 offset:7360
v_mfma_f32_16x16x32_bf16 v[172:175], v[232:235], v[156:159], v[172:175]
ds_read_b64_tr_b16 v[254:255], v6 offset:10944
s_waitcnt lgkmcnt(8)
s_barrier
v_mfma_f32_16x16x32_bf16 v[176:179], v[236:239], v[152:155], v[176:179]
v_add_u32 v5, 1152, v5
v_mfma_f32_16x16x32_bf16 v[180:183], v[236:239], v[156:159], v[180:183]
ds_read2_b64 v[232:235], v5 offset0:0 offset1:0
s_waitcnt lgkmcnt(7)
v_mfma_f32_16x16x32_bf16 v[184:187], v[240:243], v[152:155], v[184:187]
ds_read2_b64 v[236:239], v5 offset0:16 offset1:16
Lpad6956:
s_cbranch_execz Lpad7036
v_mfma_f32_16x16x32_bf16 v[188:191], v[240:243], v[156:159], v[188:191]
s_waitcnt lgkmcnt(6)
v_mfma_f32_16x16x32_bf16 v[192:195], v[244:247], v[152:155], v[192:195]
ds_read2_b64 v[240:243], v5 offset0:32 offset1:32
v_mfma_f32_16x16x32_bf16 v[196:199], v[244:247], v[156:159], v[196:199]
s_waitcnt lgkmcnt(5)
v_mfma_f32_16x16x32_bf16 v[200:203], v[248:251], v[152:155], v[200:203]
ds_read2_b64 v[244:247], v5 offset0:48 offset1:48
v_mfma_f32_16x16x32_bf16 v[204:207], v[248:251], v[156:159], v[204:207]
s_waitcnt lgkmcnt(4)
v_mfma_f32_16x16x32_bf16 v[208:211], v[252:255], v[152:155], v[208:211]
ds_read2_b64 v[248:251], v5 offset0:64 offset1:64
v_mfma_f32_16x16x32_bf16 v[212:215], v[252:255], v[156:159], v[212:215]
s_waitcnt lgkmcnt(4)
v_mfma_f32_16x16x32_bf16 v[160:163], v[232:235], v[8:11], v[160:163]
ds_read2_b64 v[252:255], v5 offset0:80 offset1:80
v_mfma_f32_16x16x32_bf16 v[164:167], v[232:235], v[10:13], v[164:167]
s_waitcnt lgkmcnt(4)
v_mfma_f32_16x16x32_bf16 v[168:171], v[236:239], v[8:11], v[168:171]
ds_read2_b64 v[232:235], v5 offset0:96 offset1:96
v_mfma_f32_16x16x32_bf16 v[172:175], v[236:239], v[10:13], v[172:175]
s_waitcnt lgkmcnt(4)
v_mfma_f32_16x16x32_bf16 v[176:179], v[240:243], v[8:11], v[176:179]
ds_read_b64_tr_b16 v[236:237], v3 offset:18432
v_mfma_f32_16x16x32_bf16 v[180:183], v[240:243], v[10:13], v[180:183]
ds_read_b64_tr_b16 v[238:239], v3 offset:23040
s_waitcnt lgkmcnt(5)
v_mfma_f32_16x16x32_bf16 v[184:187], v[244:247], v[8:11], v[184:187]
ds_read_b64_tr_b16 v[240:241], v3 offset:18464
ds_read_b64_tr_b16 v[242:243], v3 offset:23072
v_mul_f32 v160, v14, v160
v_mul_f32 v161, v14, v161
v_mul_f32 v162, v14, v162
v_mul_f32 v163, v14, v163
v_mul_f32 v164, v15, v164
v_mul_f32 v165, v15, v165
v_mfma_f32_16x16x32_bf16 v[188:191], v[244:247], v[10:13], v[188:191]
v_mul_f32 v166, v15, v166
v_mul_f32 v167, v15, v167
v_cvt_pk_bf16_f32 v160, v160, v161
v_cvt_pk_bf16_f32 v161, v162, v163
v_cvt_pk_bf16_f32 v162, v164, v165
v_cvt_pk_bf16_f32 v163, v166, v167
ds_write_b128 v0, v[160:163] offset:0
s_waitcnt lgkmcnt(7)
v_mfma_f32_16x16x32_bf16 v[192:195], v[248:251], v[8:11], v[192:195]
ds_read_b64_tr_b16 v[244:245], v3 offset:18496
ds_read_b64_tr_b16 v[246:247], v3 offset:23104
v_mul_f32 v168, v14, v168
v_mul_f32 v169, v14, v169
v_mul_f32 v170, v14, v170
v_mul_f32 v171, v14, v171
v_mul_f32 v172, v15, v172
v_mul_f32 v173, v15, v173
v_mfma_f32_16x16x32_bf16 v[196:199], v[248:251], v[10:13], v[196:199]
v_mul_f32 v174, v15, v174
v_mul_f32 v175, v15, v175
v_cvt_pk_bf16_f32 v168, v168, v169
v_cvt_pk_bf16_f32 v169, v170, v171
v_cvt_pk_bf16_f32 v170, v172, v173
v_cvt_pk_bf16_f32 v171, v174, v175
ds_write_b128 v0, v[168:171] offset:1024
s_waitcnt lgkmcnt(9)
v_mfma_f32_16x16x32_bf16 v[200:203], v[252:255], v[8:11], v[200:203]
ds_read_b64_tr_b16 v[248:249], v3 offset:18528
ds_read_b64_tr_b16 v[250:251], v3 offset:23136
v_mul_f32 v176, v14, v176
v_mul_f32 v177, v14, v177
v_mul_f32 v178, v14, v178
v_mul_f32 v179, v14, v179
v_mul_f32 v180, v15, v180
v_mul_f32 v181, v15, v181
v_mfma_f32_16x16x32_bf16 v[204:207], v[252:255], v[10:13], v[204:207]
v_mul_f32 v182, v15, v182
v_mul_f32 v183, v15, v183
v_cvt_pk_bf16_f32 v176, v176, v177
v_cvt_pk_bf16_f32 v177, v178, v179
v_cvt_pk_bf16_f32 v178, v180, v181
v_cvt_pk_bf16_f32 v179, v182, v183
ds_write_b128 v0, v[176:179] offset:2048
Lpad7036:
s_cbranch_execz Lpad7118
s_waitcnt lgkmcnt(11)
v_mfma_f32_16x16x32_bf16 v[208:211], v[232:235], v[8:11], v[208:211]
ds_read_b64_tr_b16 v[252:253], v3 offset:18560
ds_read_b64_tr_b16 v[254:255], v3 offset:23168
v_mul_f32 v184, v14, v184
v_mul_f32 v185, v14, v185
v_mul_f32 v186, v14, v186
v_mul_f32 v187, v14, v187
v_mul_f32 v188, v15, v188
v_mul_f32 v189, v15, v189
v_mfma_f32_16x16x32_bf16 v[212:215], v[232:235], v[10:13], v[212:215]
v_mul_f32 v190, v15, v190
v_mul_f32 v191, v15, v191
v_cvt_pk_bf16_f32 v184, v184, v185
v_cvt_pk_bf16_f32 v185, v186, v187
v_cvt_pk_bf16_f32 v186, v188, v189
v_cvt_pk_bf16_f32 v187, v190, v191
ds_write_b128 v0, v[184:187] offset:3072
s_waitcnt lgkmcnt(12)
v_mfma_f32_16x16x32_bf16 v[160:163], v[236:239], v[16:19], 0
ds_read_b64_tr_b16 v[232:233], v3 offset:18592
ds_read_b64_tr_b16 v[234:235], v3 offset:23200
v_mul_f32 v192, v14, v192
v_mul_f32 v193, v14, v193
v_mul_f32 v194, v14, v194
v_mul_f32 v195, v14, v195
v_mul_f32 v196, v15, v196
v_mul_f32 v197, v15, v197
v_mfma_f32_16x16x32_bf16 v[164:167], v[236:239], v[20:23], 0
v_mul_f32 v198, v15, v198
v_mul_f32 v199, v15, v199
v_cvt_pk_bf16_f32 v192, v192, v193
v_cvt_pk_bf16_f32 v193, v194, v195
v_cvt_pk_bf16_f32 v194, v196, v197
v_cvt_pk_bf16_f32 v195, v198, v199
ds_write_b128 v0, v[192:195] offset:4096
s_waitcnt lgkmcnt(13)
v_mfma_f32_16x16x32_bf16 v[168:171], v[240:243], v[16:19], 0
ds_read_b64_tr_b16 v[236:237], v3 offset:18624
ds_read_b64_tr_b16 v[238:239], v3 offset:23232
v_mul_f32 v200, v14, v200
v_mul_f32 v201, v14, v201
v_mul_f32 v202, v14, v202
v_mul_f32 v203, v14, v203
v_mul_f32 v204, v15, v204
v_mul_f32 v205, v15, v205
v_mfma_f32_16x16x32_bf16 v[172:175], v[240:243], v[20:23], 0
v_mul_f32 v206, v15, v206
v_mul_f32 v207, v15, v207
v_cvt_pk_bf16_f32 v200, v200, v201
v_cvt_pk_bf16_f32 v201, v202, v203
v_cvt_pk_bf16_f32 v202, v204, v205
v_cvt_pk_bf16_f32 v203, v206, v207
ds_write_b128 v0, v[200:203] offset:5120
s_waitcnt lgkmcnt(13)
v_mfma_f32_16x16x32_bf16 v[176:179], v[244:247], v[16:19], 0
ds_read_b64_tr_b16 v[240:241], v3 offset:18656
ds_read_b64_tr_b16 v[242:243], v3 offset:23264
v_mul_f32 v208, v14, v208
v_mul_f32 v209, v14, v209
v_mul_f32 v210, v14, v210
v_mul_f32 v211, v14, v211
v_mul_f32 v212, v15, v212
v_mul_f32 v213, v15, v213
v_mfma_f32_16x16x32_bf16 v[180:183], v[244:247], v[20:23], 0
v_mul_f32 v214, v15, v214
v_mul_f32 v215, v15, v215
v_cvt_pk_bf16_f32 v208, v208, v209
v_cvt_pk_bf16_f32 v209, v210, v211
v_cvt_pk_bf16_f32 v210, v212, v213
v_cvt_pk_bf16_f32 v211, v214, v215
ds_write_b128 v0, v[208:211] offset:6144
s_waitcnt lgkmcnt(13)
v_mfma_f32_16x16x32_bf16 v[184:187], v[248:251], v[16:19], 0
ds_read_b64_tr_b16 v[244:245], v3 offset:18688
v_mfma_f32_16x16x32_bf16 v[188:191], v[248:251], v[20:23], 0
ds_read_b64_tr_b16 v[246:247], v3 offset:23296
s_waitcnt lgkmcnt(12)
v_mfma_f32_16x16x32_bf16 v[192:195], v[252:255], v[16:19], 0
ds_read_b64_tr_b16 v[248:249], v3 offset:27648
v_mfma_f32_16x16x32_bf16 v[196:199], v[252:255], v[20:23], 0
ds_read_b64_tr_b16 v[250:251], v3 offset:32256
Lpad7118:
s_cbranch_execz Lpad7189
s_waitcnt lgkmcnt(11)
v_mfma_f32_16x16x32_bf16 v[200:203], v[232:235], v[16:19], 0
ds_read_b64_tr_b16 v[252:253], v3 offset:27680
v_mfma_f32_16x16x32_bf16 v[204:207], v[232:235], v[20:23], 0
ds_read_b64_tr_b16 v[254:255], v3 offset:32288
s_waitcnt lgkmcnt(10)
v_mfma_f32_16x16x32_bf16 v[208:211], v[236:239], v[16:19], 0
ds_read_b64_tr_b16 v[232:233], v3 offset:27712
v_mfma_f32_16x16x32_bf16 v[212:215], v[236:239], v[20:23], 0
ds_read_b64_tr_b16 v[234:235], v3 offset:32320
s_waitcnt lgkmcnt(9)
v_mfma_f32_16x16x32_bf16 v[216:219], v[240:243], v[16:19], 0
ds_read_b64_tr_b16 v[236:237], v3 offset:27744
v_mfma_f32_16x16x32_bf16 v[220:223], v[240:243], v[20:23], 0
ds_read_b64_tr_b16 v[238:239], v3 offset:32352
s_waitcnt lgkmcnt(8)
v_mfma_f32_16x16x32_bf16 v[224:227], v[244:247], v[16:19], 0
ds_read_b64_tr_b16 v[240:241], v3 offset:27776
v_mfma_f32_16x16x32_bf16 v[228:231], v[244:247], v[20:23], 0
ds_read_b64_tr_b16 v[242:243], v3 offset:32384
s_waitcnt lgkmcnt(8)
v_mfma_f32_16x16x32_bf16 v[160:163], v[248:251], v[24:27], v[160:163]
ds_read_b64_tr_b16 v[244:245], v3 offset:27808
v_mfma_f32_16x16x32_bf16 v[164:167], v[248:251], v[28:31], v[164:167]
ds_read_b64_tr_b16 v[246:247], v3 offset:32416
s_waitcnt lgkmcnt(8)
v_mfma_f32_16x16x32_bf16 v[168:171], v[252:255], v[24:27], v[168:171]
ds_read_b64_tr_b16 v[248:249], v3 offset:27840
v_mfma_f32_16x16x32_bf16 v[172:175], v[252:255], v[28:31], v[172:175]
ds_read_b64_tr_b16 v[250:251], v3 offset:32448
s_waitcnt lgkmcnt(8)
v_mfma_f32_16x16x32_bf16 v[176:179], v[232:235], v[24:27], v[176:179]
ds_read_b64_tr_b16 v[252:253], v3 offset:27872
v_mfma_f32_16x16x32_bf16 v[180:183], v[232:235], v[28:31], v[180:183]
ds_read_b64_tr_b16 v[254:255], v3 offset:32480
s_waitcnt lgkmcnt(8)
v_mfma_f32_16x16x32_bf16 v[184:187], v[236:239], v[24:27], v[184:187]
ds_read_b64_tr_b16 v[232:233], v3 offset:27904
v_mfma_f32_16x16x32_bf16 v[188:191], v[236:239], v[28:31], v[188:191]
ds_read_b64_tr_b16 v[234:235], v3 offset:32512
s_waitcnt lgkmcnt(8)
s_barrier
v_mfma_f32_16x16x32_bf16 v[192:195], v[240:243], v[24:27], v[192:195]
ds_read_b64_tr_b16 v[236:237], v3 offset:36864
v_mfma_f32_16x16x32_bf16 v[196:199], v[240:243], v[28:31], v[196:199]
ds_read_b64_tr_b16 v[238:239], v3 offset:41472
s_waitcnt lgkmcnt(8)
v_mfma_f32_16x16x32_bf16 v[200:203], v[244:247], v[24:27], v[200:203]
ds_read_b64_tr_b16 v[240:241], v3 offset:36896
v_mfma_f32_16x16x32_bf16 v[204:207], v[244:247], v[28:31], v[204:207]
ds_read_b64_tr_b16 v[242:243], v3 offset:41504
s_waitcnt lgkmcnt(8)
v_mfma_f32_16x16x32_bf16 v[208:211], v[248:251], v[24:27], v[208:211]
ds_read_b64_tr_b16 v[244:245], v3 offset:36928
v_mfma_f32_16x16x32_bf16 v[212:215], v[248:251], v[28:31], v[212:215]
ds_read_b64_tr_b16 v[246:247], v3 offset:41536
s_waitcnt lgkmcnt(8)
v_mfma_f32_16x16x32_bf16 v[216:219], v[252:255], v[24:27], v[216:219]
ds_read_b64_tr_b16 v[248:249], v3 offset:36960
v_mfma_f32_16x16x32_bf16 v[220:223], v[252:255], v[28:31], v[220:223]
ds_read_b64_tr_b16 v[250:251], v3 offset:41568
s_waitcnt lgkmcnt(8)
v_mfma_f32_16x16x32_bf16 v[224:227], v[232:235], v[24:27], v[224:227]
ds_read_b64_tr_b16 v[252:253], v3 offset:36992
v_mfma_f32_16x16x32_bf16 v[228:231], v[232:235], v[28:31], v[228:231]
ds_read_b64_tr_b16 v[254:255], v3 offset:41600
s_waitcnt lgkmcnt(8)
v_mfma_f32_16x16x32_bf16 v[160:163], v[236:239], v[32:35], v[160:163]
ds_read_b64_tr_b16 v[232:233], v3 offset:37024
v_mfma_f32_16x16x32_bf16 v[164:167], v[236:239], v[36:39], v[164:167]
ds_read_b64_tr_b16 v[234:235], v3 offset:41632
Lpad7189:
s_cbranch_execz Lpad7260
s_waitcnt lgkmcnt(8)
v_mfma_f32_16x16x32_bf16 v[168:171], v[240:243], v[32:35], v[168:171]
ds_read_b64_tr_b16 v[236:237], v3 offset:37056
v_mfma_f32_16x16x32_bf16 v[172:175], v[240:243], v[36:39], v[172:175]
ds_read_b64_tr_b16 v[238:239], v3 offset:41664
s_waitcnt lgkmcnt(8)
v_mfma_f32_16x16x32_bf16 v[176:179], v[244:247], v[32:35], v[176:179]
ds_read_b64_tr_b16 v[240:241], v3 offset:37088
v_mfma_f32_16x16x32_bf16 v[180:183], v[244:247], v[36:39], v[180:183]
ds_read_b64_tr_b16 v[242:243], v3 offset:41696
s_waitcnt lgkmcnt(8)
v_mfma_f32_16x16x32_bf16 v[184:187], v[248:251], v[32:35], v[184:187]
ds_read_b64_tr_b16 v[244:245], v3 offset:37120
v_mfma_f32_16x16x32_bf16 v[188:191], v[248:251], v[36:39], v[188:191]
ds_read_b64_tr_b16 v[246:247], v3 offset:41728
s_waitcnt lgkmcnt(8)
v_mfma_f32_16x16x32_bf16 v[192:195], v[252:255], v[32:35], v[192:195]
ds_read_b64_tr_b16 v[248:249], v3 offset:46080
v_mfma_f32_16x16x32_bf16 v[196:199], v[252:255], v[36:39], v[196:199]
ds_read_b64_tr_b16 v[250:251], v3 offset:50688
s_waitcnt lgkmcnt(8)
v_mfma_f32_16x16x32_bf16 v[200:203], v[232:235], v[32:35], v[200:203]
ds_read_b64_tr_b16 v[252:253], v3 offset:46112
v_mfma_f32_16x16x32_bf16 v[204:207], v[232:235], v[36:39], v[204:207]
ds_read_b64_tr_b16 v[254:255], v3 offset:50720
s_waitcnt lgkmcnt(8)
v_mfma_f32_16x16x32_bf16 v[208:211], v[236:239], v[32:35], v[208:211]
ds_read_b64_tr_b16 v[232:233], v3 offset:46144
v_mfma_f32_16x16x32_bf16 v[212:215], v[236:239], v[36:39], v[212:215]
ds_read_b64_tr_b16 v[234:235], v3 offset:50752
s_waitcnt lgkmcnt(8)
v_mfma_f32_16x16x32_bf16 v[216:219], v[240:243], v[32:35], v[216:219]
ds_read_b64_tr_b16 v[236:237], v3 offset:46176
v_mfma_f32_16x16x32_bf16 v[220:223], v[240:243], v[36:39], v[220:223]
ds_read_b64_tr_b16 v[238:239], v3 offset:50784
s_waitcnt lgkmcnt(8)
v_mfma_f32_16x16x32_bf16 v[224:227], v[244:247], v[32:35], v[224:227]
ds_read_b64_tr_b16 v[240:241], v3 offset:46208
v_mfma_f32_16x16x32_bf16 v[228:231], v[244:247], v[36:39], v[228:231]
ds_read_b64_tr_b16 v[242:243], v3 offset:50816
s_waitcnt lgkmcnt(8)
v_mfma_f32_16x16x32_bf16 v[160:163], v[248:251], v[40:43], v[160:163]
ds_read_b64_tr_b16 v[244:245], v3 offset:46240
v_mfma_f32_16x16x32_bf16 v[164:167], v[248:251], v[44:47], v[164:167]
ds_read_b64_tr_b16 v[246:247], v3 offset:50848
s_waitcnt lgkmcnt(8)
v_mfma_f32_16x16x32_bf16 v[168:171], v[252:255], v[40:43], v[168:171]
ds_read_b64_tr_b16 v[248:249], v3 offset:46272
v_mfma_f32_16x16x32_bf16 v[172:175], v[252:255], v[44:47], v[172:175]
ds_read_b64_tr_b16 v[250:251], v3 offset:50880
s_waitcnt lgkmcnt(8)
v_mfma_f32_16x16x32_bf16 v[176:179], v[232:235], v[40:43], v[176:179]
ds_read_b64_tr_b16 v[252:253], v3 offset:46304
v_mfma_f32_16x16x32_bf16 v[180:183], v[232:235], v[44:47], v[180:183]
ds_read_b64_tr_b16 v[254:255], v3 offset:50912
s_waitcnt lgkmcnt(8)
v_mfma_f32_16x16x32_bf16 v[184:187], v[236:239], v[40:43], v[184:187]
ds_read_b64_tr_b16 v[232:233], v3 offset:46336
v_mfma_f32_16x16x32_bf16 v[188:191], v[236:239], v[44:47], v[188:191]
ds_read_b64_tr_b16 v[234:235], v3 offset:50944
s_waitcnt lgkmcnt(8)
s_barrier
v_mfma_f32_16x16x32_bf16 v[192:195], v[240:243], v[40:43], v[192:195]
ds_read_b64_tr_b16 v[236:237], v3 offset:55296
v_mfma_f32_16x16x32_bf16 v[196:199], v[240:243], v[44:47], v[196:199]
ds_read_b64_tr_b16 v[238:239], v4 offset:2560
s_waitcnt lgkmcnt(8)
v_mfma_f32_16x16x32_bf16 v[200:203], v[244:247], v[40:43], v[200:203]
ds_read_b64_tr_b16 v[240:241], v3 offset:55328
v_mfma_f32_16x16x32_bf16 v[204:207], v[244:247], v[44:47], v[204:207]
ds_read_b64_tr_b16 v[242:243], v4 offset:2592
Lpad7260:
s_cbranch_execz Lpad7331
s_waitcnt lgkmcnt(8)
v_mfma_f32_16x16x32_bf16 v[208:211], v[248:251], v[40:43], v[208:211]
ds_read_b64_tr_b16 v[244:245], v3 offset:55360
v_mfma_f32_16x16x32_bf16 v[212:215], v[248:251], v[44:47], v[212:215]
ds_read_b64_tr_b16 v[246:247], v4 offset:2624
s_waitcnt lgkmcnt(8)
v_mfma_f32_16x16x32_bf16 v[216:219], v[252:255], v[40:43], v[216:219]
ds_read_b64_tr_b16 v[248:249], v3 offset:55392
v_mfma_f32_16x16x32_bf16 v[220:223], v[252:255], v[44:47], v[220:223]
ds_read_b64_tr_b16 v[250:251], v4 offset:2656
s_waitcnt lgkmcnt(8)
v_mfma_f32_16x16x32_bf16 v[224:227], v[232:235], v[40:43], v[224:227]
ds_read_b64_tr_b16 v[252:253], v3 offset:55424
v_mfma_f32_16x16x32_bf16 v[228:231], v[232:235], v[44:47], v[228:231]
ds_read_b64_tr_b16 v[254:255], v4 offset:2688
s_waitcnt lgkmcnt(8)
v_mfma_f32_16x16x32_bf16 v[160:163], v[236:239], v[48:51], v[160:163]
ds_read_b64_tr_b16 v[232:233], v3 offset:55456
v_mfma_f32_16x16x32_bf16 v[164:167], v[236:239], v[52:55], v[164:167]
ds_read_b64_tr_b16 v[234:235], v4 offset:2720
s_waitcnt lgkmcnt(8)
v_mfma_f32_16x16x32_bf16 v[168:171], v[240:243], v[48:51], v[168:171]
ds_read_b64_tr_b16 v[236:237], v3 offset:55488
v_mfma_f32_16x16x32_bf16 v[172:175], v[240:243], v[52:55], v[172:175]
ds_read_b64_tr_b16 v[238:239], v4 offset:2752
s_waitcnt lgkmcnt(8)
v_mfma_f32_16x16x32_bf16 v[176:179], v[244:247], v[48:51], v[176:179]
ds_read_b64_tr_b16 v[240:241], v3 offset:55520
v_mfma_f32_16x16x32_bf16 v[180:183], v[244:247], v[52:55], v[180:183]
ds_read_b64_tr_b16 v[242:243], v4 offset:2784
s_waitcnt lgkmcnt(8)
v_mfma_f32_16x16x32_bf16 v[184:187], v[248:251], v[48:51], v[184:187]
ds_read_b64_tr_b16 v[244:245], v3 offset:55552
v_mfma_f32_16x16x32_bf16 v[188:191], v[248:251], v[52:55], v[188:191]
ds_read_b64_tr_b16 v[246:247], v4 offset:2816
s_waitcnt lgkmcnt(8)
v_mfma_f32_16x16x32_bf16 v[192:195], v[252:255], v[48:51], v[192:195]
ds_read_b64_tr_b16 v[248:249], v4 offset:7168
v_mfma_f32_16x16x32_bf16 v[196:199], v[252:255], v[52:55], v[196:199]
ds_read_b64_tr_b16 v[250:251], v4 offset:11776
s_waitcnt lgkmcnt(8)
v_mfma_f32_16x16x32_bf16 v[200:203], v[232:235], v[48:51], v[200:203]
ds_read_b64_tr_b16 v[252:253], v4 offset:7200
v_mfma_f32_16x16x32_bf16 v[204:207], v[232:235], v[52:55], v[204:207]
ds_read_b64_tr_b16 v[254:255], v4 offset:11808
s_waitcnt lgkmcnt(8)
v_mfma_f32_16x16x32_bf16 v[208:211], v[236:239], v[48:51], v[208:211]
ds_read_b64_tr_b16 v[232:233], v4 offset:7232
v_mfma_f32_16x16x32_bf16 v[212:215], v[236:239], v[52:55], v[212:215]
ds_read_b64_tr_b16 v[234:235], v4 offset:11840
s_waitcnt lgkmcnt(8)
v_mfma_f32_16x16x32_bf16 v[216:219], v[240:243], v[48:51], v[216:219]
ds_read_b64_tr_b16 v[236:237], v4 offset:7264
v_mfma_f32_16x16x32_bf16 v[220:223], v[240:243], v[52:55], v[220:223]
ds_read_b64_tr_b16 v[238:239], v4 offset:11872
s_waitcnt lgkmcnt(8)
v_mfma_f32_16x16x32_bf16 v[224:227], v[244:247], v[48:51], v[224:227]
ds_read_b64_tr_b16 v[240:241], v4 offset:7296
v_mfma_f32_16x16x32_bf16 v[228:231], v[244:247], v[52:55], v[228:231]
ds_read_b64_tr_b16 v[242:243], v4 offset:11904
s_waitcnt lgkmcnt(8)
v_mfma_f32_16x16x32_bf16 v[160:163], v[248:251], v[56:59], v[160:163]
ds_read_b64_tr_b16 v[244:245], v4 offset:7328
v_mfma_f32_16x16x32_bf16 v[164:167], v[248:251], v[60:63], v[164:167]
ds_read_b64_tr_b16 v[246:247], v4 offset:11936
s_waitcnt lgkmcnt(8)
v_mfma_f32_16x16x32_bf16 v[168:171], v[252:255], v[56:59], v[168:171]
ds_read_b64_tr_b16 v[248:249], v4 offset:7360
v_mfma_f32_16x16x32_bf16 v[172:175], v[252:255], v[60:63], v[172:175]
ds_read_b64_tr_b16 v[250:251], v4 offset:11968
s_waitcnt lgkmcnt(8)
Lpad7331:
s_cbranch_execz Lpad7402
v_mfma_f32_16x16x32_bf16 v[176:179], v[232:235], v[56:59], v[176:179]
ds_read_b64_tr_b16 v[252:253], v4 offset:7392
v_mfma_f32_16x16x32_bf16 v[180:183], v[232:235], v[60:63], v[180:183]
ds_read_b64_tr_b16 v[254:255], v4 offset:12000
s_waitcnt lgkmcnt(8)
v_mfma_f32_16x16x32_bf16 v[184:187], v[236:239], v[56:59], v[184:187]
ds_read_b64_tr_b16 v[232:233], v4 offset:7424
v_mfma_f32_16x16x32_bf16 v[188:191], v[236:239], v[60:63], v[188:191]
ds_read_b64_tr_b16 v[234:235], v4 offset:12032
s_waitcnt lgkmcnt(8)
s_barrier
v_mfma_f32_16x16x32_bf16 v[192:195], v[240:243], v[56:59], v[192:195]
ds_read_b64_tr_b16 v[236:237], v4 offset:16384
v_mfma_f32_16x16x32_bf16 v[196:199], v[240:243], v[60:63], v[196:199]
ds_read_b64_tr_b16 v[238:239], v4 offset:20992
s_waitcnt lgkmcnt(8)
v_mfma_f32_16x16x32_bf16 v[200:203], v[244:247], v[56:59], v[200:203]
ds_read_b64_tr_b16 v[240:241], v4 offset:16416
v_mfma_f32_16x16x32_bf16 v[204:207], v[244:247], v[60:63], v[204:207]
ds_read_b64_tr_b16 v[242:243], v4 offset:21024
s_waitcnt lgkmcnt(8)
v_mfma_f32_16x16x32_bf16 v[208:211], v[248:251], v[56:59], v[208:211]
ds_read_b64_tr_b16 v[244:245], v4 offset:16448
v_mfma_f32_16x16x32_bf16 v[212:215], v[248:251], v[60:63], v[212:215]
ds_read_b64_tr_b16 v[246:247], v4 offset:21056
s_waitcnt lgkmcnt(8)
v_mfma_f32_16x16x32_bf16 v[216:219], v[252:255], v[56:59], v[216:219]
ds_read_b64_tr_b16 v[248:249], v4 offset:16480
v_mfma_f32_16x16x32_bf16 v[220:223], v[252:255], v[60:63], v[220:223]
ds_read_b64_tr_b16 v[250:251], v4 offset:21088
s_waitcnt lgkmcnt(8)
v_mfma_f32_16x16x32_bf16 v[224:227], v[232:235], v[56:59], v[224:227]
ds_read_b64_tr_b16 v[252:253], v4 offset:16512
v_mfma_f32_16x16x32_bf16 v[228:231], v[232:235], v[60:63], v[228:231]
ds_read_b64_tr_b16 v[254:255], v4 offset:21120
s_waitcnt lgkmcnt(8)
v_mfma_f32_16x16x32_bf16 v[160:163], v[236:239], v[64:67], v[160:163]
ds_read_b64_tr_b16 v[232:233], v4 offset:16544
v_mfma_f32_16x16x32_bf16 v[164:167], v[236:239], v[68:71], v[164:167]
ds_read_b64_tr_b16 v[234:235], v4 offset:21152
s_waitcnt lgkmcnt(8)
v_mfma_f32_16x16x32_bf16 v[168:171], v[240:243], v[64:67], v[168:171]
ds_read_b64_tr_b16 v[236:237], v4 offset:16576
v_mfma_f32_16x16x32_bf16 v[172:175], v[240:243], v[68:71], v[172:175]
ds_read_b64_tr_b16 v[238:239], v4 offset:21184
s_waitcnt lgkmcnt(8)
v_mfma_f32_16x16x32_bf16 v[176:179], v[244:247], v[64:67], v[176:179]
ds_read_b64_tr_b16 v[240:241], v4 offset:16608
v_mfma_f32_16x16x32_bf16 v[180:183], v[244:247], v[68:71], v[180:183]
ds_read_b64_tr_b16 v[242:243], v4 offset:21216
s_waitcnt lgkmcnt(8)
v_mfma_f32_16x16x32_bf16 v[184:187], v[248:251], v[64:67], v[184:187]
ds_read_b64_tr_b16 v[244:245], v4 offset:16640
v_mfma_f32_16x16x32_bf16 v[188:191], v[248:251], v[68:71], v[188:191]
ds_read_b64_tr_b16 v[246:247], v4 offset:21248
s_waitcnt lgkmcnt(8)
v_mfma_f32_16x16x32_bf16 v[192:195], v[252:255], v[64:67], v[192:195]
ds_read_b64_tr_b16 v[248:249], v4 offset:25600
v_mfma_f32_16x16x32_bf16 v[196:199], v[252:255], v[68:71], v[196:199]
ds_read_b64_tr_b16 v[250:251], v4 offset:30208
s_waitcnt lgkmcnt(8)
v_mfma_f32_16x16x32_bf16 v[200:203], v[232:235], v[64:67], v[200:203]
ds_read_b64_tr_b16 v[252:253], v4 offset:25632
v_mfma_f32_16x16x32_bf16 v[204:207], v[232:235], v[68:71], v[204:207]
ds_read_b64_tr_b16 v[254:255], v4 offset:30240
s_waitcnt lgkmcnt(8)
v_mfma_f32_16x16x32_bf16 v[208:211], v[236:239], v[64:67], v[208:211]
ds_read_b64_tr_b16 v[232:233], v4 offset:25664
v_mfma_f32_16x16x32_bf16 v[212:215], v[236:239], v[68:71], v[212:215]
ds_read_b64_tr_b16 v[234:235], v4 offset:30272
s_waitcnt lgkmcnt(8)
Lpad7402:
s_cbranch_execz Lpad7473
v_mfma_f32_16x16x32_bf16 v[216:219], v[240:243], v[64:67], v[216:219]
ds_read_b64_tr_b16 v[236:237], v4 offset:25696
v_mfma_f32_16x16x32_bf16 v[220:223], v[240:243], v[68:71], v[220:223]
ds_read_b64_tr_b16 v[238:239], v4 offset:30304
s_waitcnt lgkmcnt(8)
v_mfma_f32_16x16x32_bf16 v[224:227], v[244:247], v[64:67], v[224:227]
ds_read_b64_tr_b16 v[240:241], v4 offset:25728
v_mfma_f32_16x16x32_bf16 v[228:231], v[244:247], v[68:71], v[228:231]
ds_read_b64_tr_b16 v[242:243], v4 offset:30336
s_waitcnt lgkmcnt(8)
v_mfma_f32_16x16x32_bf16 v[160:163], v[248:251], v[72:75], v[160:163]
ds_read_b64_tr_b16 v[244:245], v4 offset:25760
v_mfma_f32_16x16x32_bf16 v[164:167], v[248:251], v[76:79], v[164:167]
ds_read_b64_tr_b16 v[246:247], v4 offset:30368
s_waitcnt lgkmcnt(8)
v_mfma_f32_16x16x32_bf16 v[168:171], v[252:255], v[72:75], v[168:171]
ds_read_b64_tr_b16 v[248:249], v4 offset:25792
v_mfma_f32_16x16x32_bf16 v[172:175], v[252:255], v[76:79], v[172:175]
ds_read_b64_tr_b16 v[250:251], v4 offset:30400
s_waitcnt lgkmcnt(8)
v_mfma_f32_16x16x32_bf16 v[176:179], v[232:235], v[72:75], v[176:179]
ds_read_b64_tr_b16 v[252:253], v4 offset:25824
v_mfma_f32_16x16x32_bf16 v[180:183], v[232:235], v[76:79], v[180:183]
ds_read_b64_tr_b16 v[254:255], v4 offset:30432
s_waitcnt lgkmcnt(8)
v_mfma_f32_16x16x32_bf16 v[184:187], v[236:239], v[72:75], v[184:187]
ds_read_b64_tr_b16 v[232:233], v4 offset:25856
v_mfma_f32_16x16x32_bf16 v[188:191], v[236:239], v[76:79], v[188:191]
ds_read_b64_tr_b16 v[234:235], v4 offset:30464
s_waitcnt lgkmcnt(8)
s_barrier
v_mfma_f32_16x16x32_bf16 v[192:195], v[240:243], v[72:75], v[192:195]
ds_read_b64_tr_b16 v[236:237], v3 offset:0
v_mfma_f32_16x16x32_bf16 v[196:199], v[240:243], v[76:79], v[196:199]
ds_read_b64_tr_b16 v[238:239], v3 offset:4608
s_waitcnt lgkmcnt(8)
v_mfma_f32_16x16x32_bf16 v[200:203], v[244:247], v[72:75], v[200:203]
ds_read_b64_tr_b16 v[240:241], v3 offset:32
v_mfma_f32_16x16x32_bf16 v[204:207], v[244:247], v[76:79], v[204:207]
ds_read_b64_tr_b16 v[242:243], v3 offset:4640
s_waitcnt lgkmcnt(8)
v_mfma_f32_16x16x32_bf16 v[208:211], v[248:251], v[72:75], v[208:211]
ds_read_b64_tr_b16 v[244:245], v3 offset:64
v_mfma_f32_16x16x32_bf16 v[212:215], v[248:251], v[76:79], v[212:215]
ds_read_b64_tr_b16 v[246:247], v3 offset:4672
s_waitcnt lgkmcnt(8)
v_mfma_f32_16x16x32_bf16 v[216:219], v[252:255], v[72:75], v[216:219]
ds_read_b64_tr_b16 v[248:249], v3 offset:96
v_mfma_f32_16x16x32_bf16 v[220:223], v[252:255], v[76:79], v[220:223]
ds_read_b64_tr_b16 v[250:251], v3 offset:4704
s_waitcnt lgkmcnt(8)
v_mfma_f32_16x16x32_bf16 v[224:227], v[232:235], v[72:75], v[224:227]
ds_read_b64_tr_b16 v[252:253], v3 offset:128
v_mfma_f32_16x16x32_bf16 v[228:231], v[232:235], v[76:79], v[228:231]
ds_read_b64_tr_b16 v[254:255], v3 offset:4736
s_waitcnt lgkmcnt(8)
v_mfma_f32_16x16x32_bf16 v[160:163], v[236:239], v[80:83], v[160:163]
ds_read_b64_tr_b16 v[232:233], v3 offset:160
v_mfma_f32_16x16x32_bf16 v[164:167], v[236:239], v[84:87], v[164:167]
ds_read_b64_tr_b16 v[234:235], v3 offset:4768
s_waitcnt lgkmcnt(8)
v_mfma_f32_16x16x32_bf16 v[168:171], v[240:243], v[80:83], v[168:171]
ds_read_b64_tr_b16 v[236:237], v3 offset:192
v_mfma_f32_16x16x32_bf16 v[172:175], v[240:243], v[84:87], v[172:175]
ds_read_b64_tr_b16 v[238:239], v3 offset:4800
s_waitcnt lgkmcnt(8)
v_mfma_f32_16x16x32_bf16 v[176:179], v[244:247], v[80:83], v[176:179]
ds_read_b64_tr_b16 v[240:241], v3 offset:224
v_mfma_f32_16x16x32_bf16 v[180:183], v[244:247], v[84:87], v[180:183]
ds_read_b64_tr_b16 v[242:243], v3 offset:4832
s_waitcnt lgkmcnt(8)
Lpad7473:
s_cbranch_execz Lback0
v_mfma_f32_16x16x32_bf16 v[184:187], v[248:251], v[80:83], v[184:187]
ds_read_b64_tr_b16 v[244:245], v3 offset:256
v_mfma_f32_16x16x32_bf16 v[188:191], v[248:251], v[84:87], v[188:191]
ds_read_b64_tr_b16 v[246:247], v3 offset:4864
s_waitcnt lgkmcnt(8)
v_mfma_f32_16x16x32_bf16 v[192:195], v[252:255], v[80:83], v[192:195]
ds_read_b64_tr_b16 v[248:249], v3 offset:9216
v_mfma_f32_16x16x32_bf16 v[196:199], v[252:255], v[84:87], v[196:199]
ds_read_b64_tr_b16 v[250:251], v3 offset:13824
s_waitcnt lgkmcnt(8)
v_mfma_f32_16x16x32_bf16 v[200:203], v[232:235], v[80:83], v[200:203]
ds_read_b64_tr_b16 v[252:253], v3 offset:9248
v_mfma_f32_16x16x32_bf16 v[204:207], v[232:235], v[84:87], v[204:207]
ds_read_b64_tr_b16 v[254:255], v3 offset:13856
s_waitcnt lgkmcnt(8)
v_mfma_f32_16x16x32_bf16 v[208:211], v[236:239], v[80:83], v[208:211]
ds_read_b64_tr_b16 v[232:233], v3 offset:9280
v_mfma_f32_16x16x32_bf16 v[212:215], v[236:239], v[84:87], v[212:215]
ds_read_b64_tr_b16 v[234:235], v3 offset:13888
s_waitcnt lgkmcnt(8)
v_mfma_f32_16x16x32_bf16 v[216:219], v[240:243], v[80:83], v[216:219]
ds_read_b64_tr_b16 v[236:237], v3 offset:9312
v_mfma_f32_16x16x32_bf16 v[220:223], v[240:243], v[84:87], v[220:223]
ds_read_b64_tr_b16 v[238:239], v3 offset:13920
s_waitcnt lgkmcnt(8)
v_mfma_f32_16x16x32_bf16 v[224:227], v[244:247], v[80:83], v[224:227]
ds_read_b64_tr_b16 v[240:241], v3 offset:9344
v_mfma_f32_16x16x32_bf16 v[228:231], v[244:247], v[84:87], v[228:231]
ds_read_b64_tr_b16 v[242:243], v3 offset:13952
s_waitcnt lgkmcnt(8)
v_mfma_f32_16x16x32_bf16 v[160:163], v[248:251], v[88:91], v[160:163]
ds_read_b64_tr_b16 v[244:245], v3 offset:9376
v_mfma_f32_16x16x32_bf16 v[164:167], v[248:251], v[92:95], v[164:167]
ds_read_b64_tr_b16 v[246:247], v3 offset:13984
s_waitcnt lgkmcnt(8)
v_mfma_f32_16x16x32_bf16 v[168:171], v[252:255], v[88:91], v[168:171]
ds_read_b64_tr_b16 v[248:249], v3 offset:9408
v_mfma_f32_16x16x32_bf16 v[172:175], v[252:255], v[92:95], v[172:175]
ds_read_b64_tr_b16 v[250:251], v3 offset:14016
s_waitcnt lgkmcnt(8)
v_mfma_f32_16x16x32_bf16 v[176:179], v[232:235], v[88:91], v[176:179]
ds_read_b64_tr_b16 v[252:253], v3 offset:9440
v_mfma_f32_16x16x32_bf16 v[180:183], v[232:235], v[92:95], v[180:183]
ds_read_b64_tr_b16 v[254:255], v3 offset:14048
s_waitcnt lgkmcnt(8)
v_mfma_f32_16x16x32_bf16 v[184:187], v[236:239], v[88:91], v[184:187]
ds_read_b64_tr_b16 v[232:233], v3 offset:9472
v_mfma_f32_16x16x32_bf16 v[188:191], v[236:239], v[92:95], v[188:191]
ds_read_b64_tr_b16 v[234:235], v3 offset:14080
s_waitcnt lgkmcnt(8)
s_barrier
v_mfma_f32_16x16x32_bf16 v[192:195], v[240:243], v[88:91], v[192:195]
ds_read_b64_tr_b16 v[236:237], v3 offset:18432
v_mfma_f32_16x16x32_bf16 v[196:199], v[240:243], v[92:95], v[196:199]
ds_read_b64_tr_b16 v[238:239], v3 offset:23040
s_waitcnt lgkmcnt(8)
v_mfma_f32_16x16x32_bf16 v[200:203], v[244:247], v[88:91], v[200:203]
ds_read_b64_tr_b16 v[240:241], v3 offset:18464
v_mfma_f32_16x16x32_bf16 v[204:207], v[244:247], v[92:95], v[204:207]
ds_read_b64_tr_b16 v[242:243], v3 offset:23072
s_waitcnt lgkmcnt(8)
v_mfma_f32_16x16x32_bf16 v[208:211], v[248:251], v[88:91], v[208:211]
ds_read_b64_tr_b16 v[244:245], v3 offset:18496
v_mfma_f32_16x16x32_bf16 v[212:215], v[248:251], v[92:95], v[212:215]
ds_read_b64_tr_b16 v[246:247], v3 offset:23104
s_waitcnt lgkmcnt(8)
v_mfma_f32_16x16x32_bf16 v[216:219], v[252:255], v[88:91], v[216:219]
ds_read_b64_tr_b16 v[248:249], v3 offset:18528
v_mfma_f32_16x16x32_bf16 v[220:223], v[252:255], v[92:95], v[220:223]
ds_read_b64_tr_b16 v[250:251], v3 offset:23136
s_waitcnt lgkmcnt(8)
Lpad7544:
s_cbranch_execz Lpad7615
v_mfma_f32_16x16x32_bf16 v[224:227], v[232:235], v[88:91], v[224:227]
ds_read_b64_tr_b16 v[252:253], v3 offset:18560
v_mfma_f32_16x16x32_bf16 v[228:231], v[232:235], v[92:95], v[228:231]
ds_read_b64_tr_b16 v[254:255], v3 offset:23168
s_waitcnt lgkmcnt(8)
v_mfma_f32_16x16x32_bf16 v[160:163], v[236:239], v[96:99], v[160:163]
ds_read_b64_tr_b16 v[232:233], v3 offset:18592
v_mfma_f32_16x16x32_bf16 v[164:167], v[236:239], v[100:103], v[164:167]
ds_read_b64_tr_b16 v[234:235], v3 offset:23200
s_waitcnt lgkmcnt(8)
v_mfma_f32_16x16x32_bf16 v[168:171], v[240:243], v[96:99], v[168:171]
ds_read_b64_tr_b16 v[236:237], v3 offset:18624
v_mfma_f32_16x16x32_bf16 v[172:175], v[240:243], v[100:103], v[172:175]
ds_read_b64_tr_b16 v[238:239], v3 offset:23232
s_waitcnt lgkmcnt(8)
v_mfma_f32_16x16x32_bf16 v[176:179], v[244:247], v[96:99], v[176:179]
ds_read_b64_tr_b16 v[240:241], v3 offset:18656
v_mfma_f32_16x16x32_bf16 v[180:183], v[244:247], v[100:103], v[180:183]
ds_read_b64_tr_b16 v[242:243], v3 offset:23264
s_waitcnt lgkmcnt(8)
v_mfma_f32_16x16x32_bf16 v[184:187], v[248:251], v[96:99], v[184:187]
ds_read_b64_tr_b16 v[244:245], v3 offset:18688
v_mfma_f32_16x16x32_bf16 v[188:191], v[248:251], v[100:103], v[188:191]
ds_read_b64_tr_b16 v[246:247], v3 offset:23296
s_waitcnt lgkmcnt(8)
v_mfma_f32_16x16x32_bf16 v[192:195], v[252:255], v[96:99], v[192:195]
ds_read_b64_tr_b16 v[248:249], v3 offset:27648
v_mfma_f32_16x16x32_bf16 v[196:199], v[252:255], v[100:103], v[196:199]
ds_read_b64_tr_b16 v[250:251], v3 offset:32256
s_waitcnt lgkmcnt(8)
v_mfma_f32_16x16x32_bf16 v[200:203], v[232:235], v[96:99], v[200:203]
ds_read_b64_tr_b16 v[252:253], v3 offset:27680
v_mfma_f32_16x16x32_bf16 v[204:207], v[232:235], v[100:103], v[204:207]
ds_read_b64_tr_b16 v[254:255], v3 offset:32288
s_waitcnt lgkmcnt(8)
v_mfma_f32_16x16x32_bf16 v[208:211], v[236:239], v[96:99], v[208:211]
ds_read_b64_tr_b16 v[232:233], v3 offset:27712
v_mfma_f32_16x16x32_bf16 v[212:215], v[236:239], v[100:103], v[212:215]
ds_read_b64_tr_b16 v[234:235], v3 offset:32320
s_waitcnt lgkmcnt(8)
v_mfma_f32_16x16x32_bf16 v[216:219], v[240:243], v[96:99], v[216:219]
ds_read_b64_tr_b16 v[236:237], v3 offset:27744
v_mfma_f32_16x16x32_bf16 v[220:223], v[240:243], v[100:103], v[220:223]
ds_read_b64_tr_b16 v[238:239], v3 offset:32352
s_waitcnt lgkmcnt(8)
v_mfma_f32_16x16x32_bf16 v[224:227], v[244:247], v[96:99], v[224:227]
ds_read_b64_tr_b16 v[240:241], v3 offset:27776
v_mfma_f32_16x16x32_bf16 v[228:231], v[244:247], v[100:103], v[228:231]
ds_read_b64_tr_b16 v[242:243], v3 offset:32384
s_waitcnt lgkmcnt(8)
v_mfma_f32_16x16x32_bf16 v[160:163], v[248:251], v[104:107], v[160:163]
ds_read_b64_tr_b16 v[244:245], v3 offset:27808
v_mfma_f32_16x16x32_bf16 v[164:167], v[248:251], v[108:111], v[164:167]
ds_read_b64_tr_b16 v[246:247], v3 offset:32416
s_waitcnt lgkmcnt(8)
v_mfma_f32_16x16x32_bf16 v[168:171], v[252:255], v[104:107], v[168:171]
ds_read_b64_tr_b16 v[248:249], v3 offset:27840
v_mfma_f32_16x16x32_bf16 v[172:175], v[252:255], v[108:111], v[172:175]
ds_read_b64_tr_b16 v[250:251], v3 offset:32448
s_waitcnt lgkmcnt(8)
v_mfma_f32_16x16x32_bf16 v[176:179], v[232:235], v[104:107], v[176:179]
ds_read_b64_tr_b16 v[252:253], v3 offset:27872
v_mfma_f32_16x16x32_bf16 v[180:183], v[232:235], v[108:111], v[180:183]
ds_read_b64_tr_b16 v[254:255], v3 offset:32480
s_waitcnt lgkmcnt(8)
v_mfma_f32_16x16x32_bf16 v[184:187], v[236:239], v[104:107], v[184:187]
ds_read_b64_tr_b16 v[232:233], v3 offset:27904
v_mfma_f32_16x16x32_bf16 v[188:191], v[236:239], v[108:111], v[188:191]
ds_read_b64_tr_b16 v[234:235], v3 offset:32512
s_waitcnt lgkmcnt(8)
s_barrier
Lpad7615:
s_cbranch_execz Lpad7686
v_mfma_f32_16x16x32_bf16 v[192:195], v[240:243], v[104:107], v[192:195]
ds_read_b64_tr_b16 v[236:237], v3 offset:36864
v_mfma_f32_16x16x32_bf16 v[196:199], v[240:243], v[108:111], v[196:199]
ds_read_b64_tr_b16 v[238:239], v3 offset:41472
s_waitcnt lgkmcnt(8)
v_mfma_f32_16x16x32_bf16 v[200:203], v[244:247], v[104:107], v[200:203]
ds_read_b64_tr_b16 v[240:241], v3 offset:36896
v_mfma_f32_16x16x32_bf16 v[204:207], v[244:247], v[108:111], v[204:207]
ds_read_b64_tr_b16 v[242:243], v3 offset:41504
s_waitcnt lgkmcnt(8)
v_mfma_f32_16x16x32_bf16 v[208:211], v[248:251], v[104:107], v[208:211]
ds_read_b64_tr_b16 v[244:245], v3 offset:36928
v_mfma_f32_16x16x32_bf16 v[212:215], v[248:251], v[108:111], v[212:215]
ds_read_b64_tr_b16 v[246:247], v3 offset:41536
s_waitcnt lgkmcnt(8)
v_mfma_f32_16x16x32_bf16 v[216:219], v[252:255], v[104:107], v[216:219]
ds_read_b64_tr_b16 v[248:249], v3 offset:36960
v_mfma_f32_16x16x32_bf16 v[220:223], v[252:255], v[108:111], v[220:223]
ds_read_b64_tr_b16 v[250:251], v3 offset:41568
s_waitcnt lgkmcnt(8)
v_mfma_f32_16x16x32_bf16 v[224:227], v[232:235], v[104:107], v[224:227]
ds_read_b64_tr_b16 v[252:253], v3 offset:36992
v_mfma_f32_16x16x32_bf16 v[228:231], v[232:235], v[108:111], v[228:231]
ds_read_b64_tr_b16 v[254:255], v3 offset:41600
s_waitcnt lgkmcnt(8)
v_mfma_f32_16x16x32_bf16 v[160:163], v[236:239], v[112:115], v[160:163]
ds_read_b64_tr_b16 v[232:233], v3 offset:37024
v_mfma_f32_16x16x32_bf16 v[164:167], v[236:239], v[116:119], v[164:167]
ds_read_b64_tr_b16 v[234:235], v3 offset:41632
s_waitcnt lgkmcnt(8)
v_mfma_f32_16x16x32_bf16 v[168:171], v[240:243], v[112:115], v[168:171]
ds_read_b64_tr_b16 v[236:237], v3 offset:37056
v_mfma_f32_16x16x32_bf16 v[172:175], v[240:243], v[116:119], v[172:175]
ds_read_b64_tr_b16 v[238:239], v3 offset:41664
s_waitcnt lgkmcnt(8)
v_mfma_f32_16x16x32_bf16 v[176:179], v[244:247], v[112:115], v[176:179]
ds_read_b64_tr_b16 v[240:241], v3 offset:37088
v_mfma_f32_16x16x32_bf16 v[180:183], v[244:247], v[116:119], v[180:183]
ds_read_b64_tr_b16 v[242:243], v3 offset:41696
s_waitcnt lgkmcnt(8)
v_mfma_f32_16x16x32_bf16 v[184:187], v[248:251], v[112:115], v[184:187]
ds_read_b64_tr_b16 v[244:245], v3 offset:37120
v_mfma_f32_16x16x32_bf16 v[188:191], v[248:251], v[116:119], v[188:191]
ds_read_b64_tr_b16 v[246:247], v3 offset:41728
s_waitcnt lgkmcnt(8)
v_mfma_f32_16x16x32_bf16 v[192:195], v[252:255], v[112:115], v[192:195]
ds_read_b64_tr_b16 v[248:249], v3 offset:46080
v_mfma_f32_16x16x32_bf16 v[196:199], v[252:255], v[116:119], v[196:199]
ds_read_b64_tr_b16 v[250:251], v3 offset:50688
s_waitcnt lgkmcnt(8)
v_mfma_f32_16x16x32_bf16 v[200:203], v[232:235], v[112:115], v[200:203]
ds_read_b64_tr_b16 v[252:253], v3 offset:46112
v_mfma_f32_16x16x32_bf16 v[204:207], v[232:235], v[116:119], v[204:207]
ds_read_b64_tr_b16 v[254:255], v3 offset:50720
s_waitcnt lgkmcnt(8)
v_mfma_f32_16x16x32_bf16 v[208:211], v[236:239], v[112:115], v[208:211]
ds_read_b64_tr_b16 v[232:233], v3 offset:46144
v_mfma_f32_16x16x32_bf16 v[212:215], v[236:239], v[116:119], v[212:215]
ds_read_b64_tr_b16 v[234:235], v3 offset:50752
s_waitcnt lgkmcnt(8)
v_mfma_f32_16x16x32_bf16 v[216:219], v[240:243], v[112:115], v[216:219]
ds_read_b64_tr_b16 v[236:237], v3 offset:46176
v_mfma_f32_16x16x32_bf16 v[220:223], v[240:243], v[116:119], v[220:223]
ds_read_b64_tr_b16 v[238:239], v3 offset:50784
s_waitcnt lgkmcnt(8)
v_mfma_f32_16x16x32_bf16 v[224:227], v[244:247], v[112:115], v[224:227]
ds_read_b64_tr_b16 v[240:241], v3 offset:46208
v_mfma_f32_16x16x32_bf16 v[228:231], v[244:247], v[116:119], v[228:231]
ds_read_b64_tr_b16 v[242:243], v3 offset:50816
s_waitcnt lgkmcnt(8)
v_mfma_f32_16x16x32_bf16 v[160:163], v[248:251], v[120:123], v[160:163]
Lpad7686:
s_cbranch_execz Lpad7757
ds_read_b64_tr_b16 v[244:245], v3 offset:46240
v_mfma_f32_16x16x32_bf16 v[164:167], v[248:251], v[124:127], v[164:167]
ds_read_b64_tr_b16 v[246:247], v3 offset:50848
s_waitcnt lgkmcnt(8)
v_mfma_f32_16x16x32_bf16 v[168:171], v[252:255], v[120:123], v[168:171]
ds_read_b64_tr_b16 v[248:249], v3 offset:46272
v_mfma_f32_16x16x32_bf16 v[172:175], v[252:255], v[124:127], v[172:175]
ds_read_b64_tr_b16 v[250:251], v3 offset:50880
s_waitcnt lgkmcnt(8)
v_mfma_f32_16x16x32_bf16 v[176:179], v[232:235], v[120:123], v[176:179]
ds_read_b64_tr_b16 v[252:253], v3 offset:46304
v_mfma_f32_16x16x32_bf16 v[180:183], v[232:235], v[124:127], v[180:183]
ds_read_b64_tr_b16 v[254:255], v3 offset:50912
s_waitcnt lgkmcnt(8)
v_mfma_f32_16x16x32_bf16 v[184:187], v[236:239], v[120:123], v[184:187]
ds_read_b64_tr_b16 v[232:233], v3 offset:46336
v_mfma_f32_16x16x32_bf16 v[188:191], v[236:239], v[124:127], v[188:191]
ds_read_b64_tr_b16 v[234:235], v3 offset:50944
s_waitcnt lgkmcnt(8)
s_barrier
v_mfma_f32_16x16x32_bf16 v[192:195], v[240:243], v[120:123], v[192:195]
ds_read_b64_tr_b16 v[236:237], v3 offset:55296
v_mfma_f32_16x16x32_bf16 v[196:199], v[240:243], v[124:127], v[196:199]
ds_read_b64_tr_b16 v[238:239], v4 offset:2560
s_waitcnt lgkmcnt(8)
v_mfma_f32_16x16x32_bf16 v[200:203], v[244:247], v[120:123], v[200:203]
ds_read_b64_tr_b16 v[240:241], v3 offset:55328
v_mfma_f32_16x16x32_bf16 v[204:207], v[244:247], v[124:127], v[204:207]
ds_read_b64_tr_b16 v[242:243], v4 offset:2592
s_waitcnt lgkmcnt(8)
v_mfma_f32_16x16x32_bf16 v[208:211], v[248:251], v[120:123], v[208:211]
ds_read_b64_tr_b16 v[244:245], v3 offset:55360
v_mfma_f32_16x16x32_bf16 v[212:215], v[248:251], v[124:127], v[212:215]
ds_read_b64_tr_b16 v[246:247], v4 offset:2624
s_waitcnt lgkmcnt(8)
v_mfma_f32_16x16x32_bf16 v[216:219], v[252:255], v[120:123], v[216:219]
ds_read_b64_tr_b16 v[248:249], v3 offset:55392
v_mfma_f32_16x16x32_bf16 v[220:223], v[252:255], v[124:127], v[220:223]
ds_read_b64_tr_b16 v[250:251], v4 offset:2656
s_waitcnt lgkmcnt(8)
v_mfma_f32_16x16x32_bf16 v[224:227], v[232:235], v[120:123], v[224:227]
ds_read_b64_tr_b16 v[252:253], v3 offset:55424
v_mfma_f32_16x16x32_bf16 v[228:231], v[232:235], v[124:127], v[228:231]
ds_read_b64_tr_b16 v[254:255], v4 offset:2688
s_waitcnt lgkmcnt(8)
v_mfma_f32_16x16x32_bf16 v[160:163], v[236:239], v[128:131], v[160:163]
ds_read_b64_tr_b16 v[232:233], v3 offset:55456
ds_read_b64_tr_b16 v[234:235], v4 offset:2720
v_mfma_f32_16x16x32_bf16 v[164:167], v[236:239], v[132:135], v[164:167]
v_bfe_u32 v96, v2, 2, 2
v_and_b32 v97, 3, v2
s_waitcnt lgkmcnt(8)
v_mfma_f32_16x16x32_bf16 v[168:171], v[240:243], v[128:131], v[168:171]
ds_read_b64_tr_b16 v[236:237], v3 offset:55488
ds_read_b64_tr_b16 v[238:239], v4 offset:2752
v_mfma_f32_16x16x32_bf16 v[172:175], v[240:243], v[132:135], v[172:175]
v_lshl_add_u32 v96, v96, 3, v97
v_bfe_u32 v97, v2, 4, 1
s_waitcnt lgkmcnt(8)
v_mfma_f32_16x16x32_bf16 v[176:179], v[244:247], v[128:131], v[176:179]
ds_read_b64_tr_b16 v[240:241], v3 offset:55520
ds_read_b64_tr_b16 v[242:243], v4 offset:2784
v_mfma_f32_16x16x32_bf16 v[180:183], v[244:247], v[132:135], v[180:183]
v_lshl_add_u32 v97, v97, 2, v96
v_lshlrev_b32 v96, 1, v96
s_waitcnt lgkmcnt(8)
v_mfma_f32_16x16x32_bf16 v[184:187], v[248:251], v[128:131], v[184:187]
ds_read_b64_tr_b16 v[244:245], v3 offset:55552
ds_read_b64_tr_b16 v[246:247], v4 offset:2816
v_mfma_f32_16x16x32_bf16 v[188:191], v[248:251], v[132:135], v[188:191]
v_lshlrev_b32 v97, 1, v97
Lpad7757:
s_cbranch_execz Lpad7831
s_lshl_b32 s62, s70, 6
s_waitcnt lgkmcnt(8)
v_mfma_f32_16x16x32_bf16 v[192:195], v[252:255], v[128:131], v[192:195]
ds_read_b64_tr_b16 v[248:249], v4 offset:7168
ds_read_b64_tr_b16 v[250:251], v4 offset:11776
v_mfma_f32_16x16x32_bf16 v[196:199], v[252:255], v[132:135], v[196:199]
buffer_load_ushort v100, v97, s[36:39], s62 offen
buffer_load_ushort v101, v96, s[36:39], s62 offen
s_waitcnt lgkmcnt(8)
v_mfma_f32_16x16x32_bf16 v[200:203], v[232:235], v[128:131], v[200:203]
ds_read_b64_tr_b16 v[252:253], v4 offset:7200
ds_read_b64_tr_b16 v[254:255], v4 offset:11808
v_mfma_f32_16x16x32_bf16 v[204:207], v[232:235], v[132:135], v[204:207]
buffer_load_ushort v102, v96, s[36:39], s62 offen offset:8
v_lshlrev_b32 v98, 4, v2
s_waitcnt lgkmcnt(8)
v_mfma_f32_16x16x32_bf16 v[208:211], v[236:239], v[128:131], v[208:211]
ds_read_b64_tr_b16 v[232:233], v4 offset:7232
ds_read_b64_tr_b16 v[234:235], v4 offset:11840
v_mfma_f32_16x16x32_bf16 v[212:215], v[236:239], v[132:135], v[212:215]
v_add_u32 v104, 16384, v98
v_and_b32 v106, 15, v2
s_waitcnt lgkmcnt(8)
v_mfma_f32_16x16x32_bf16 v[216:219], v[240:243], v[128:131], v[216:219]
ds_read_b64_tr_b16 v[236:237], v4 offset:7264
ds_read_b64_tr_b16 v[238:239], v4 offset:11872
v_mfma_f32_16x16x32_bf16 v[220:223], v[240:243], v[132:135], v[220:223]
v_lshrrev_b32 v98, 4, v2
v_bfe_u32 v99, v2, 1, 3
s_waitcnt lgkmcnt(8)
v_mfma_f32_16x16x32_bf16 v[224:227], v[244:247], v[128:131], v[224:227]
ds_read_b64_tr_b16 v[240:241], v4 offset:7296
ds_read_b64_tr_b16 v[242:243], v4 offset:11904
v_mfma_f32_16x16x32_bf16 v[228:231], v[244:247], v[132:135], v[228:231]
v_xor_b32 v98, v98, v99
v_lshlrev_b32 v98, 4, v98
s_waitcnt lgkmcnt(8)
v_mfma_f32_16x16x32_bf16 v[160:163], v[248:251], v[136:139], v[160:163]
ds_read_b64_tr_b16 v[244:245], v4 offset:7328
ds_read_b64_tr_b16 v[246:247], v4 offset:11936
v_mfma_f32_16x16x32_bf16 v[164:167], v[248:251], v[140:143], v[164:167]
v_lshl_add_u32 v106, v106, 7, v98
s_lshl_b32 s62, s58, 12
s_waitcnt lgkmcnt(8)
v_mfma_f32_16x16x32_bf16 v[168:171], v[252:255], v[136:139], v[168:171]
ds_read_b64_tr_b16 v[248:249], v4 offset:7360
ds_read_b64_tr_b16 v[250:251], v4 offset:11968
v_mfma_f32_16x16x32_bf16 v[172:175], v[252:255], v[140:143], v[172:175]
v_add_u32 v106, s62, v106
v_xor_b32 v107, 64, v106
s_waitcnt lgkmcnt(8)
v_mfma_f32_16x16x32_bf16 v[176:179], v[232:235], v[136:139], v[176:179]
ds_read_b64_tr_b16 v[252:253], v4 offset:7392
ds_read_b64_tr_b16 v[254:255], v4 offset:12000
v_mfma_f32_16x16x32_bf16 v[180:183], v[232:235], v[140:143], v[180:183]
v_add_u32 v110, 34816, v104
v_add_u32 v112, 34816, v106
s_waitcnt lgkmcnt(8)
v_mfma_f32_16x16x32_bf16 v[184:187], v[236:239], v[136:139], v[184:187]
ds_read_b64_tr_b16 v[232:233], v4 offset:7424
ds_read_b64_tr_b16 v[234:235], v4 offset:12032
v_mfma_f32_16x16x32_bf16 v[188:191], v[236:239], v[140:143], v[188:191]
v_add_u32 v113, 34816, v107
v_add_u32 v116, 69632, v104
s_waitcnt lgkmcnt(8)
s_barrier
v_mfma_f32_16x16x32_bf16 v[192:195], v[240:243], v[136:139], v[192:195]
ds_read_b64_tr_b16 v[236:237], v4 offset:16384
ds_read_b64_tr_b16 v[238:239], v4 offset:20992
v_mfma_f32_16x16x32_bf16 v[196:199], v[240:243], v[140:143], v[196:199]
v_add_u32 v118, 69632, v106
v_add_u32 v119, 69632, v107
s_waitcnt lgkmcnt(8)
v_mfma_f32_16x16x32_bf16 v[200:203], v[244:247], v[136:139], v[200:203]
Lpad7831:
s_cbranch_execz Lpad7905
ds_read_b64_tr_b16 v[240:241], v4 offset:16416
ds_read_b64_tr_b16 v[242:243], v4 offset:21024
v_mfma_f32_16x16x32_bf16 v[204:207], v[244:247], v[140:143], v[204:207]
v_mul_f32 v16, v14, v14
v_mul_f32 v17, v15, v15
s_waitcnt lgkmcnt(8)
v_mfma_f32_16x16x32_bf16 v[208:211], v[248:251], v[136:139], v[208:211]
ds_read_b64_tr_b16 v[244:245], v4 offset:16448
ds_read_b64_tr_b16 v[246:247], v4 offset:21056
v_mfma_f32_16x16x32_bf16 v[212:215], v[248:251], v[140:143], v[212:215]
v_mul_f32 v18, 0xc0135761, v14
v_mul_f32 v19, 0xc0135761, v15
s_waitcnt lgkmcnt(8)
v_mfma_f32_16x16x32_bf16 v[216:219], v[252:255], v[136:139], v[216:219]
ds_read_b64_tr_b16 v[248:249], v4 offset:16480
ds_read_b64_tr_b16 v[250:251], v4 offset:21088
v_mfma_f32_16x16x32_bf16 v[220:223], v[252:255], v[140:143], v[220:223]
v_rcp_f32 v20, v14
v_rcp_f32 v21, v15
s_waitcnt lgkmcnt(8)
v_mfma_f32_16x16x32_bf16 v[224:227], v[232:235], v[136:139], v[224:227]
ds_read_b64_tr_b16 v[252:253], v4 offset:16512
ds_read_b64_tr_b16 v[254:255], v4 offset:21120
v_mfma_f32_16x16x32_bf16 v[228:231], v[232:235], v[140:143], v[228:231]
v_mul_f32 v16, v16, v14
v_mul_f32 v17, v17, v15
s_waitcnt lgkmcnt(8)
v_mfma_f32_16x16x32_bf16 v[160:163], v[236:239], v[144:147], v[160:163]
ds_read_b64_tr_b16 v[232:233], v4 offset:16544
ds_read_b64_tr_b16 v[234:235], v4 offset:21152
v_mfma_f32_16x16x32_bf16 v[164:167], v[236:239], v[148:151], v[164:167]
v_mul_f32 v16, s72, v16
v_mul_f32 v17, s72, v17
s_waitcnt lgkmcnt(8)
v_mfma_f32_16x16x32_bf16 v[168:171], v[240:243], v[144:147], v[168:171]
ds_read_b64_tr_b16 v[236:237], v4 offset:16576
v_mfma_f32_16x16x32_bf16 v[172:175], v[240:243], v[148:151], v[172:175]
ds_read_b64_tr_b16 v[238:239], v4 offset:21184
s_waitcnt lgkmcnt(8)
v_mfma_f32_16x16x32_bf16 v[176:179], v[244:247], v[144:147], v[176:179]
ds_read_b64_tr_b16 v[240:241], v4 offset:16608
v_mfma_f32_16x16x32_bf16 v[180:183], v[244:247], v[148:151], v[180:183]
ds_read_b64_tr_b16 v[242:243], v4 offset:21216
s_waitcnt lgkmcnt(8)
v_mfma_f32_16x16x32_bf16 v[184:187], v[248:251], v[144:147], v[184:187]
ds_read_b64_tr_b16 v[244:245], v4 offset:16640
v_mfma_f32_16x16x32_bf16 v[188:191], v[248:251], v[148:151], v[188:191]
ds_read_b64_tr_b16 v[246:247], v4 offset:21248
s_waitcnt lgkmcnt(8)
v_mfma_f32_16x16x32_bf16 v[192:195], v[252:255], v[144:147], v[192:195]
ds_read_b64_tr_b16 v[248:249], v4 offset:25600
v_mfma_f32_16x16x32_bf16 v[196:199], v[252:255], v[148:151], v[196:199]
ds_read_b64_tr_b16 v[250:251], v4 offset:30208
s_waitcnt lgkmcnt(8)
v_mfma_f32_16x16x32_bf16 v[200:203], v[232:235], v[144:147], v[200:203]
ds_read_b64_tr_b16 v[252:253], v4 offset:25632
v_mfma_f32_16x16x32_bf16 v[204:207], v[232:235], v[148:151], v[204:207]
ds_read_b64_tr_b16 v[254:255], v4 offset:30240
s_waitcnt lgkmcnt(8)
v_mfma_f32_16x16x32_bf16 v[208:211], v[236:239], v[144:147], v[208:211]
ds_read_b64_tr_b16 v[232:233], v4 offset:25664
v_mfma_f32_16x16x32_bf16 v[212:215], v[236:239], v[148:151], v[212:215]
ds_read_b64_tr_b16 v[234:235], v4 offset:30272
s_waitcnt lgkmcnt(8)
v_mfma_f32_16x16x32_bf16 v[216:219], v[240:243], v[144:147], v[216:219]
ds_read_b64_tr_b16 v[236:237], v4 offset:25696
v_mfma_f32_16x16x32_bf16 v[220:223], v[240:243], v[148:151], v[220:223]
ds_read_b64_tr_b16 v[238:239], v4 offset:30304
s_waitcnt lgkmcnt(8)
v_mfma_f32_16x16x32_bf16 v[224:227], v[244:247], v[144:147], v[224:227]
ds_read_b64_tr_b16 v[240:241], v4 offset:25728
v_mfma_f32_16x16x32_bf16 v[228:231], v[244:247], v[148:151], v[228:231]
ds_read_b64_tr_b16 v[242:243], v4 offset:30336
s_waitcnt lgkmcnt(8)
Lpad7905:
s_cbranch_execz Lpad7979
v_mfma_f32_16x16x32_bf16 v[160:163], v[248:251], v[152:155], v[160:163]
ds_read_b64_tr_b16 v[244:245], v4 offset:25760
v_mfma_f32_16x16x32_bf16 v[164:167], v[248:251], v[156:159], v[164:167]
ds_read_b64_tr_b16 v[246:247], v4 offset:30368
s_waitcnt lgkmcnt(8)
v_mfma_f32_16x16x32_bf16 v[168:171], v[252:255], v[152:155], v[168:171]
ds_read_b64_tr_b16 v[248:249], v4 offset:25792
v_mfma_f32_16x16x32_bf16 v[172:175], v[252:255], v[156:159], v[172:175]
ds_read_b64_tr_b16 v[250:251], v4 offset:30400
s_waitcnt lgkmcnt(8)
v_mfma_f32_16x16x32_bf16 v[176:179], v[232:235], v[152:155], v[176:179]
ds_read_b64_tr_b16 v[252:253], v4 offset:25824
v_mfma_f32_16x16x32_bf16 v[180:183], v[232:235], v[156:159], v[180:183]
ds_read_b64_tr_b16 v[254:255], v4 offset:30432
s_waitcnt lgkmcnt(8)
v_mfma_f32_16x16x32_bf16 v[184:187], v[236:239], v[152:155], v[184:187]
ds_read_b64_tr_b16 v[232:233], v4 offset:25856
v_mfma_f32_16x16x32_bf16 v[188:191], v[236:239], v[156:159], v[188:191]
ds_read_b64_tr_b16 v[234:235], v4 offset:30464
s_waitcnt lgkmcnt(8)
s_barrier
v_mfma_f32_16x16x32_bf16 v[192:195], v[240:243], v[152:155], v[192:195]
v_add_u32 v5, 896, v5
v_mfma_f32_16x16x32_bf16 v[196:199], v[240:243], v[156:159], v[196:199]
ds_read2_b64 v[236:239], v5 offset0:0 offset1:0
s_waitcnt lgkmcnt(7)
v_mfma_f32_16x16x32_bf16 v[200:203], v[244:247], v[152:155], v[200:203]
ds_read2_b64 v[240:243], v5 offset0:16 offset1:16
v_mfma_f32_16x16x32_bf16 v[204:207], v[244:247], v[156:159], v[204:207]
s_waitcnt lgkmcnt(6)
v_mfma_f32_16x16x32_bf16 v[208:211], v[248:251], v[152:155], v[208:211]
ds_read2_b64 v[244:247], v5 offset0:32 offset1:32
v_mfma_f32_16x16x32_bf16 v[212:215], v[248:251], v[156:159], v[212:215]
s_waitcnt lgkmcnt(5)
v_mfma_f32_16x16x32_bf16 v[216:219], v[252:255], v[152:155], v[216:219]
ds_read2_b64 v[248:251], v5 offset0:48 offset1:48
v_mfma_f32_16x16x32_bf16 v[220:223], v[252:255], v[156:159], v[220:223]
s_waitcnt lgkmcnt(4)
v_mfma_f32_16x16x32_bf16 v[224:227], v[232:235], v[152:155], v[224:227]
ds_read2_b64 v[252:255], v5 offset0:64 offset1:64
v_mfma_f32_16x16x32_bf16 v[228:231], v[232:235], v[156:159], v[228:231]
s_waitcnt lgkmcnt(4)
v_mfma_f32_16x16x32_bf16 v[160:163], v[236:239], v[8:11], v[160:163]
ds_read2_b64 v[232:235], v5 offset0:80 offset1:80
v_mfma_f32_16x16x32_bf16 v[164:167], v[236:239], v[10:13], v[164:167]
s_waitcnt lgkmcnt(4)
v_mfma_f32_16x16x32_bf16 v[168:171], v[240:243], v[8:11], v[168:171]
ds_read2_b64 v[236:239], v5 offset0:96 offset1:96
v_mfma_f32_16x16x32_bf16 v[172:175], v[240:243], v[10:13], v[172:175]
s_waitcnt lgkmcnt(4)
v_mfma_f32_16x16x32_bf16 v[176:179], v[244:247], v[8:11], v[176:179]
ds_read2_b64 v[240:243], v5 offset0:112 offset1:112
v_mfma_f32_16x16x32_bf16 v[180:183], v[244:247], v[10:13], v[180:183]
s_waitcnt lgkmcnt(4)
v_mfma_f32_16x16x32_bf16 v[184:187], v[248:251], v[8:11], v[184:187]
ds_read2_b64 v[244:247], v5 offset0:128 offset1:128
v_mfma_f32_16x16x32_bf16 v[188:191], v[248:251], v[10:13], v[188:191]
s_waitcnt lgkmcnt(4)
v_mfma_f32_16x16x32_bf16 v[192:195], v[252:255], v[8:11], v[192:195]
v_mfma_f32_16x16x32_bf16 v[196:199], v[252:255], v[10:13], v[196:199]
s_waitcnt lgkmcnt(3)
v_mfma_f32_16x16x32_bf16 v[200:203], v[232:235], v[8:11], v[200:203]
v_mfma_f32_16x16x32_bf16 v[204:207], v[232:235], v[10:13], v[204:207]
s_waitcnt lgkmcnt(2)
v_mfma_f32_16x16x32_bf16 v[208:211], v[236:239], v[8:11], v[208:211]
v_mfma_f32_16x16x32_bf16 v[212:215], v[236:239], v[10:13], v[212:215]
s_waitcnt lgkmcnt(1)
v_mfma_f32_16x16x32_bf16 v[216:219], v[240:243], v[8:11], v[216:219]
v_mfma_f32_16x16x32_bf16 v[220:223], v[240:243], v[10:13], v[220:223]
s_waitcnt lgkmcnt(0)
v_mfma_f32_16x16x32_bf16 v[224:227], v[244:247], v[8:11], v[224:227]
v_mfma_f32_16x16x32_bf16 v[228:231], v[244:247], v[10:13], v[228:231]
L_p1:
v_mov_b32 v10, 0xc0135761
Lpad7979:
s_cbranch_execz Lback0
v_pk_mul_f32 v[24:25], v[160:161], v[160:161]
v_pk_fma_f32 v[24:25], v[24:25], v[16:17], v[18:19] op_sel:[0,0,0] op_sel_hi:[1,0,0]
s_nop 0
v_pk_mul_f32 v[24:25], v[24:25], v[160:161]
v_exp_f32 v24, v24
v_pk_mul_f32 v[26:27], v[162:163], v[162:163]
v_exp_f32 v25, v25
v_pk_fma_f32 v[26:27], v[26:27], v[16:17], v[18:19] op_sel:[0,0,0] op_sel_hi:[1,0,0]
v_pk_fma_f32 v[24:25], v[24:25], v[20:21], v[20:21] op_sel:[0,0,0] op_sel_hi:[1,0,0]
v_pk_mul_f32 v[26:27], v[26:27], v[162:163]
v_exp_f32 v26, v26
v_pk_mul_f32 v[28:29], v[164:165], v[164:165]
v_exp_f32 v27, v27
v_pk_fma_f32 v[28:29], v[28:29], v[16:17], v[18:19] op_sel:[0,1,1] op_sel_hi:[1,1,1]
v_rcp_f32 v24, v24
v_rcp_f32 v25, v25
v_pk_fma_f32 v[26:27], v[26:27], v[20:21], v[20:21] op_sel:[0,0,0] op_sel_hi:[1,0,0]
v_pk_mul_f32 v[28:29], v[28:29], v[164:165]
v_pk_mul_f32 v[160:161], v[160:161], v[24:25]
v_exp_f32 v28, v28
v_pk_mul_f32 v[24:25], v[166:167], v[166:167]
v_exp_f32 v29, v29
v_pk_fma_f32 v[24:25], v[24:25], v[16:17], v[18:19] op_sel:[0,1,1] op_sel_hi:[1,1,1]
v_rcp_f32 v26, v26
v_cvt_pk_bf16_f32 v122, v160, v161
v_rcp_f32 v27, v27
v_pk_fma_f32 v[28:29], v[28:29], v[20:21], v[20:21] op_sel:[0,1,1] op_sel_hi:[1,1,1]
v_pk_mul_f32 v[24:25], v[24:25], v[166:167]
v_pk_mul_f32 v[162:163], v[162:163], v[26:27]
v_exp_f32 v24, v24
v_pk_mul_f32 v[26:27], v[168:169], v[168:169]
v_exp_f32 v25, v25
v_pk_fma_f32 v[26:27], v[26:27], v[16:17], v[18:19] op_sel:[0,0,0] op_sel_hi:[1,0,0]
v_rcp_f32 v28, v28
v_cvt_pk_bf16_f32 v123, v162, v163
v_rcp_f32 v29, v29
v_pk_fma_f32 v[24:25], v[24:25], v[20:21], v[20:21] op_sel:[0,1,1] op_sel_hi:[1,1,1]
v_pk_mul_f32 v[26:27], v[26:27], v[168:169]
v_pk_mul_f32 v[164:165], v[164:165], v[28:29]
v_exp_f32 v26, v26
v_pk_mul_f32 v[28:29], v[170:171], v[170:171]
v_exp_f32 v27, v27
v_pk_fma_f32 v[28:29], v[28:29], v[16:17], v[18:19] op_sel:[0,0,0] op_sel_hi:[1,0,0]
v_rcp_f32 v24, v24
v_cvt_pk_bf16_f32 v124, v164, v165
v_rcp_f32 v25, v25
v_pk_fma_f32 v[26:27], v[26:27], v[20:21], v[20:21] op_sel:[0,0,0] op_sel_hi:[1,0,0]
v_pk_mul_f32 v[28:29], v[28:29], v[170:171]
v_pk_mul_f32 v[166:167], v[166:167], v[24:25]
v_exp_f32 v28, v28
v_pk_mul_f32 v[24:25], v[172:173], v[172:173]
v_exp_f32 v29, v29
v_pk_fma_f32 v[24:25], v[24:25], v[16:17], v[18:19] op_sel:[0,1,1] op_sel_hi:[1,1,1]
v_rcp_f32 v26, v26
v_cvt_pk_bf16_f32 v125, v166, v167
v_rcp_f32 v27, v27
v_pk_fma_f32 v[28:29], v[28:29], v[20:21], v[20:21] op_sel:[0,0,0] op_sel_hi:[1,0,0]
v_pk_mul_f32 v[24:25], v[24:25], v[172:173]
v_pk_mul_f32 v[168:169], v[168:169], v[26:27]
v_exp_f32 v24, v24
v_pk_mul_f32 v[26:27], v[174:175], v[174:175]
v_exp_f32 v25, v25
v_pk_fma_f32 v[26:27], v[26:27], v[16:17], v[18:19] op_sel:[0,1,1] op_sel_hi:[1,1,1]
v_rcp_f32 v28, v28
v_cvt_pk_bf16_f32 v126, v168, v169
v_rcp_f32 v29, v29
v_pk_fma_f32 v[24:25], v[24:25], v[20:21], v[20:21] op_sel:[0,1,1] op_sel_hi:[1,1,1]
v_pk_mul_f32 v[26:27], v[26:27], v[174:175]
v_pk_mul_f32 v[170:171], v[170:171], v[28:29]
v_exp_f32 v26, v26
v_pk_mul_f32 v[28:29], v[176:177], v[176:177]
v_exp_f32 v27, v27
v_pk_fma_f32 v[28:29], v[28:29], v[16:17], v[18:19] op_sel:[0,0,0] op_sel_hi:[1,0,0]
v_rcp_f32 v24, v24
v_cvt_pk_bf16_f32 v127, v170, v171
v_rcp_f32 v25, v25
v_pk_fma_f32 v[26:27], v[26:27], v[20:21], v[20:21] op_sel:[0,1,1] op_sel_hi:[1,1,1]
v_pk_mul_f32 v[28:29], v[28:29], v[176:177]
v_pk_mul_f32 v[172:173], v[172:173], v[24:25]
Lpad8058:
s_cbranch_execz Lpad8138
v_exp_f32 v28, v28
v_pk_mul_f32 v[24:25], v[178:179], v[178:179]
v_exp_f32 v29, v29
v_pk_fma_f32 v[24:25], v[24:25], v[16:17], v[18:19] op_sel:[0,0,0] op_sel_hi:[1,0,0]
v_rcp_f32 v26, v26
v_cvt_pk_bf16_f32 v128, v172, v173
v_rcp_f32 v27, v27
v_pk_fma_f32 v[28:29], v[28:29], v[20:21], v[20:21] op_sel:[0,0,0] op_sel_hi:[1,0,0]
v_pk_mul_f32 v[24:25], v[24:25], v[178:179]
v_pk_mul_f32 v[174:175], v[174:175], v[26:27]
v_exp_f32 v24, v24
v_pk_mul_f32 v[26:27], v[180:181], v[180:181]
v_exp_f32 v25, v25
v_pk_fma_f32 v[26:27], v[26:27], v[16:17], v[18:19] op_sel:[0,1,1] op_sel_hi:[1,1,1]
v_rcp_f32 v28, v28
v_cvt_pk_bf16_f32 v129, v174, v175
v_rcp_f32 v29, v29
v_pk_fma_f32 v[24:25], v[24:25], v[20:21], v[20:21] op_sel:[0,0,0] op_sel_hi:[1,0,0]
v_pk_mul_f32 v[26:27], v[26:27], v[180:181]
v_pk_mul_f32 v[176:177], v[176:177], v[28:29]
v_exp_f32 v26, v26
v_pk_mul_f32 v[28:29], v[182:183], v[182:183]
v_exp_f32 v27, v27
v_pk_fma_f32 v[28:29], v[28:29], v[16:17], v[18:19] op_sel:[0,1,1] op_sel_hi:[1,1,1]
v_rcp_f32 v24, v24
v_cvt_pk_bf16_f32 v130, v176, v177
v_rcp_f32 v25, v25
v_pk_fma_f32 v[26:27], v[26:27], v[20:21], v[20:21] op_sel:[0,1,1] op_sel_hi:[1,1,1]
v_pk_mul_f32 v[28:29], v[28:29], v[182:183]
v_pk_mul_f32 v[178:179], v[178:179], v[24:25]
v_exp_f32 v28, v28
v_pk_mul_f32 v[24:25], v[184:185], v[184:185]
v_exp_f32 v29, v29
v_pk_fma_f32 v[24:25], v[24:25], v[16:17], v[18:19] op_sel:[0,0,0] op_sel_hi:[1,0,0]
v_rcp_f32 v26, v26
v_cvt_pk_bf16_f32 v131, v178, v179
v_rcp_f32 v27, v27
v_pk_fma_f32 v[28:29], v[28:29], v[20:21], v[20:21] op_sel:[0,1,1] op_sel_hi:[1,1,1]
v_pk_mul_f32 v[24:25], v[24:25], v[184:185]
v_pk_mul_f32 v[180:181], v[180:181], v[26:27]
v_exp_f32 v24, v24
v_pk_mul_f32 v[26:27], v[186:187], v[186:187]
v_exp_f32 v25, v25
v_pk_fma_f32 v[26:27], v[26:27], v[16:17], v[18:19] op_sel:[0,0,0] op_sel_hi:[1,0,0]
v_rcp_f32 v28, v28
v_cvt_pk_bf16_f32 v132, v180, v181
v_rcp_f32 v29, v29
v_pk_fma_f32 v[24:25], v[24:25], v[20:21], v[20:21] op_sel:[0,0,0] op_sel_hi:[1,0,0]
v_pk_mul_f32 v[26:27], v[26:27], v[186:187]
s_barrier
v_pk_mul_f32 v[182:183], v[182:183], v[28:29]
v_exp_f32 v26, v26
v_pk_mul_f32 v[28:29], v[188:189], v[188:189]
v_exp_f32 v27, v27
v_pk_fma_f32 v[28:29], v[28:29], v[16:17], v[18:19] op_sel:[0,1,1] op_sel_hi:[1,1,1]
v_rcp_f32 v24, v24
v_cvt_pk_bf16_f32 v133, v182, v183
v_rcp_f32 v25, v25
v_pk_fma_f32 v[26:27], v[26:27], v[20:21], v[20:21] op_sel:[0,0,0] op_sel_hi:[1,0,0]
v_pk_mul_f32 v[28:29], v[28:29], v[188:189]
v_pk_mul_f32 v[184:185], v[184:185], v[24:25]
v_exp_f32 v28, v28
v_pk_mul_f32 v[24:25], v[190:191], v[190:191]
v_exp_f32 v29, v29
v_pk_fma_f32 v[24:25], v[24:25], v[16:17], v[18:19] op_sel:[0,1,1] op_sel_hi:[1,1,1]
v_rcp_f32 v26, v26
v_cvt_pk_bf16_f32 v134, v184, v185
v_rcp_f32 v27, v27
v_pk_fma_f32 v[28:29], v[28:29], v[20:21], v[20:21] op_sel:[0,1,1] op_sel_hi:[1,1,1]
v_pk_mul_f32 v[24:25], v[24:25], v[190:191]
v_pk_mul_f32 v[186:187], v[186:187], v[26:27]
v_exp_f32 v24, v24
v_pk_mul_f32 v[26:27], v[192:193], v[192:193]
v_exp_f32 v25, v25
v_pk_fma_f32 v[26:27], v[26:27], v[16:17], v[18:19] op_sel:[0,0,0] op_sel_hi:[1,0,0]
v_rcp_f32 v28, v28
v_cvt_pk_bf16_f32 v135, v186, v187
v_rcp_f32 v29, v29
v_pk_fma_f32 v[24:25], v[24:25], v[20:21], v[20:21] op_sel:[0,1,1] op_sel_hi:[1,1,1]
v_pk_mul_f32 v[26:27], v[26:27], v[192:193]
Lpad8138:
s_cbranch_execz Lpad8217
v_pk_mul_f32 v[188:189], v[188:189], v[28:29]
v_exp_f32 v26, v26
v_pk_mul_f32 v[28:29], v[194:195], v[194:195]
v_exp_f32 v27, v27
v_pk_fma_f32 v[28:29], v[28:29], v[16:17], v[18:19] op_sel:[0,0,0] op_sel_hi:[1,0,0]
v_rcp_f32 v24, v24
v_cvt_pk_bf16_f32 v136, v188, v189
v_rcp_f32 v25, v25
v_pk_fma_f32 v[26:27], v[26:27], v[20:21], v[20:21] op_sel:[0,0,0] op_sel_hi:[1,0,0]
v_pk_mul_f32 v[28:29], v[28:29], v[194:195]
v_pk_mul_f32 v[190:191], v[190:191], v[24:25]
v_exp_f32 v28, v28
v_pk_mul_f32 v[24:25], v[196:197], v[196:197]
v_exp_f32 v29, v29
v_pk_fma_f32 v[24:25], v[24:25], v[16:17], v[18:19] op_sel:[0,1,1] op_sel_hi:[1,1,1]
v_rcp_f32 v26, v26
v_cvt_pk_bf16_f32 v137, v190, v191
v_rcp_f32 v27, v27
v_pk_fma_f32 v[28:29], v[28:29], v[20:21], v[20:21] op_sel:[0,0,0] op_sel_hi:[1,0,0]
v_pk_mul_f32 v[24:25], v[24:25], v[196:197]
v_pk_mul_f32 v[192:193], v[192:193], v[26:27]
v_exp_f32 v24, v24
v_pk_mul_f32 v[26:27], v[198:199], v[198:199]
v_exp_f32 v25, v25
v_pk_fma_f32 v[26:27], v[26:27], v[16:17], v[18:19] op_sel:[0,1,1] op_sel_hi:[1,1,1]
v_rcp_f32 v28, v28
v_cvt_pk_bf16_f32 v138, v192, v193
v_rcp_f32 v29, v29
v_pk_fma_f32 v[24:25], v[24:25], v[20:21], v[20:21] op_sel:[0,1,1] op_sel_hi:[1,1,1]
v_pk_mul_f32 v[26:27], v[26:27], v[198:199]
v_pk_mul_f32 v[194:195], v[194:195], v[28:29]
v_exp_f32 v26, v26
v_pk_mul_f32 v[28:29], v[200:201], v[200:201]
v_exp_f32 v27, v27
v_pk_fma_f32 v[28:29], v[28:29], v[16:17], v[18:19] op_sel:[0,0,0] op_sel_hi:[1,0,0]
v_rcp_f32 v24, v24
v_cvt_pk_bf16_f32 v139, v194, v195
v_rcp_f32 v25, v25
v_pk_fma_f32 v[26:27], v[26:27], v[20:21], v[20:21] op_sel:[0,1,1] op_sel_hi:[1,1,1]
v_pk_mul_f32 v[28:29], v[28:29], v[200:201]
v_pk_mul_f32 v[196:197], v[196:197], v[24:25]
v_exp_f32 v28, v28
v_pk_mul_f32 v[24:25], v[202:203], v[202:203]
v_exp_f32 v29, v29
v_pk_fma_f32 v[24:25], v[24:25], v[16:17], v[18:19] op_sel:[0,0,0] op_sel_hi:[1,0,0]
v_rcp_f32 v26, v26
v_cvt_pk_bf16_f32 v140, v196, v197
v_rcp_f32 v27, v27
v_pk_fma_f32 v[28:29], v[28:29], v[20:21], v[20:21] op_sel:[0,0,0] op_sel_hi:[1,0,0]
v_pk_mul_f32 v[24:25], v[24:25], v[202:203]
v_pk_mul_f32 v[198:199], v[198:199], v[26:27]
v_exp_f32 v24, v24
v_pk_mul_f32 v[26:27], v[204:205], v[204:205]
v_exp_f32 v25, v25
v_pk_fma_f32 v[26:27], v[26:27], v[16:17], v[18:19] op_sel:[0,1,1] op_sel_hi:[1,1,1]
v_rcp_f32 v28, v28
v_cvt_pk_bf16_f32 v141, v198, v199
v_rcp_f32 v29, v29
v_pk_fma_f32 v[24:25], v[24:25], v[20:21], v[20:21] op_sel:[0,0,0] op_sel_hi:[1,0,0]
v_pk_mul_f32 v[26:27], v[26:27], v[204:205]
v_pk_mul_f32 v[200:201], v[200:201], v[28:29]
v_exp_f32 v26, v26
v_pk_mul_f32 v[28:29], v[206:207], v[206:207]
v_exp_f32 v27, v27
v_pk_fma_f32 v[28:29], v[28:29], v[16:17], v[18:19] op_sel:[0,1,1] op_sel_hi:[1,1,1]
v_rcp_f32 v24, v24
v_cvt_pk_bf16_f32 v142, v200, v201
v_rcp_f32 v25, v25
v_pk_fma_f32 v[26:27], v[26:27], v[20:21], v[20:21] op_sel:[0,1,1] op_sel_hi:[1,1,1]
v_pk_mul_f32 v[28:29], v[28:29], v[206:207]
v_pk_mul_f32 v[202:203], v[202:203], v[24:25]
v_exp_f32 v28, v28
v_pk_mul_f32 v[24:25], v[208:209], v[208:209]
v_exp_f32 v29, v29
v_pk_fma_f32 v[24:25], v[24:25], v[16:17], v[18:19] op_sel:[0,0,0] op_sel_hi:[1,0,0]
v_rcp_f32 v26, v26
v_cvt_pk_bf16_f32 v143, v202, v203
v_rcp_f32 v27, v27
v_pk_fma_f32 v[28:29], v[28:29], v[20:21], v[20:21] op_sel:[0,1,1] op_sel_hi:[1,1,1]
Lpad8217:
s_cbranch_execz Lpad8297
v_pk_mul_f32 v[24:25], v[24:25], v[208:209]
v_pk_mul_f32 v[204:205], v[204:205], v[26:27]
v_exp_f32 v24, v24
v_pk_mul_f32 v[26:27], v[210:211], v[210:211]
v_exp_f32 v25, v25
v_pk_fma_f32 v[26:27], v[26:27], v[16:17], v[18:19] op_sel:[0,0,0] op_sel_hi:[1,0,0]
v_rcp_f32 v28, v28
v_cvt_pk_bf16_f32 v144, v204, v205
v_rcp_f32 v29, v29
v_pk_fma_f32 v[24:25], v[24:25], v[20:21], v[20:21] op_sel:[0,0,0] op_sel_hi:[1,0,0]
v_pk_mul_f32 v[26:27], v[26:27], v[210:211]
v_pk_mul_f32 v[206:207], v[206:207], v[28:29]
v_exp_f32 v26, v26
v_pk_mul_f32 v[28:29], v[212:213], v[212:213]
v_exp_f32 v27, v27
v_pk_fma_f32 v[28:29], v[28:29], v[16:17], v[18:19] op_sel:[0,1,1] op_sel_hi:[1,1,1]
v_rcp_f32 v24, v24
v_cvt_pk_bf16_f32 v145, v206, v207
v_rcp_f32 v25, v25
v_pk_fma_f32 v[26:27], v[26:27], v[20:21], v[20:21] op_sel:[0,0,0] op_sel_hi:[1,0,0]
v_pk_mul_f32 v[28:29], v[28:29], v[212:213]
v_pk_mul_f32 v[208:209], v[208:209], v[24:25]
v_exp_f32 v28, v28
v_pk_mul_f32 v[24:25], v[214:215], v[214:215]
v_exp_f32 v29, v29
v_pk_fma_f32 v[24:25], v[24:25], v[16:17], v[18:19] op_sel:[0,1,1] op_sel_hi:[1,1,1]
v_rcp_f32 v26, v26
v_cvt_pk_bf16_f32 v146, v208, v209
v_rcp_f32 v27, v27
v_pk_fma_f32 v[28:29], v[28:29], v[20:21], v[20:21] op_sel:[0,1,1] op_sel_hi:[1,1,1]
v_pk_mul_f32 v[24:25], v[24:25], v[214:215]
v_pk_mul_f32 v[210:211], v[210:211], v[26:27]
v_exp_f32 v24, v24
v_pk_mul_f32 v[26:27], v[216:217], v[216:217]
v_exp_f32 v25, v25
v_pk_fma_f32 v[26:27], v[26:27], v[16:17], v[18:19] op_sel:[0,0,0] op_sel_hi:[1,0,0]
v_rcp_f32 v28, v28
v_cvt_pk_bf16_f32 v147, v210, v211
v_rcp_f32 v29, v29
v_pk_fma_f32 v[24:25], v[24:25], v[20:21], v[20:21] op_sel:[0,1,1] op_sel_hi:[1,1,1]
v_pk_mul_f32 v[26:27], v[26:27], v[216:217]
v_pk_mul_f32 v[212:213], v[212:213], v[28:29]
v_exp_f32 v26, v26
v_pk_mul_f32 v[28:29], v[218:219], v[218:219]
v_exp_f32 v27, v27
v_pk_fma_f32 v[28:29], v[28:29], v[16:17], v[18:19] op_sel:[0,0,0] op_sel_hi:[1,0,0]
v_rcp_f32 v24, v24
v_cvt_pk_bf16_f32 v148, v212, v213
v_rcp_f32 v25, v25
v_pk_fma_f32 v[26:27], v[26:27], v[20:21], v[20:21] op_sel:[0,0,0] op_sel_hi:[1,0,0]
v_pk_mul_f32 v[28:29], v[28:29], v[218:219]
v_pk_mul_f32 v[214:215], v[214:215], v[24:25]
v_exp_f32 v28, v28
v_pk_mul_f32 v[24:25], v[220:221], v[220:221]
v_exp_f32 v29, v29
v_pk_fma_f32 v[24:25], v[24:25], v[16:17], v[18:19] op_sel:[0,1,1] op_sel_hi:[1,1,1]
v_rcp_f32 v26, v26
v_cvt_pk_bf16_f32 v149, v214, v215
v_rcp_f32 v27, v27
v_pk_fma_f32 v[28:29], v[28:29], v[20:21], v[20:21] op_sel:[0,0,0] op_sel_hi:[1,0,0]
v_pk_mul_f32 v[24:25], v[24:25], v[220:221]
v_pk_mul_f32 v[216:217], v[216:217], v[26:27]
v_exp_f32 v24, v24
v_pk_mul_f32 v[26:27], v[222:223], v[222:223]
v_exp_f32 v25, v25
v_pk_fma_f32 v[26:27], v[26:27], v[16:17], v[18:19] op_sel:[0,1,1] op_sel_hi:[1,1,1]
v_rcp_f32 v28, v28
v_cvt_pk_bf16_f32 v150, v216, v217
v_rcp_f32 v29, v29
v_pk_fma_f32 v[24:25], v[24:25], v[20:21], v[20:21] op_sel:[0,1,1] op_sel_hi:[1,1,1]
v_pk_mul_f32 v[26:27], v[26:27], v[222:223]
v_pk_mul_f32 v[218:219], v[218:219], v[28:29]
v_exp_f32 v26, v26
v_pk_mul_f32 v[28:29], v[224:225], v[224:225]
v_exp_f32 v27, v27
v_pk_fma_f32 v[28:29], v[28:29], v[16:17], v[18:19] op_sel:[0,0,0] op_sel_hi:[1,0,0]
v_rcp_f32 v24, v24
v_cvt_pk_bf16_f32 v151, v218, v219
v_rcp_f32 v25, v25
v_pk_fma_f32 v[26:27], v[26:27], v[20:21], v[20:21] op_sel:[0,1,1] op_sel_hi:[1,1,1]
Lpad8297:
s_cbranch_execz Lpad8376
v_pk_mul_f32 v[28:29], v[28:29], v[224:225]
v_pk_mul_f32 v[220:221], v[220:221], v[24:25]
v_exp_f32 v28, v28
v_pk_mul_f32 v[24:25], v[226:227], v[226:227]
v_exp_f32 v29, v29
v_pk_fma_f32 v[24:25], v[24:25], v[16:17], v[18:19] op_sel:[0,0,0] op_sel_hi:[1,0,0]
v_rcp_f32 v26, v26
v_cvt_pk_bf16_f32 v152, v220, v221
v_rcp_f32 v27, v27
v_pk_fma_f32 v[28:29], v[28:29], v[20:21], v[20:21] op_sel:[0,0,0] op_sel_hi:[1,0,0]
v_pk_mul_f32 v[24:25], v[24:25], v[226:227]
v_pk_mul_f32 v[222:223], v[222:223], v[26:27]
v_exp_f32 v24, v24
v_pk_mul_f32 v[26:27], v[228:229], v[228:229]
v_exp_f32 v25, v25
v_pk_fma_f32 v[26:27], v[26:27], v[16:17], v[18:19] op_sel:[0,1,1] op_sel_hi:[1,1,1]
v_rcp_f32 v28, v28
v_cvt_pk_bf16_f32 v153, v222, v223
v_rcp_f32 v29, v29
v_pk_fma_f32 v[24:25], v[24:25], v[20:21], v[20:21] op_sel:[0,0,0] op_sel_hi:[1,0,0]
v_pk_mul_f32 v[26:27], v[26:27], v[228:229]
v_pk_mul_f32 v[224:225], v[224:225], v[28:29]
v_exp_f32 v26, v26
v_pk_mul_f32 v[28:29], v[230:231], v[230:231]
v_exp_f32 v27, v27
v_pk_fma_f32 v[28:29], v[28:29], v[16:17], v[18:19] op_sel:[0,1,1] op_sel_hi:[1,1,1]
v_rcp_f32 v24, v24
v_cvt_pk_bf16_f32 v154, v224, v225
v_rcp_f32 v25, v25
v_pk_fma_f32 v[26:27], v[26:27], v[20:21], v[20:21] op_sel:[0,1,1] op_sel_hi:[1,1,1]
v_pk_mul_f32 v[28:29], v[28:29], v[230:231]
v_pk_mul_f32 v[226:227], v[226:227], v[24:25]
v_exp_f32 v28, v28
v_exp_f32 v29, v29
v_rcp_f32 v26, v26
v_cvt_pk_bf16_f32 v155, v226, v227
v_rcp_f32 v27, v27
v_pk_fma_f32 v[28:29], v[28:29], v[20:21], v[20:21] op_sel:[0,1,1] op_sel_hi:[1,1,1]
v_pk_mul_f32 v[228:229], v[228:229], v[26:27]
v_rcp_f32 v28, v28
v_cvt_pk_bf16_f32 v156, v228, v229
v_rcp_f32 v29, v29
s_nop 0
v_pk_mul_f32 v[230:231], v[230:231], v[28:29]
v_cvt_pk_bf16_f32 v157, v230, v231
s_waitcnt vmcnt(0)
v_lshlrev_b32 v248, 16, v101
v_lshlrev_b32 v249, 16, v101
v_lshlrev_b32 v250, 16, v101
v_lshlrev_b32 v251, 16, v101
v_lshlrev_b32 v252, 16, v102
v_lshlrev_b32 v253, 16, v102
v_lshlrev_b32 v254, 16, v102
v_lshlrev_b32 v255, 16, v102
s_barrier
ds_read_b128 v[16:19], v106 offset:0
ds_read_b128 v[20:23], v106 offset:2048
ds_read_b128 v[24:27], v104 offset:0
ds_read_b128 v[28:31], v104 offset:1024
ds_read_b128 v[32:35], v104 offset:2048
ds_read_b128 v[36:39], v104 offset:3072
ds_read_b128 v[40:43], v104 offset:4096
ds_read_b128 v[44:47], v104 offset:5120
ds_read_b128 v[48:51], v104 offset:6144
ds_read_b128 v[52:55], v104 offset:7168
ds_read_b128 v[56:59], v104 offset:8192
s_waitcnt lgkmcnt(0)
v_mfma_f32_16x16x32_bf16 v[160:163], v[24:27], v[16:19], v[248:251]
ds_read_b128 v[60:63], v107 offset:0
s_lshl_b32 s62, s70, 2
v_mfma_f32_16x16x32_bf16 v[164:167], v[24:27], v[20:23], v[252:255]
ds_read_b128 v[64:67], v107 offset:2048
v_mfma_f32_16x16x32_bf16 v[168:171], v[28:31], v[16:19], v[248:251]
ds_read_b128 v[68:71], v104 offset:9216
s_lshr_b32 s63, s57, 2
v_mfma_f32_16x16x32_bf16 v[172:175], v[28:31], v[20:23], v[252:255]
ds_read_b128 v[72:75], v104 offset:10240
v_mfma_f32_16x16x32_bf16 v[176:179], v[32:35], v[16:19], v[248:251]
ds_read_b128 v[76:79], v104 offset:11264
Lpad8376:
s_cbranch_execz Lpad8448
v_mfma_f32_16x16x32_bf16 v[180:183], v[32:35], v[20:23], v[252:255]
ds_read_b128 v[80:83], v104 offset:12288
s_add_u32 s62, s62, s63
v_mfma_f32_16x16x32_bf16 v[184:187], v[36:39], v[16:19], v[248:251]
ds_read_b128 v[84:87], v104 offset:13312
v_mfma_f32_16x16x32_bf16 v[188:191], v[36:39], v[20:23], v[252:255]
ds_read_b128 v[88:91], v104 offset:14336
s_mul_i32 s70, s62, 36864
v_mfma_f32_16x16x32_bf16 v[192:195], v[40:43], v[16:19], v[248:251]
ds_read_b128 v[92:95], v104 offset:15360
v_mfma_f32_16x16x32_bf16 v[196:199], v[40:43], v[20:23], v[252:255]
ds_read_b128 v[96:99], v104 offset:16384
v_mfma_f32_16x16x32_bf16 v[200:203], v[44:47], v[16:19], v[248:251]
ds_read_b128 v[100:103], v104 offset:17408
s_add_u32 s70, s70, 19136512
v_mfma_f32_16x16x32_bf16 v[204:207], v[44:47], v[20:23], v[252:255]
s_lshl_b32 s71, s62, 7
v_mfma_f32_16x16x32_bf16 v[208:211], v[48:51], v[16:19], v[248:251]
v_mfma_f32_16x16x32_bf16 v[212:215], v[48:51], v[20:23], v[252:255]
s_add_u32 s71, s71, 44240896
v_mfma_f32_16x16x32_bf16 v[216:219], v[52:55], v[16:19], v[248:251]
s_and_b32 s63, s57, 3
v_mfma_f32_16x16x32_bf16 v[220:223], v[52:55], v[20:23], v[252:255]
s_lshl_b32 s64, s63, 13
v_mfma_f32_16x16x32_bf16 v[224:227], v[56:59], v[16:19], v[248:251]
s_add_u32 s64, s64, s70
v_mfma_f32_16x16x32_bf16 v[228:231], v[56:59], v[20:23], v[252:255]
s_waitcnt lgkmcnt(0)
s_barrier
v_mfma_f32_16x16x32_bf16 v[160:163], v[68:71], v[60:63], v[160:163]
ds_read_b128 v[16:19], v112 offset:0
s_add_u32 s65, s64, 4096
v_mfma_f32_16x16x32_bf16 v[164:167], v[68:71], v[64:67], v[164:167]
ds_read_b128 v[20:23], v112 offset:2048
v_mfma_f32_16x16x32_bf16 v[168:171], v[72:75], v[60:63], v[168:171]
ds_read_b128 v[24:27], v110 offset:0
s_lshl_b32 s62, s63, 10
v_mfma_f32_16x16x32_bf16 v[172:175], v[72:75], v[64:67], v[172:175]
ds_read_b128 v[28:31], v110 offset:1024
v_mfma_f32_16x16x32_bf16 v[176:179], v[76:79], v[60:63], v[176:179]
ds_read_b128 v[32:35], v110 offset:2048
v_mfma_f32_16x16x32_bf16 v[180:183], v[76:79], v[64:67], v[180:183]
ds_read_b128 v[36:39], v110 offset:3072
s_add_u32 s62, s62, s70
v_mfma_f32_16x16x32_bf16 v[184:187], v[80:83], v[60:63], v[184:187]
ds_read_b128 v[40:43], v110 offset:4096
v_mfma_f32_16x16x32_bf16 v[188:191], v[80:83], v[64:67], v[188:191]
ds_read_b128 v[44:47], v110 offset:5120
v_mfma_f32_16x16x32_bf16 v[192:195], v[84:87], v[60:63], v[192:195]
ds_read_b128 v[48:51], v110 offset:6144
s_add_u32 s62, s62, 32768
v_mfma_f32_16x16x32_bf16 v[196:199], v[84:87], v[64:67], v[196:199]
ds_read_b128 v[52:55], v110 offset:7168
v_mfma_f32_16x16x32_bf16 v[200:203], v[88:91], v[60:63], v[200:203]
ds_read_b128 v[56:59], v110 offset:8192
v_mfma_f32_16x16x32_bf16 v[204:207], v[88:91], v[64:67], v[204:207]
v_lshlrev_b32 v8, 4, v2
v_mfma_f32_16x16x32_bf16 v[208:211], v[92:95], v[60:63], v[208:211]
v_add_u32 v9, 57344, v8
v_mfma_f32_16x16x32_bf16 v[212:215], v[92:95], v[64:67], v[212:215]
v_add_u32 v10, 114688, v8
v_mfma_f32_16x16x32_bf16 v[216:219], v[96:99], v[60:63], v[216:219]
v_mfma_f32_16x16x32_bf16 v[220:223], v[96:99], v[64:67], v[220:223]
v_and_b32 v6, 3, v2
v_mfma_f32_16x16x32_bf16 v[224:227], v[100:103], v[60:63], v[224:227]
v_lshlrev_b32 v6, 2, v6
v_mfma_f32_16x16x32_bf16 v[228:231], v[100:103], v[64:67], v[228:231]
s_waitcnt lgkmcnt(0)
s_mov_b32 s69, 0
L_g2:
v_mfma_f32_16x16x32_bf16 v[160:163], v[24:27], v[16:19], v[160:163]
ds_read_b128 v[60:63], v113 offset:0
Lpad8448:
s_cbranch_execz Lpad8513
v_mfma_f32_16x16x32_bf16 v[164:167], v[24:27], v[20:23], v[164:167]
ds_read_b128 v[64:67], v113 offset:2048
v_mfma_f32_16x16x32_bf16 v[168:171], v[28:31], v[16:19], v[168:171]
ds_read_b128 v[68:71], v110 offset:9216
v_mfma_f32_16x16x32_bf16 v[172:175], v[28:31], v[20:23], v[172:175]
ds_read_b128 v[72:75], v110 offset:10240
v_mfma_f32_16x16x32_bf16 v[176:179], v[32:35], v[16:19], v[176:179]
ds_read_b128 v[76:79], v110 offset:11264
v_mfma_f32_16x16x32_bf16 v[180:183], v[32:35], v[20:23], v[180:183]
ds_read_b128 v[80:83], v110 offset:12288
v_mfma_f32_16x16x32_bf16 v[184:187], v[36:39], v[16:19], v[184:187]
ds_read_b128 v[84:87], v110 offset:13312
v_mfma_f32_16x16x32_bf16 v[188:191], v[36:39], v[20:23], v[188:191]
ds_read_b128 v[88:91], v110 offset:14336
v_mfma_f32_16x16x32_bf16 v[192:195], v[40:43], v[16:19], v[192:195]
ds_read_b128 v[92:95], v110 offset:15360
v_mfma_f32_16x16x32_bf16 v[196:199], v[40:43], v[20:23], v[196:199]
ds_read_b128 v[96:99], v110 offset:16384
v_mfma_f32_16x16x32_bf16 v[200:203], v[44:47], v[16:19], v[200:203]
ds_read_b128 v[100:103], v110 offset:17408
v_mfma_f32_16x16x32_bf16 v[204:207], v[44:47], v[20:23], v[204:207]
v_mfma_f32_16x16x32_bf16 v[208:211], v[48:51], v[16:19], v[208:211]
v_mfma_f32_16x16x32_bf16 v[212:215], v[48:51], v[20:23], v[212:215]
v_mfma_f32_16x16x32_bf16 v[216:219], v[52:55], v[16:19], v[216:219]
v_mfma_f32_16x16x32_bf16 v[220:223], v[52:55], v[20:23], v[220:223]
v_mfma_f32_16x16x32_bf16 v[224:227], v[56:59], v[16:19], v[224:227]
v_mfma_f32_16x16x32_bf16 v[228:231], v[56:59], v[20:23], v[228:231]
s_waitcnt lgkmcnt(0)
s_barrier
v_mfma_f32_16x16x32_bf16 v[160:163], v[68:71], v[60:63], v[160:163]
ds_read_b128 v[16:19], v118 offset:0
v_mfma_f32_16x16x32_bf16 v[164:167], v[68:71], v[64:67], v[164:167]
ds_read_b128 v[20:23], v118 offset:2048
v_mfma_f32_16x16x32_bf16 v[168:171], v[72:75], v[60:63], v[168:171]
ds_read_b128 v[24:27], v116 offset:0
v_mfma_f32_16x16x32_bf16 v[172:175], v[72:75], v[64:67], v[172:175]
ds_read_b128 v[28:31], v116 offset:1024
v_mfma_f32_16x16x32_bf16 v[176:179], v[76:79], v[60:63], v[176:179]
ds_read_b128 v[32:35], v116 offset:2048
v_mfma_f32_16x16x32_bf16 v[180:183], v[76:79], v[64:67], v[180:183]
ds_read_b128 v[36:39], v116 offset:3072
v_mfma_f32_16x16x32_bf16 v[184:187], v[80:83], v[60:63], v[184:187]
ds_read_b128 v[40:43], v116 offset:4096
v_mfma_f32_16x16x32_bf16 v[188:191], v[80:83], v[64:67], v[188:191]
ds_read_b128 v[44:47], v116 offset:5120
v_mfma_f32_16x16x32_bf16 v[192:195], v[84:87], v[60:63], v[192:195]
ds_read_b128 v[48:51], v116 offset:6144
v_mfma_f32_16x16x32_bf16 v[196:199], v[84:87], v[64:67], v[196:199]
ds_read_b128 v[52:55], v116 offset:7168
v_mfma_f32_16x16x32_bf16 v[200:203], v[88:91], v[60:63], v[200:203]
ds_read_b128 v[56:59], v116 offset:8192
v_mfma_f32_16x16x32_bf16 v[204:207], v[88:91], v[64:67], v[204:207]
v_mfma_f32_16x16x32_bf16 v[208:211], v[92:95], v[60:63], v[208:211]
v_mfma_f32_16x16x32_bf16 v[212:215], v[92:95], v[64:67], v[212:215]
v_mfma_f32_16x16x32_bf16 v[216:219], v[96:99], v[60:63], v[216:219]
v_mfma_f32_16x16x32_bf16 v[220:223], v[96:99], v[64:67], v[220:223]
v_mfma_f32_16x16x32_bf16 v[224:227], v[100:103], v[60:63], v[224:227]
v_mfma_f32_16x16x32_bf16 v[228:231], v[100:103], v[64:67], v[228:231]
s_waitcnt lgkmcnt(0)
v_mfma_f32_16x16x32_bf16 v[160:163], v[24:27], v[16:19], v[160:163]
ds_read_b128 v[60:63], v119 offset:0
v_mfma_f32_16x16x32_bf16 v[164:167], v[24:27], v[20:23], v[164:167]
ds_read_b128 v[64:67], v119 offset:2048
v_mfma_f32_16x16x32_bf16 v[168:171], v[28:31], v[16:19], v[168:171]
ds_read_b128 v[68:71], v116 offset:9216
Lpad8513:
s_cbranch_execz Lpad8578
v_mfma_f32_16x16x32_bf16 v[172:175], v[28:31], v[20:23], v[172:175]
ds_read_b128 v[72:75], v116 offset:10240
v_mfma_f32_16x16x32_bf16 v[176:179], v[32:35], v[16:19], v[176:179]
ds_read_b128 v[76:79], v116 offset:11264
v_mfma_f32_16x16x32_bf16 v[180:183], v[32:35], v[20:23], v[180:183]
ds_read_b128 v[80:83], v116 offset:12288
v_mfma_f32_16x16x32_bf16 v[184:187], v[36:39], v[16:19], v[184:187]
ds_read_b128 v[84:87], v116 offset:13312
v_mfma_f32_16x16x32_bf16 v[188:191], v[36:39], v[20:23], v[188:191]
ds_read_b128 v[88:91], v116 offset:14336
v_mfma_f32_16x16x32_bf16 v[192:195], v[40:43], v[16:19], v[192:195]
ds_read_b128 v[92:95], v116 offset:15360
v_mfma_f32_16x16x32_bf16 v[196:199], v[40:43], v[20:23], v[196:199]
ds_read_b128 v[96:99], v116 offset:16384
v_mfma_f32_16x16x32_bf16 v[200:203], v[44:47], v[16:19], v[200:203]
ds_read_b128 v[100:103], v116 offset:17408
v_mfma_f32_16x16x32_bf16 v[204:207], v[44:47], v[20:23], v[204:207]
v_mfma_f32_16x16x32_bf16 v[208:211], v[48:51], v[16:19], v[208:211]
v_mfma_f32_16x16x32_bf16 v[212:215], v[48:51], v[20:23], v[212:215]
v_mfma_f32_16x16x32_bf16 v[216:219], v[52:55], v[16:19], v[216:219]
v_mfma_f32_16x16x32_bf16 v[220:223], v[52:55], v[20:23], v[220:223]
v_mfma_f32_16x16x32_bf16 v[224:227], v[56:59], v[16:19], v[224:227]
v_mfma_f32_16x16x32_bf16 v[228:231], v[56:59], v[20:23], v[228:231]
s_waitcnt lgkmcnt(0)
s_barrier
v_mfma_f32_16x16x32_bf16 v[160:163], v[68:71], v[60:63], v[160:163]
ds_read_b128 v[16:19], v106 offset:0
v_mfma_f32_16x16x32_bf16 v[164:167], v[68:71], v[64:67], v[164:167]
ds_read_b128 v[20:23], v106 offset:2048
v_mfma_f32_16x16x32_bf16 v[168:171], v[72:75], v[60:63], v[168:171]
ds_read_b128 v[24:27], v104 offset:0
v_mfma_f32_16x16x32_bf16 v[172:175], v[72:75], v[64:67], v[172:175]
ds_read_b128 v[28:31], v104 offset:1024
v_mfma_f32_16x16x32_bf16 v[176:179], v[76:79], v[60:63], v[176:179]
ds_read_b128 v[32:35], v104 offset:2048
v_mfma_f32_16x16x32_bf16 v[180:183], v[76:79], v[64:67], v[180:183]
ds_read_b128 v[36:39], v104 offset:3072
v_mfma_f32_16x16x32_bf16 v[184:187], v[80:83], v[60:63], v[184:187]
ds_read_b128 v[40:43], v104 offset:4096
v_mfma_f32_16x16x32_bf16 v[188:191], v[80:83], v[64:67], v[188:191]
ds_read_b128 v[44:47], v104 offset:5120
v_mfma_f32_16x16x32_bf16 v[192:195], v[84:87], v[60:63], v[192:195]
ds_read_b128 v[48:51], v104 offset:6144
v_mfma_f32_16x16x32_bf16 v[196:199], v[84:87], v[64:67], v[196:199]
ds_read_b128 v[52:55], v104 offset:7168
v_mfma_f32_16x16x32_bf16 v[200:203], v[88:91], v[60:63], v[200:203]
ds_read_b128 v[56:59], v104 offset:8192
v_mfma_f32_16x16x32_bf16 v[204:207], v[88:91], v[64:67], v[204:207]
v_mfma_f32_16x16x32_bf16 v[208:211], v[92:95], v[60:63], v[208:211]
v_mfma_f32_16x16x32_bf16 v[212:215], v[92:95], v[64:67], v[212:215]
v_mfma_f32_16x16x32_bf16 v[216:219], v[96:99], v[60:63], v[216:219]
v_mfma_f32_16x16x32_bf16 v[220:223], v[96:99], v[64:67], v[220:223]
v_mfma_f32_16x16x32_bf16 v[224:227], v[100:103], v[60:63], v[224:227]
v_mfma_f32_16x16x32_bf16 v[228:231], v[100:103], v[64:67], v[228:231]
s_waitcnt lgkmcnt(0)
v_mfma_f32_16x16x32_bf16 v[160:163], v[24:27], v[16:19], v[160:163]
ds_read_b128 v[60:63], v107 offset:0
v_mfma_f32_16x16x32_bf16 v[164:167], v[24:27], v[20:23], v[164:167]
ds_read_b128 v[64:67], v107 offset:2048
v_mfma_f32_16x16x32_bf16 v[168:171], v[28:31], v[16:19], v[168:171]
ds_read_b128 v[68:71], v104 offset:9216
v_mfma_f32_16x16x32_bf16 v[172:175], v[28:31], v[20:23], v[172:175]
ds_read_b128 v[72:75], v104 offset:10240
v_mfma_f32_16x16x32_bf16 v[176:179], v[32:35], v[16:19], v[176:179]
ds_read_b128 v[76:79], v104 offset:11264
Lpad8578:
s_cbranch_execz Lback0
v_mfma_f32_16x16x32_bf16 v[180:183], v[32:35], v[20:23], v[180:183]
ds_read_b128 v[80:83], v104 offset:12288
v_mfma_f32_16x16x32_bf16 v[184:187], v[36:39], v[16:19], v[184:187]
ds_read_b128 v[84:87], v104 offset:13312
v_mfma_f32_16x16x32_bf16 v[188:191], v[36:39], v[20:23], v[188:191]
ds_read_b128 v[88:91], v104 offset:14336
v_mfma_f32_16x16x32_bf16 v[192:195], v[40:43], v[16:19], v[192:195]
ds_read_b128 v[92:95], v104 offset:15360
v_mfma_f32_16x16x32_bf16 v[196:199], v[40:43], v[20:23], v[196:199]
ds_read_b128 v[96:99], v104 offset:16384
v_mfma_f32_16x16x32_bf16 v[200:203], v[44:47], v[16:19], v[200:203]
ds_read_b128 v[100:103], v104 offset:17408
v_mfma_f32_16x16x32_bf16 v[204:207], v[44:47], v[20:23], v[204:207]
v_mfma_f32_16x16x32_bf16 v[208:211], v[48:51], v[16:19], v[208:211]
v_mfma_f32_16x16x32_bf16 v[212:215], v[48:51], v[20:23], v[212:215]
v_mfma_f32_16x16x32_bf16 v[216:219], v[52:55], v[16:19], v[216:219]
v_mfma_f32_16x16x32_bf16 v[220:223], v[52:55], v[20:23], v[220:223]
v_mfma_f32_16x16x32_bf16 v[224:227], v[56:59], v[16:19], v[224:227]
v_mfma_f32_16x16x32_bf16 v[228:231], v[56:59], v[20:23], v[228:231]
s_waitcnt lgkmcnt(0)
s_barrier
v_mfma_f32_16x16x32_bf16 v[160:163], v[68:71], v[60:63], v[160:163]
ds_read_b128 v[16:19], v112 offset:0
s_add_u32 s69, s69, 1
v_mfma_f32_16x16x32_bf16 v[164:167], v[68:71], v[64:67], v[164:167]
ds_read_b128 v[20:23], v112 offset:2048
v_mfma_f32_16x16x32_bf16 v[168:171], v[72:75], v[60:63], v[168:171]
ds_read_b128 v[24:27], v110 offset:0
v_mfma_f32_16x16x32_bf16 v[172:175], v[72:75], v[64:67], v[172:175]
ds_read_b128 v[28:31], v110 offset:1024
v_mfma_f32_16x16x32_bf16 v[176:179], v[76:79], v[60:63], v[176:179]
ds_read_b128 v[32:35], v110 offset:2048
v_mfma_f32_16x16x32_bf16 v[180:183], v[76:79], v[64:67], v[180:183]
ds_read_b128 v[36:39], v110 offset:3072
v_mfma_f32_16x16x32_bf16 v[184:187], v[80:83], v[60:63], v[184:187]
ds_read_b128 v[40:43], v110 offset:4096
v_mfma_f32_16x16x32_bf16 v[188:191], v[80:83], v[64:67], v[188:191]
ds_read_b128 v[44:47], v110 offset:5120
v_mfma_f32_16x16x32_bf16 v[192:195], v[84:87], v[60:63], v[192:195]
ds_read_b128 v[48:51], v110 offset:6144
v_mfma_f32_16x16x32_bf16 v[196:199], v[84:87], v[64:67], v[196:199]
ds_read_b128 v[52:55], v110 offset:7168
v_mfma_f32_16x16x32_bf16 v[200:203], v[88:91], v[60:63], v[200:203]
ds_read_b128 v[56:59], v110 offset:8192
v_mfma_f32_16x16x32_bf16 v[204:207], v[88:91], v[64:67], v[204:207]
s_cmp_lt_u32 s69, 10
v_mfma_f32_16x16x32_bf16 v[208:211], v[92:95], v[60:63], v[208:211]
v_mfma_f32_16x16x32_bf16 v[212:215], v[92:95], v[64:67], v[212:215]
v_mfma_f32_16x16x32_bf16 v[216:219], v[96:99], v[60:63], v[216:219]
v_mfma_f32_16x16x32_bf16 v[220:223], v[96:99], v[64:67], v[220:223]
v_mfma_f32_16x16x32_bf16 v[224:227], v[100:103], v[60:63], v[224:227]
v_mfma_f32_16x16x32_bf16 v[228:231], v[100:103], v[64:67], v[228:231]
s_waitcnt lgkmcnt(0)
s_cbranch_scc1 L_g2
v_mfma_f32_16x16x32_bf16 v[160:163], v[24:27], v[16:19], v[160:163]
ds_read_b128 v[60:63], v113 offset:0
v_mfma_f32_16x16x32_bf16 v[164:167], v[24:27], v[20:23], v[164:167]
ds_read_b128 v[64:67], v113 offset:2048
v_mfma_f32_16x16x32_bf16 v[168:171], v[28:31], v[16:19], v[168:171]
ds_read_b128 v[68:71], v110 offset:9216
v_mfma_f32_16x16x32_bf16 v[172:175], v[28:31], v[20:23], v[172:175]
ds_read_b128 v[72:75], v110 offset:10240
v_mfma_f32_16x16x32_bf16 v[176:179], v[32:35], v[16:19], v[176:179]
ds_read_b128 v[76:79], v110 offset:11264
v_mfma_f32_16x16x32_bf16 v[180:183], v[32:35], v[20:23], v[180:183]
ds_read_b128 v[80:83], v110 offset:12288
Lpad8644:
s_cbranch_execz Lpad8713
v_mfma_f32_16x16x32_bf16 v[184:187], v[36:39], v[16:19], v[184:187]
ds_read_b128 v[84:87], v110 offset:13312
v_mfma_f32_16x16x32_bf16 v[188:191], v[36:39], v[20:23], v[188:191]
ds_read_b128 v[88:91], v110 offset:14336
v_mfma_f32_16x16x32_bf16 v[192:195], v[40:43], v[16:19], v[192:195]
ds_read_b128 v[92:95], v110 offset:15360
v_mfma_f32_16x16x32_bf16 v[196:199], v[40:43], v[20:23], v[196:199]
ds_read_b128 v[96:99], v110 offset:16384
v_mfma_f32_16x16x32_bf16 v[200:203], v[44:47], v[16:19], v[200:203]
ds_read_b128 v[100:103], v110 offset:17408
v_mfma_f32_16x16x32_bf16 v[204:207], v[44:47], v[20:23], v[204:207]
v_mfma_f32_16x16x32_bf16 v[208:211], v[48:51], v[16:19], v[208:211]
v_mfma_f32_16x16x32_bf16 v[212:215], v[48:51], v[20:23], v[212:215]
v_mfma_f32_16x16x32_bf16 v[216:219], v[52:55], v[16:19], v[216:219]
v_mfma_f32_16x16x32_bf16 v[220:223], v[52:55], v[20:23], v[220:223]
v_mfma_f32_16x16x32_bf16 v[224:227], v[56:59], v[16:19], v[224:227]
v_mfma_f32_16x16x32_bf16 v[228:231], v[56:59], v[20:23], v[228:231]
s_waitcnt lgkmcnt(0)
s_barrier
v_mfma_f32_16x16x32_bf16 v[160:163], v[68:71], v[60:63], v[160:163]
v_mfma_f32_16x16x32_bf16 v[164:167], v[68:71], v[64:67], v[164:167]
v_mfma_f32_16x16x32_bf16 v[168:171], v[72:75], v[60:63], v[168:171]
v_mfma_f32_16x16x32_bf16 v[172:175], v[72:75], v[64:67], v[172:175]
v_mfma_f32_16x16x32_bf16 v[176:179], v[76:79], v[60:63], v[176:179]
v_mfma_f32_16x16x32_bf16 v[180:183], v[76:79], v[64:67], v[180:183]
v_mfma_f32_16x16x32_bf16 v[184:187], v[80:83], v[60:63], v[184:187]
v_mfma_f32_16x16x32_bf16 v[188:191], v[80:83], v[64:67], v[188:191]
v_mfma_f32_16x16x32_bf16 v[192:195], v[84:87], v[60:63], v[192:195]
v_mfma_f32_16x16x32_bf16 v[196:199], v[84:87], v[64:67], v[196:199]
v_mfma_f32_16x16x32_bf16 v[200:203], v[88:91], v[60:63], v[200:203]
v_mfma_f32_16x16x32_bf16 v[204:207], v[88:91], v[64:67], v[204:207]
v_mfma_f32_16x16x32_bf16 v[208:211], v[92:95], v[60:63], v[208:211]
v_mfma_f32_16x16x32_bf16 v[212:215], v[92:95], v[64:67], v[212:215]
v_mfma_f32_16x16x32_bf16 v[216:219], v[96:99], v[60:63], v[216:219]
v_mfma_f32_16x16x32_bf16 v[220:223], v[96:99], v[64:67], v[220:223]
v_mfma_f32_16x16x32_bf16 v[224:227], v[100:103], v[60:63], v[224:227]
v_mfma_f32_16x16x32_bf16 v[228:231], v[100:103], v[64:67], v[228:231]
v_lshlrev_b32 v12, 16, v122
v_and_b32 v13, 0xffff0000, v122
v_pk_mul_f32 v[12:13], v[12:13], v[160:161]
v_cvt_pk_bf16_f32 v16, v12, v13
v_lshlrev_b32 v14, 16, v123
v_and_b32 v15, 0xffff0000, v123
v_pk_mul_f32 v[14:15], v[14:15], v[162:163]
v_cvt_pk_bf16_f32 v17, v14, v15
v_lshlrev_b32 v12, 16, v124
v_and_b32 v13, 0xffff0000, v124
v_pk_mul_f32 v[12:13], v[12:13], v[164:165]
v_cvt_pk_bf16_f32 v20, v12, v13
v_lshlrev_b32 v14, 16, v125
v_and_b32 v15, 0xffff0000, v125
v_pk_mul_f32 v[14:15], v[14:15], v[166:167]
v_cvt_pk_bf16_f32 v21, v14, v15
v_lshlrev_b32 v12, 16, v126
v_and_b32 v13, 0xffff0000, v126
v_pk_mul_f32 v[12:13], v[12:13], v[168:169]
v_cvt_pk_bf16_f32 v18, v12, v13
v_lshlrev_b32 v14, 16, v127
v_and_b32 v15, 0xffff0000, v127
v_pk_mul_f32 v[14:15], v[14:15], v[170:171]
v_cvt_pk_bf16_f32 v19, v14, v15
v_lshlrev_b32 v12, 16, v128
v_and_b32 v13, 0xffff0000, v128
v_pk_mul_f32 v[12:13], v[12:13], v[172:173]
v_cvt_pk_bf16_f32 v22, v12, v13
v_lshlrev_b32 v14, 16, v129
v_and_b32 v15, 0xffff0000, v129
v_pk_mul_f32 v[14:15], v[14:15], v[174:175]
v_cvt_pk_bf16_f32 v23, v14, v15
Lpad8713:
s_cbranch_execz Lpad8785
buffer_store_dwordx4 v[16:19], v8, s[20:23], s64 offen offset:0 sc1
buffer_store_dwordx4 v[20:23], v8, s[20:23], s64 offen offset:1024 sc1
v_lshlrev_b32 v12, 16, v130
v_and_b32 v13, 0xffff0000, v130
v_pk_mul_f32 v[12:13], v[12:13], v[176:177]
v_cvt_pk_bf16_f32 v24, v12, v13
v_lshlrev_b32 v14, 16, v131
v_and_b32 v15, 0xffff0000, v131
v_pk_mul_f32 v[14:15], v[14:15], v[178:179]
v_cvt_pk_bf16_f32 v25, v14, v15
v_lshlrev_b32 v12, 16, v132
v_and_b32 v13, 0xffff0000, v132
v_pk_mul_f32 v[12:13], v[12:13], v[180:181]
v_cvt_pk_bf16_f32 v28, v12, v13
v_lshlrev_b32 v14, 16, v133
v_and_b32 v15, 0xffff0000, v133
v_pk_mul_f32 v[14:15], v[14:15], v[182:183]
v_cvt_pk_bf16_f32 v29, v14, v15
v_lshlrev_b32 v12, 16, v134
v_and_b32 v13, 0xffff0000, v134
v_pk_mul_f32 v[12:13], v[12:13], v[184:185]
v_cvt_pk_bf16_f32 v26, v12, v13
v_lshlrev_b32 v14, 16, v135
v_and_b32 v15, 0xffff0000, v135
v_pk_mul_f32 v[14:15], v[14:15], v[186:187]
v_cvt_pk_bf16_f32 v27, v14, v15
v_lshlrev_b32 v12, 16, v136
v_and_b32 v13, 0xffff0000, v136
v_pk_mul_f32 v[12:13], v[12:13], v[188:189]
v_cvt_pk_bf16_f32 v30, v12, v13
v_lshlrev_b32 v14, 16, v137
v_and_b32 v15, 0xffff0000, v137
v_pk_mul_f32 v[14:15], v[14:15], v[190:191]
v_cvt_pk_bf16_f32 v31, v14, v15
buffer_store_dwordx4 v[24:27], v8, s[20:23], s64 offen offset:2048 sc1
buffer_store_dwordx4 v[28:31], v8, s[20:23], s64 offen offset:3072 sc1
v_lshlrev_b32 v12, 16, v138
v_and_b32 v13, 0xffff0000, v138
v_pk_mul_f32 v[12:13], v[12:13], v[192:193]
v_cvt_pk_bf16_f32 v32, v12, v13
v_lshlrev_b32 v14, 16, v139
v_and_b32 v15, 0xffff0000, v139
v_pk_mul_f32 v[14:15], v[14:15], v[194:195]
v_cvt_pk_bf16_f32 v33, v14, v15
v_lshlrev_b32 v12, 16, v140
v_and_b32 v13, 0xffff0000, v140
v_pk_mul_f32 v[12:13], v[12:13], v[196:197]
v_cvt_pk_bf16_f32 v36, v12, v13
v_lshlrev_b32 v14, 16, v141
v_and_b32 v15, 0xffff0000, v141
v_pk_mul_f32 v[14:15], v[14:15], v[198:199]
v_cvt_pk_bf16_f32 v37, v14, v15
v_lshlrev_b32 v12, 16, v142
v_and_b32 v13, 0xffff0000, v142
v_pk_mul_f32 v[12:13], v[12:13], v[200:201]
v_cvt_pk_bf16_f32 v34, v12, v13
v_lshlrev_b32 v14, 16, v143
v_and_b32 v15, 0xffff0000, v143
v_pk_mul_f32 v[14:15], v[14:15], v[202:203]
v_cvt_pk_bf16_f32 v35, v14, v15
v_lshlrev_b32 v12, 16, v144
v_and_b32 v13, 0xffff0000, v144
v_pk_mul_f32 v[12:13], v[12:13], v[204:205]
v_cvt_pk_bf16_f32 v38, v12, v13
v_lshlrev_b32 v14, 16, v145
v_and_b32 v15, 0xffff0000, v145
v_pk_mul_f32 v[14:15], v[14:15], v[206:207]
v_cvt_pk_bf16_f32 v39, v14, v15
buffer_store_dwordx4 v[32:35], v8, s[20:23], s65 offen offset:0 sc1
buffer_store_dwordx4 v[36:39], v8, s[20:23], s65 offen offset:1024 sc1
v_lshlrev_b32 v12, 16, v146
v_and_b32 v13, 0xffff0000, v146
Lpad8785:
s_cbranch_execz Lpad1079
v_pk_mul_f32 v[12:13], v[12:13], v[208:209]
v_cvt_pk_bf16_f32 v40, v12, v13
v_lshlrev_b32 v14, 16, v147
v_and_b32 v15, 0xffff0000, v147
v_pk_mul_f32 v[14:15], v[14:15], v[210:211]
v_cvt_pk_bf16_f32 v41, v14, v15
v_lshlrev_b32 v12, 16, v148
v_and_b32 v13, 0xffff0000, v148
v_pk_mul_f32 v[12:13], v[12:13], v[212:213]
v_cvt_pk_bf16_f32 v44, v12, v13
v_lshlrev_b32 v14, 16, v149
v_and_b32 v15, 0xffff0000, v149
v_pk_mul_f32 v[14:15], v[14:15], v[214:215]
v_cvt_pk_bf16_f32 v45, v14, v15
v_lshlrev_b32 v12, 16, v150
v_and_b32 v13, 0xffff0000, v150
v_pk_mul_f32 v[12:13], v[12:13], v[216:217]
v_cvt_pk_bf16_f32 v42, v12, v13
v_lshlrev_b32 v14, 16, v151
v_and_b32 v15, 0xffff0000, v151
v_pk_mul_f32 v[14:15], v[14:15], v[218:219]
v_cvt_pk_bf16_f32 v43, v14, v15
v_lshlrev_b32 v12, 16, v152
v_and_b32 v13, 0xffff0000, v152
v_pk_mul_f32 v[12:13], v[12:13], v[220:221]
v_cvt_pk_bf16_f32 v46, v12, v13
v_lshlrev_b32 v14, 16, v153
v_and_b32 v15, 0xffff0000, v153
v_pk_mul_f32 v[14:15], v[14:15], v[222:223]
v_cvt_pk_bf16_f32 v47, v14, v15
buffer_store_dwordx4 v[40:43], v8, s[20:23], s65 offen offset:2048 sc1
buffer_store_dwordx4 v[44:47], v8, s[20:23], s65 offen offset:3072 sc1
v_lshlrev_b32 v12, 16, v154
v_and_b32 v13, 0xffff0000, v154
v_pk_mul_f32 v[12:13], v[12:13], v[224:225]
v_cvt_pk_bf16_f32 v48, v12, v13
v_lshlrev_b32 v14, 16, v155
v_and_b32 v15, 0xffff0000, v155
v_pk_mul_f32 v[14:15], v[14:15], v[226:227]
v_cvt_pk_bf16_f32 v49, v14, v15
v_lshlrev_b32 v12, 16, v156
v_and_b32 v13, 0xffff0000, v156
v_pk_mul_f32 v[12:13], v[12:13], v[228:229]
v_cvt_pk_bf16_f32 v50, v12, v13
v_lshlrev_b32 v14, 16, v157
v_and_b32 v15, 0xffff0000, v157
v_pk_mul_f32 v[14:15], v[14:15], v[230:231]
v_cvt_pk_bf16_f32 v51, v14, v15
buffer_store_dwordx4 v[48:51], v8, s[20:23], s62 offen sc1
s_bfe_u32 s69, s2, 65541
s_lshl_b32 s69, s69, 2
s_add_u32 s69, s69, s58
s_mov_b32 s3, 1
s_mov_b64 exec, 0
s_cmp_eq_u32 s69, 0
s_cbranch_scc1 Lpad8872
s_cmp_eq_u32 s69, 1
s_cbranch_scc1 Lpad9019
s_cmp_eq_u32 s69, 2
s_cbranch_scc1 Lpad9102
s_cmp_eq_u32 s69, 3
s_cbranch_scc1 Lpad9245
s_cmp_eq_u32 s69, 4
s_cbranch_scc1 Lpad9318
s_cmp_eq_u32 s69, 5
s_cbranch_scc1 Lpad9394
s_cmp_eq_u32 s69, 6
s_cbranch_scc1 Lpad9536
s_branch Lpad9606
Lback2:
s_cmp_eq_u32 s3, 1
s_mov_b32 s3, 0
s_mov_b64 exec, -1
L_hd:
s_lshl_b32 s62, s63, 2
s_add_u32 s62, s62, s71
s_waitcnt vmcnt(0)
v_mov_b32 v3, 0
v_mov_b32 v4, s59
s_mov_b64 exec, 1
buffer_store_dword v4, v3, s[20:23], s62 offen sc1
s_mov_b64 exec, -1
L_hf:
s_barrier
ds_read_b128 v[232:235], v9 offset:16384
ds_read_b128 v[236:239], v9 offset:17408
ds_read_b128 v[240:243], v9 offset:18432
Lpad8872:
s_cbranch_execz Lpad8944
ds_read_b128 v[244:247], v9 offset:19456
ds_read_b128 v[248:251], v9 offset:20480
s_waitcnt lgkmcnt(4)
v_mfma_f32_16x16x32_bf16 v[160:163], v[232:235], v[16:19], 0
ds_read_b128 v[252:255], v9 offset:21504
v_mfma_f32_16x16x32_bf16 v[164:167], v[232:235], v[20:23], 0
s_waitcnt lgkmcnt(4)
v_mfma_f32_16x16x32_bf16 v[168:171], v[236:239], v[16:19], 0
ds_read_b128 v[232:235], v9 offset:22528
v_mfma_f32_16x16x32_bf16 v[172:175], v[236:239], v[20:23], 0
s_waitcnt lgkmcnt(4)
v_mfma_f32_16x16x32_bf16 v[176:179], v[240:243], v[16:19], 0
ds_read_b128 v[236:239], v9 offset:23552
v_mfma_f32_16x16x32_bf16 v[180:183], v[240:243], v[20:23], 0
s_waitcnt lgkmcnt(4)
v_mfma_f32_16x16x32_bf16 v[184:187], v[244:247], v[16:19], 0
ds_read_b128 v[240:243], v9 offset:24576
v_mfma_f32_16x16x32_bf16 v[188:191], v[244:247], v[20:23], 0
s_waitcnt lgkmcnt(4)
v_mfma_f32_16x16x32_bf16 v[192:195], v[248:251], v[16:19], 0
ds_read_b128 v[244:247], v9 offset:25600
v_mfma_f32_16x16x32_bf16 v[196:199], v[248:251], v[20:23], 0
s_waitcnt lgkmcnt(4)
v_mfma_f32_16x16x32_bf16 v[200:203], v[252:255], v[16:19], 0
ds_read_b128 v[248:251], v9 offset:26624
v_mfma_f32_16x16x32_bf16 v[204:207], v[252:255], v[20:23], 0
s_waitcnt lgkmcnt(4)
v_mfma_f32_16x16x32_bf16 v[208:211], v[232:235], v[16:19], 0
ds_read_b128 v[252:255], v9 offset:27648
v_mfma_f32_16x16x32_bf16 v[212:215], v[232:235], v[20:23], 0
s_waitcnt lgkmcnt(4)
v_mfma_f32_16x16x32_bf16 v[216:219], v[236:239], v[16:19], 0
ds_read_b128 v[232:235], v9 offset:28672
v_mfma_f32_16x16x32_bf16 v[220:223], v[236:239], v[20:23], 0
s_waitcnt lgkmcnt(4)
v_mfma_f32_16x16x32_bf16 v[224:227], v[240:243], v[16:19], 0
ds_read_b128 v[236:239], v9 offset:29696
v_mfma_f32_16x16x32_bf16 v[228:231], v[240:243], v[20:23], 0
s_waitcnt lgkmcnt(4)
v_mfma_f32_16x16x32_bf16 v[160:163], v[244:247], v[24:27], v[160:163]
ds_read_b128 v[240:243], v9 offset:30720
v_mfma_f32_16x16x32_bf16 v[164:167], v[244:247], v[28:31], v[164:167]
s_waitcnt lgkmcnt(4)
v_mfma_f32_16x16x32_bf16 v[168:171], v[248:251], v[24:27], v[168:171]
ds_read_b128 v[244:247], v9 offset:31744
v_mfma_f32_16x16x32_bf16 v[172:175], v[248:251], v[28:31], v[172:175]
s_waitcnt lgkmcnt(4)
v_mfma_f32_16x16x32_bf16 v[176:179], v[252:255], v[24:27], v[176:179]
ds_read_b128 v[248:251], v9 offset:32768
v_mfma_f32_16x16x32_bf16 v[180:183], v[252:255], v[28:31], v[180:183]
s_waitcnt lgkmcnt(4)
v_mfma_f32_16x16x32_bf16 v[184:187], v[232:235], v[24:27], v[184:187]
ds_read_b128 v[252:255], v9 offset:33792
v_mfma_f32_16x16x32_bf16 v[188:191], v[232:235], v[28:31], v[188:191]
s_waitcnt lgkmcnt(4)
v_mfma_f32_16x16x32_bf16 v[192:195], v[236:239], v[24:27], v[192:195]
ds_read_b128 v[232:235], v8 offset:0
v_mfma_f32_16x16x32_bf16 v[196:199], v[236:239], v[28:31], v[196:199]
s_waitcnt lgkmcnt(4)
v_mfma_f32_16x16x32_bf16 v[200:203], v[240:243], v[24:27], v[200:203]
ds_read_b128 v[236:239], v8 offset:1024
v_mfma_f32_16x16x32_bf16 v[204:207], v[240:243], v[28:31], v[204:207]
s_waitcnt lgkmcnt(4)
v_mfma_f32_16x16x32_bf16 v[208:211], v[244:247], v[24:27], v[208:211]
ds_read_b128 v[240:243], v8 offset:2048
v_mfma_f32_16x16x32_bf16 v[212:215], v[244:247], v[28:31], v[212:215]
s_waitcnt lgkmcnt(4)
v_mfma_f32_16x16x32_bf16 v[216:219], v[248:251], v[24:27], v[216:219]
ds_read_b128 v[244:247], v8 offset:3072
v_mfma_f32_16x16x32_bf16 v[220:223], v[248:251], v[28:31], v[220:223]
s_waitcnt lgkmcnt(4)
v_mfma_f32_16x16x32_bf16 v[224:227], v[252:255], v[24:27], v[224:227]
Lpad8944:
s_cbranch_execz Lback2
ds_read_b128 v[248:251], v8 offset:4096
v_mfma_f32_16x16x32_bf16 v[228:231], v[252:255], v[28:31], v[228:231]
s_waitcnt lgkmcnt(4)
v_mfma_f32_16x16x32_bf16 v[160:163], v[232:235], v[32:35], v[160:163]
ds_read_b128 v[252:255], v8 offset:5120
v_mfma_f32_16x16x32_bf16 v[164:167], v[232:235], v[36:39], v[164:167]
s_waitcnt lgkmcnt(4)
v_mfma_f32_16x16x32_bf16 v[168:171], v[236:239], v[32:35], v[168:171]
ds_read_b128 v[232:235], v8 offset:6144
v_mfma_f32_16x16x32_bf16 v[172:175], v[236:239], v[36:39], v[172:175]
s_waitcnt lgkmcnt(4)
v_mfma_f32_16x16x32_bf16 v[176:179], v[240:243], v[32:35], v[176:179]
ds_read_b128 v[236:239], v8 offset:7168
v_mfma_f32_16x16x32_bf16 v[180:183], v[240:243], v[36:39], v[180:183]
s_waitcnt lgkmcnt(4)
v_mfma_f32_16x16x32_bf16 v[184:187], v[244:247], v[32:35], v[184:187]
ds_read_b128 v[240:243], v8 offset:8192
v_mfma_f32_16x16x32_bf16 v[188:191], v[244:247], v[36:39], v[188:191]
s_waitcnt lgkmcnt(4)
v_mfma_f32_16x16x32_bf16 v[192:195], v[248:251], v[32:35], v[192:195]
ds_read_b128 v[244:247], v8 offset:9216
v_mfma_f32_16x16x32_bf16 v[196:199], v[248:251], v[36:39], v[196:199]
s_waitcnt lgkmcnt(4)
v_mfma_f32_16x16x32_bf16 v[200:203], v[252:255], v[32:35], v[200:203]
ds_read_b128 v[248:251], v8 offset:10240
v_mfma_f32_16x16x32_bf16 v[204:207], v[252:255], v[36:39], v[204:207]
s_waitcnt lgkmcnt(4)
v_mfma_f32_16x16x32_bf16 v[208:211], v[232:235], v[32:35], v[208:211]
ds_read_b128 v[252:255], v8 offset:11264
v_mfma_f32_16x16x32_bf16 v[212:215], v[232:235], v[36:39], v[212:215]
s_waitcnt lgkmcnt(4)
v_mfma_f32_16x16x32_bf16 v[216:219], v[236:239], v[32:35], v[216:219]
ds_read_b128 v[232:235], v8 offset:12288
v_mfma_f32_16x16x32_bf16 v[220:223], v[236:239], v[36:39], v[220:223]
s_waitcnt lgkmcnt(4)
v_mfma_f32_16x16x32_bf16 v[224:227], v[240:243], v[32:35], v[224:227]
ds_read_b128 v[236:239], v8 offset:13312
v_mfma_f32_16x16x32_bf16 v[228:231], v[240:243], v[36:39], v[228:231]
s_waitcnt lgkmcnt(4)
v_mfma_f32_16x16x32_bf16 v[160:163], v[244:247], v[40:43], v[160:163]
ds_read_b128 v[240:243], v8 offset:14336
v_mfma_f32_16x16x32_bf16 v[164:167], v[244:247], v[44:47], v[164:167]
s_waitcnt lgkmcnt(4)
v_mfma_f32_16x16x32_bf16 v[168:171], v[248:251], v[40:43], v[168:171]
ds_read_b128 v[244:247], v8 offset:15360
v_mfma_f32_16x16x32_bf16 v[172:175], v[248:251], v[44:47], v[172:175]
s_waitcnt lgkmcnt(4)
v_mfma_f32_16x16x32_bf16 v[176:179], v[252:255], v[40:43], v[176:179]
ds_read_b128 v[248:251], v8 offset:16384
v_mfma_f32_16x16x32_bf16 v[180:183], v[252:255], v[44:47], v[180:183]
s_waitcnt lgkmcnt(4)
v_mfma_f32_16x16x32_bf16 v[184:187], v[232:235], v[40:43], v[184:187]
ds_read_b128 v[252:255], v8 offset:17408
v_mfma_f32_16x16x32_bf16 v[188:191], v[232:235], v[44:47], v[188:191]
s_waitcnt lgkmcnt(4)
v_mfma_f32_16x16x32_bf16 v[192:195], v[236:239], v[40:43], v[192:195]
v_mfma_f32_16x16x32_bf16 v[196:199], v[236:239], v[44:47], v[196:199]
s_waitcnt lgkmcnt(3)
v_mfma_f32_16x16x32_bf16 v[200:203], v[240:243], v[40:43], v[200:203]
v_mfma_f32_16x16x32_bf16 v[204:207], v[240:243], v[44:47], v[204:207]
s_waitcnt lgkmcnt(2)
v_mfma_f32_16x16x32_bf16 v[208:211], v[244:247], v[40:43], v[208:211]
v_mfma_f32_16x16x32_bf16 v[212:215], v[244:247], v[44:47], v[212:215]
s_waitcnt lgkmcnt(1)
v_mfma_f32_16x16x32_bf16 v[216:219], v[248:251], v[40:43], v[216:219]
v_mfma_f32_16x16x32_bf16 v[220:223], v[248:251], v[44:47], v[220:223]
s_waitcnt lgkmcnt(0)
v_mfma_f32_16x16x32_bf16 v[224:227], v[252:255], v[40:43], v[224:227]
v_mfma_f32_16x16x32_bf16 v[228:231], v[252:255], v[44:47], v[228:231]
s_barrier
buffer_load_dword v3, v6, s[20:23], s71 offen offset:0 sc1
s_lshl_b32 s62, s56, 2
s_add_u32 s62, s62, s63
s_lshl_b32 s62, s62, 2
s_add_u32 s62, s62, s58
Lpad9019:
s_cbranch_execz Lback2
s_lshr_b32 s64, s57, 2
s_lshl_b32 s68, s62, 7
s_lshl_b32 s65, s64, 2
s_add_u32 s68, s68, s65
s_add_u32 s68, s68, 44273664
s_lshl_b32 s62, s62, 2
s_add_u32 s62, s62, s64
s_mul_i32 s62, s62, 9216
s_add_u32 s62, s62, 34775040
s_cmp_eq_u32 s64, s58
s_cselect_b32 s72, 0x40000000, s62
s_add_u32 s73, s72, 4096
s_add_u32 s74, s72, 8192
s_cmp_eq_u32 s64, s58
s_cselect_b32 s62, 0, 9216
s_add_u32 s62, s62, 141312
v_add_u32 v7, s62, v8
s_add_u32 s62, s63, 1
s_and_b32 s62, s62, 3
s_lshl_b32 s62, s62, 13
s_add_u32 s76, s62, s70
s_add_u32 s77, s76, 4096
s_add_u32 s62, s63, 2
s_and_b32 s62, s62, 3
s_lshl_b32 s62, s62, 13
s_add_u32 s78, s62, s70
s_add_u32 s79, s78, 4096
s_add_u32 s62, s63, 3
s_and_b32 s62, s62, 3
s_lshl_b32 s62, s62, 13
s_add_u32 s80, s62, s70
s_add_u32 s81, s80, 4096
s_add_u32 s82, s70, 32768
s_waitcnt vmcnt(0)
Lp2:
v_cmp_ne_u32 vcc, s59, v3
s_cbranch_vccz Lq3
buffer_load_dword v3, v6, s[20:23], s71 offen offset:0 sc1
s_waitcnt vmcnt(0)
s_add_u32 s60, s60, 1
s_cmp_lt_u32 s60, 131072
s_cbranch_scc1 Lp2
Lq3:
buffer_load_dwordx4 v[48:51], v8, s[20:23], s76 offen offset:0 sc1
buffer_load_dwordx4 v[52:55], v8, s[20:23], s76 offen offset:1024 sc1
buffer_load_dwordx4 v[56:59], v8, s[20:23], s76 offen offset:2048 sc1
buffer_load_dwordx4 v[60:63], v8, s[20:23], s76 offen offset:3072 sc1
buffer_load_dwordx4 v[64:67], v8, s[20:23], s77 offen offset:0 sc1
buffer_load_dwordx4 v[68:71], v8, s[20:23], s77 offen offset:1024 sc1
buffer_load_dwordx4 v[72:75], v8, s[20:23], s77 offen offset:2048 sc1
s_barrier
ds_read_b128 v[232:235], v8 offset:18432
ds_read_b128 v[236:239], v8 offset:19456
ds_read_b128 v[240:243], v8 offset:20480
ds_read_b128 v[244:247], v8 offset:21504
ds_read_b128 v[248:251], v8 offset:22528
s_waitcnt vmcnt(5) lgkmcnt(4)
v_mfma_f32_16x16x32_bf16 v[160:163], v[232:235], v[48:51], v[160:163]
ds_read_b128 v[252:255], v8 offset:23552
v_mfma_f32_16x16x32_bf16 v[164:167], v[232:235], v[52:55], v[164:167]
buffer_load_dwordx4 v[76:79], v8, s[20:23], s77 offen offset:3072 sc1
s_waitcnt lgkmcnt(4)
v_mfma_f32_16x16x32_bf16 v[168:171], v[236:239], v[48:51], v[168:171]
ds_read_b128 v[232:235], v8 offset:24576
v_mfma_f32_16x16x32_bf16 v[172:175], v[236:239], v[52:55], v[172:175]
s_waitcnt lgkmcnt(4)
v_mfma_f32_16x16x32_bf16 v[176:179], v[240:243], v[48:51], v[176:179]
ds_read_b128 v[236:239], v8 offset:25600
v_mfma_f32_16x16x32_bf16 v[180:183], v[240:243], v[52:55], v[180:183]
buffer_load_dwordx4 v[80:83], v8, s[20:23], s78 offen offset:0 sc1
s_waitcnt lgkmcnt(4)
v_mfma_f32_16x16x32_bf16 v[184:187], v[244:247], v[48:51], v[184:187]
ds_read_b128 v[240:243], v8 offset:26624
v_mfma_f32_16x16x32_bf16 v[188:191], v[244:247], v[52:55], v[188:191]
s_waitcnt lgkmcnt(4)
v_mfma_f32_16x16x32_bf16 v[192:195], v[248:251], v[48:51], v[192:195]
ds_read_b128 v[244:247], v8 offset:27648
v_mfma_f32_16x16x32_bf16 v[196:199], v[248:251], v[52:55], v[196:199]
buffer_load_dwordx4 v[84:87], v8, s[20:23], s78 offen offset:1024 sc1
s_waitcnt lgkmcnt(4)
v_mfma_f32_16x16x32_bf16 v[200:203], v[252:255], v[48:51], v[200:203]
ds_read_b128 v[248:251], v8 offset:28672
v_mfma_f32_16x16x32_bf16 v[204:207], v[252:255], v[52:55], v[204:207]
Lpad9102:
s_cbranch_execz Lpad9174
s_waitcnt lgkmcnt(4)
v_mfma_f32_16x16x32_bf16 v[208:211], v[232:235], v[48:51], v[208:211]
ds_read_b128 v[252:255], v8 offset:29696
v_mfma_f32_16x16x32_bf16 v[212:215], v[232:235], v[52:55], v[212:215]
buffer_load_dwordx4 v[88:91], v8, s[20:23], s78 offen offset:2048 sc1
s_waitcnt lgkmcnt(4)
v_mfma_f32_16x16x32_bf16 v[216:219], v[236:239], v[48:51], v[216:219]
ds_read_b128 v[232:235], v8 offset:30720
v_mfma_f32_16x16x32_bf16 v[220:223], v[236:239], v[52:55], v[220:223]
s_waitcnt lgkmcnt(4)
v_mfma_f32_16x16x32_bf16 v[224:227], v[240:243], v[48:51], v[224:227]
ds_read_b128 v[236:239], v8 offset:31744
v_mfma_f32_16x16x32_bf16 v[228:231], v[240:243], v[52:55], v[228:231]
buffer_load_dwordx4 v[92:95], v8, s[20:23], s78 offen offset:3072 sc1
s_waitcnt vmcnt(8) lgkmcnt(4)
v_mfma_f32_16x16x32_bf16 v[160:163], v[244:247], v[56:59], v[160:163]
ds_read_b128 v[240:243], v8 offset:32768
v_mfma_f32_16x16x32_bf16 v[164:167], v[244:247], v[60:63], v[164:167]
s_waitcnt lgkmcnt(4)
v_mfma_f32_16x16x32_bf16 v[168:171], v[248:251], v[56:59], v[168:171]
ds_read_b128 v[244:247], v8 offset:33792
v_mfma_f32_16x16x32_bf16 v[172:175], v[248:251], v[60:63], v[172:175]
buffer_load_dwordx4 v[96:99], v8, s[20:23], s79 offen offset:0 sc1
s_waitcnt lgkmcnt(4)
v_mfma_f32_16x16x32_bf16 v[176:179], v[252:255], v[56:59], v[176:179]
ds_read_b128 v[248:251], v8 offset:34816
v_mfma_f32_16x16x32_bf16 v[180:183], v[252:255], v[60:63], v[180:183]
s_waitcnt lgkmcnt(4)
v_mfma_f32_16x16x32_bf16 v[184:187], v[232:235], v[56:59], v[184:187]
ds_read_b128 v[252:255], v8 offset:35840
v_mfma_f32_16x16x32_bf16 v[188:191], v[232:235], v[60:63], v[188:191]
buffer_load_dwordx4 v[100:103], v8, s[20:23], s79 offen offset:1024 sc1
s_waitcnt lgkmcnt(4)
v_mfma_f32_16x16x32_bf16 v[192:195], v[236:239], v[56:59], v[192:195]
ds_read_b128 v[232:235], v8 offset:36864
v_mfma_f32_16x16x32_bf16 v[196:199], v[236:239], v[60:63], v[196:199]
s_waitcnt lgkmcnt(4)
v_mfma_f32_16x16x32_bf16 v[200:203], v[240:243], v[56:59], v[200:203]
ds_read_b128 v[236:239], v8 offset:37888
v_mfma_f32_16x16x32_bf16 v[204:207], v[240:243], v[60:63], v[204:207]
buffer_load_dwordx4 v[104:107], v8, s[20:23], s79 offen offset:2048 sc1
s_waitcnt lgkmcnt(4)
v_mfma_f32_16x16x32_bf16 v[208:211], v[244:247], v[56:59], v[208:211]
ds_read_b128 v[240:243], v8 offset:38912
v_mfma_f32_16x16x32_bf16 v[212:215], v[244:247], v[60:63], v[212:215]
s_waitcnt lgkmcnt(4)
v_mfma_f32_16x16x32_bf16 v[216:219], v[248:251], v[56:59], v[216:219]
ds_read_b128 v[244:247], v8 offset:39936
v_mfma_f32_16x16x32_bf16 v[220:223], v[248:251], v[60:63], v[220:223]
buffer_load_dwordx4 v[108:111], v8, s[20:23], s79 offen offset:3072 sc1
s_waitcnt lgkmcnt(4)
v_mfma_f32_16x16x32_bf16 v[224:227], v[252:255], v[56:59], v[224:227]
ds_read_b128 v[248:251], v8 offset:40960
v_mfma_f32_16x16x32_bf16 v[228:231], v[252:255], v[60:63], v[228:231]
s_waitcnt vmcnt(10) lgkmcnt(4)
v_mfma_f32_16x16x32_bf16 v[160:163], v[232:235], v[64:67], v[160:163]
ds_read_b128 v[252:255], v8 offset:41984
v_mfma_f32_16x16x32_bf16 v[164:167], v[232:235], v[68:71], v[164:167]
buffer_load_dwordx4 v[112:115], v8, s[20:23], s80 offen offset:0 sc1
s_waitcnt lgkmcnt(4)
v_mfma_f32_16x16x32_bf16 v[168:171], v[236:239], v[64:67], v[168:171]
ds_read_b128 v[232:235], v8 offset:43008
v_mfma_f32_16x16x32_bf16 v[172:175], v[236:239], v[68:71], v[172:175]
s_waitcnt lgkmcnt(4)
v_mfma_f32_16x16x32_bf16 v[176:179], v[240:243], v[64:67], v[176:179]
ds_read_b128 v[236:239], v8 offset:44032
v_mfma_f32_16x16x32_bf16 v[180:183], v[240:243], v[68:71], v[180:183]
buffer_load_dwordx4 v[116:119], v8, s[20:23], s80 offen offset:1024 sc1
s_waitcnt lgkmcnt(4)
v_mfma_f32_16x16x32_bf16 v[184:187], v[244:247], v[64:67], v[184:187]
ds_read_b128 v[240:243], v8 offset:45056
v_mfma_f32_16x16x32_bf16 v[188:191], v[244:247], v[68:71], v[188:191]
Lpad9174:
s_cbranch_execz Lback2
s_waitcnt lgkmcnt(4)
v_mfma_f32_16x16x32_bf16 v[192:195], v[248:251], v[64:67], v[192:195]
ds_read_b128 v[244:247], v8 offset:46080
v_mfma_f32_16x16x32_bf16 v[196:199], v[248:251], v[68:71], v[196:199]
buffer_load_dwordx4 v[120:123], v8, s[20:23], s80 offen offset:2048 sc1
s_waitcnt lgkmcnt(4)
v_mfma_f32_16x16x32_bf16 v[200:203], v[252:255], v[64:67], v[200:203]
ds_read_b128 v[248:251], v8 offset:47104
v_mfma_f32_16x16x32_bf16 v[204:207], v[252:255], v[68:71], v[204:207]
s_waitcnt lgkmcnt(4)
v_mfma_f32_16x16x32_bf16 v[208:211], v[232:235], v[64:67], v[208:211]
ds_read_b128 v[252:255], v8 offset:48128
v_mfma_f32_16x16x32_bf16 v[212:215], v[232:235], v[68:71], v[212:215]
buffer_load_dwordx4 v[124:127], v8, s[20:23], s80 offen offset:3072 sc1
s_waitcnt lgkmcnt(4)
v_mfma_f32_16x16x32_bf16 v[216:219], v[236:239], v[64:67], v[216:219]
ds_read_b128 v[232:235], v8 offset:49152
v_mfma_f32_16x16x32_bf16 v[220:223], v[236:239], v[68:71], v[220:223]
s_waitcnt lgkmcnt(4)
v_mfma_f32_16x16x32_bf16 v[224:227], v[240:243], v[64:67], v[224:227]
ds_read_b128 v[236:239], v8 offset:50176
v_mfma_f32_16x16x32_bf16 v[228:231], v[240:243], v[68:71], v[228:231]
buffer_load_dwordx4 v[128:131], v8, s[20:23], s81 offen offset:0 sc1
s_waitcnt vmcnt(13) lgkmcnt(4)
v_mfma_f32_16x16x32_bf16 v[160:163], v[244:247], v[72:75], v[160:163]
ds_read_b128 v[240:243], v8 offset:51200
v_mfma_f32_16x16x32_bf16 v[164:167], v[244:247], v[76:79], v[164:167]
s_waitcnt lgkmcnt(4)
v_mfma_f32_16x16x32_bf16 v[168:171], v[248:251], v[72:75], v[168:171]
ds_read_b128 v[244:247], v8 offset:52224
v_mfma_f32_16x16x32_bf16 v[172:175], v[248:251], v[76:79], v[172:175]
buffer_load_dwordx4 v[132:135], v8, s[20:23], s81 offen offset:1024 sc1
s_waitcnt lgkmcnt(4)
v_mfma_f32_16x16x32_bf16 v[176:179], v[252:255], v[72:75], v[176:179]
ds_read_b128 v[248:251], v8 offset:53248
v_mfma_f32_16x16x32_bf16 v[180:183], v[252:255], v[76:79], v[180:183]
s_waitcnt lgkmcnt(4)
v_mfma_f32_16x16x32_bf16 v[184:187], v[232:235], v[72:75], v[184:187]
ds_read_b128 v[252:255], v8 offset:54272
v_mfma_f32_16x16x32_bf16 v[188:191], v[232:235], v[76:79], v[188:191]
buffer_load_dwordx4 v[136:139], v8, s[20:23], s81 offen offset:2048 sc1
s_waitcnt lgkmcnt(4)
v_mfma_f32_16x16x32_bf16 v[192:195], v[236:239], v[72:75], v[192:195]
ds_read_b128 v[232:235], v8 offset:55296
v_mfma_f32_16x16x32_bf16 v[196:199], v[236:239], v[76:79], v[196:199]
s_waitcnt lgkmcnt(4)
v_mfma_f32_16x16x32_bf16 v[200:203], v[240:243], v[72:75], v[200:203]
ds_read_b128 v[236:239], v8 offset:56320
v_mfma_f32_16x16x32_bf16 v[204:207], v[240:243], v[76:79], v[204:207]
buffer_load_dwordx4 v[140:143], v8, s[20:23], s81 offen offset:3072 sc1
s_waitcnt lgkmcnt(4)
v_mfma_f32_16x16x32_bf16 v[208:211], v[244:247], v[72:75], v[208:211]
ds_read_b128 v[240:243], v9 offset:0
v_mfma_f32_16x16x32_bf16 v[212:215], v[244:247], v[76:79], v[212:215]
s_waitcnt lgkmcnt(4)
v_mfma_f32_16x16x32_bf16 v[216:219], v[248:251], v[72:75], v[216:219]
ds_read_b128 v[244:247], v9 offset:1024
v_mfma_f32_16x16x32_bf16 v[220:223], v[248:251], v[76:79], v[220:223]
buffer_load_dwordx4 v[144:147], v8, s[20:23], s82 offen offset:0 sc1
s_waitcnt lgkmcnt(4)
v_mfma_f32_16x16x32_bf16 v[224:227], v[252:255], v[72:75], v[224:227]
ds_read_b128 v[248:251], v9 offset:2048
v_mfma_f32_16x16x32_bf16 v[228:231], v[252:255], v[76:79], v[228:231]
s_waitcnt vmcnt(15) lgkmcnt(4)
v_mfma_f32_16x16x32_bf16 v[160:163], v[232:235], v[80:83], v[160:163]
ds_read_b128 v[252:255], v9 offset:3072
v_mfma_f32_16x16x32_bf16 v[164:167], v[232:235], v[84:87], v[164:167]
buffer_load_dwordx4 v[148:151], v8, s[20:23], s82 offen offset:1024 sc1
s_waitcnt lgkmcnt(4)
v_mfma_f32_16x16x32_bf16 v[168:171], v[236:239], v[80:83], v[168:171]
ds_read_b128 v[232:235], v9 offset:4096
Lpad9245:
s_cbranch_execz Lback2
v_mfma_f32_16x16x32_bf16 v[172:175], v[236:239], v[84:87], v[172:175]
s_waitcnt lgkmcnt(4)
v_mfma_f32_16x16x32_bf16 v[176:179], v[240:243], v[80:83], v[176:179]
ds_read_b128 v[236:239], v9 offset:5120
v_mfma_f32_16x16x32_bf16 v[180:183], v[240:243], v[84:87], v[180:183]
buffer_load_dwordx4 v[152:155], v8, s[20:23], s82 offen offset:2048 sc1
s_waitcnt lgkmcnt(4)
v_mfma_f32_16x16x32_bf16 v[184:187], v[244:247], v[80:83], v[184:187]
ds_read_b128 v[240:243], v9 offset:6144
v_mfma_f32_16x16x32_bf16 v[188:191], v[244:247], v[84:87], v[188:191]
s_waitcnt lgkmcnt(4)
s_barrier
v_mfma_f32_16x16x32_bf16 v[192:195], v[248:251], v[80:83], v[192:195]
ds_read_b128 v[244:247], v9 offset:7168
v_mfma_f32_16x16x32_bf16 v[196:199], v[248:251], v[84:87], v[196:199]
buffer_load_dwordx4 v[156:159], v8, s[20:23], s82 offen offset:3072 sc1
s_waitcnt lgkmcnt(4)
v_mfma_f32_16x16x32_bf16 v[200:203], v[252:255], v[80:83], v[200:203]
ds_read_b128 v[248:251], v9 offset:8192
v_mfma_f32_16x16x32_bf16 v[204:207], v[252:255], v[84:87], v[204:207]
s_waitcnt lgkmcnt(4)
v_mfma_f32_16x16x32_bf16 v[208:211], v[232:235], v[80:83], v[208:211]
ds_read_b128 v[252:255], v9 offset:9216
v_mfma_f32_16x16x32_bf16 v[212:215], v[232:235], v[84:87], v[212:215]
s_waitcnt lgkmcnt(4)
v_mfma_f32_16x16x32_bf16 v[216:219], v[236:239], v[80:83], v[216:219]
ds_read_b128 v[232:235], v9 offset:10240
v_mfma_f32_16x16x32_bf16 v[220:223], v[236:239], v[84:87], v[220:223]
s_waitcnt lgkmcnt(4)
v_mfma_f32_16x16x32_bf16 v[224:227], v[240:243], v[80:83], v[224:227]
ds_read_b128 v[236:239], v9 offset:11264
v_mfma_f32_16x16x32_bf16 v[228:231], v[240:243], v[84:87], v[228:231]
s_waitcnt vmcnt(16) lgkmcnt(4)
v_mfma_f32_16x16x32_bf16 v[160:163], v[244:247], v[88:91], v[160:163]
ds_read_b128 v[240:243], v9 offset:12288
v_mfma_f32_16x16x32_bf16 v[164:167], v[244:247], v[92:95], v[164:167]
s_waitcnt lgkmcnt(4)
v_mfma_f32_16x16x32_bf16 v[168:171], v[248:251], v[88:91], v[168:171]
ds_read_b128 v[244:247], v9 offset:13312
v_mfma_f32_16x16x32_bf16 v[172:175], v[248:251], v[92:95], v[172:175]
s_waitcnt lgkmcnt(4)
v_mfma_f32_16x16x32_bf16 v[176:179], v[252:255], v[88:91], v[176:179]
ds_read_b128 v[248:251], v9 offset:14336
v_mfma_f32_16x16x32_bf16 v[180:183], v[252:255], v[92:95], v[180:183]
s_waitcnt lgkmcnt(4)
v_mfma_f32_16x16x32_bf16 v[184:187], v[232:235], v[88:91], v[184:187]
ds_read_b128 v[252:255], v9 offset:15360
v_mfma_f32_16x16x32_bf16 v[188:191], v[232:235], v[92:95], v[188:191]
s_waitcnt lgkmcnt(4)
v_mfma_f32_16x16x32_bf16 v[192:195], v[236:239], v[88:91], v[192:195]
ds_read_b128 v[232:235], v9 offset:47104
v_mfma_f32_16x16x32_bf16 v[196:199], v[236:239], v[92:95], v[196:199]
s_waitcnt lgkmcnt(4)
v_mfma_f32_16x16x32_bf16 v[200:203], v[240:243], v[88:91], v[200:203]
ds_read_b128 v[236:239], v9 offset:48128
v_mfma_f32_16x16x32_bf16 v[204:207], v[240:243], v[92:95], v[204:207]
s_waitcnt lgkmcnt(4)
v_mfma_f32_16x16x32_bf16 v[208:211], v[244:247], v[88:91], v[208:211]
ds_read_b128 v[240:243], v9 offset:49152
v_mfma_f32_16x16x32_bf16 v[212:215], v[244:247], v[92:95], v[212:215]
s_waitcnt lgkmcnt(4)
v_mfma_f32_16x16x32_bf16 v[216:219], v[248:251], v[88:91], v[216:219]
ds_read_b128 v[244:247], v9 offset:50176
v_mfma_f32_16x16x32_bf16 v[220:223], v[248:251], v[92:95], v[220:223]
s_waitcnt lgkmcnt(4)
v_mfma_f32_16x16x32_bf16 v[224:227], v[252:255], v[88:91], v[224:227]
ds_read_b128 v[248:251], v9 offset:51200
v_mfma_f32_16x16x32_bf16 v[228:231], v[252:255], v[92:95], v[228:231]
s_waitcnt vmcnt(14) lgkmcnt(4)
v_mfma_f32_16x16x32_bf16 v[160:163], v[232:235], v[96:99], v[160:163]
ds_read_b128 v[252:255], v9 offset:52224
v_mfma_f32_16x16x32_bf16 v[164:167], v[232:235], v[100:103], v[164:167]
s_waitcnt lgkmcnt(4)
Lpad9318:
s_cbranch_execz Lback2
v_mfma_f32_16x16x32_bf16 v[168:171], v[236:239], v[96:99], v[168:171]
ds_read_b128 v[232:235], v9 offset:53248
v_mfma_f32_16x16x32_bf16 v[172:175], v[236:239], v[100:103], v[172:175]
s_waitcnt lgkmcnt(4)
v_mfma_f32_16x16x32_bf16 v[176:179], v[240:243], v[96:99], v[176:179]
ds_read_b128 v[236:239], v9 offset:54272
v_mfma_f32_16x16x32_bf16 v[180:183], v[240:243], v[100:103], v[180:183]
s_waitcnt lgkmcnt(4)
v_mfma_f32_16x16x32_bf16 v[184:187], v[244:247], v[96:99], v[184:187]
ds_read_b128 v[240:243], v9 offset:55296
v_mfma_f32_16x16x32_bf16 v[188:191], v[244:247], v[100:103], v[188:191]
s_waitcnt lgkmcnt(4)
v_mfma_f32_16x16x32_bf16 v[192:195], v[248:251], v[96:99], v[192:195]
ds_read_b128 v[244:247], v9 offset:56320
v_mfma_f32_16x16x32_bf16 v[196:199], v[248:251], v[100:103], v[196:199]
s_waitcnt lgkmcnt(4)
v_mfma_f32_16x16x32_bf16 v[200:203], v[252:255], v[96:99], v[200:203]
ds_read_b128 v[248:251], v10 offset:8192
v_mfma_f32_16x16x32_bf16 v[204:207], v[252:255], v[100:103], v[204:207]
s_waitcnt lgkmcnt(4)
v_mfma_f32_16x16x32_bf16 v[208:211], v[232:235], v[96:99], v[208:211]
ds_read_b128 v[252:255], v10 offset:17408
v_mfma_f32_16x16x32_bf16 v[212:215], v[232:235], v[100:103], v[212:215]
s_waitcnt lgkmcnt(4)
v_mfma_f32_16x16x32_bf16 v[216:219], v[236:239], v[96:99], v[216:219]
ds_read_b128 v[232:235], v8 offset:0
v_mfma_f32_16x16x32_bf16 v[220:223], v[236:239], v[100:103], v[220:223]
s_waitcnt lgkmcnt(4)
v_mfma_f32_16x16x32_bf16 v[224:227], v[240:243], v[96:99], v[224:227]
ds_read_b128 v[236:239], v8 offset:9216
v_mfma_f32_16x16x32_bf16 v[228:231], v[240:243], v[100:103], v[228:231]
s_waitcnt vmcnt(12) lgkmcnt(4)
v_mfma_f32_16x16x32_bf16 v[160:163], v[244:247], v[104:107], v[160:163]
ds_read_b128 v[240:243], v9 offset:16384
v_mfma_f32_16x16x32_bf16 v[164:167], v[244:247], v[108:111], v[164:167]
s_waitcnt vmcnt(10) lgkmcnt(4)
v_mfma_f32_16x16x32_bf16 v[160:163], v[248:251], v[112:115], v[160:163]
ds_read_b128 v[244:247], v9 offset:25600
v_mfma_f32_16x16x32_bf16 v[164:167], v[248:251], v[116:119], v[164:167]
s_waitcnt vmcnt(8) lgkmcnt(4)
v_mfma_f32_16x16x32_bf16 v[160:163], v[252:255], v[120:123], v[160:163]
ds_read_b128 v[248:251], v10 offset:0
v_mfma_f32_16x16x32_bf16 v[164:167], v[252:255], v[124:127], v[164:167]
s_waitcnt vmcnt(6) lgkmcnt(4)
v_mfma_f32_16x16x32_bf16 v[160:163], v[232:235], v[128:131], v[160:163]
ds_read_b128 v[252:255], v10 offset:9216
v_mfma_f32_16x16x32_bf16 v[164:167], v[232:235], v[132:135], v[164:167]
s_waitcnt vmcnt(4) lgkmcnt(4)
v_mfma_f32_16x16x32_bf16 v[160:163], v[236:239], v[136:139], v[160:163]
ds_read_b128 v[232:235], v10 offset:18432
v_mfma_f32_16x16x32_bf16 v[164:167], v[236:239], v[140:143], v[164:167]
s_waitcnt vmcnt(2)
v_swap_b32 v146, v148
v_swap_b32 v147, v149
s_waitcnt lgkmcnt(4)
s_nop 0
v_mfma_f32_16x16x32_bf16 v[160:163], v[240:243], v[144:147], v[160:163]
ds_read_b128 v[236:239], v8 offset:1024
v_mfma_f32_16x16x32_bf16 v[164:167], v[240:243], v[148:151], v[164:167]
s_waitcnt vmcnt(0)
v_swap_b32 v154, v156
v_swap_b32 v155, v157
s_waitcnt lgkmcnt(4)
s_nop 0
v_mfma_f32_16x16x32_bf16 v[160:163], v[244:247], v[152:155], v[160:163]
ds_read_b128 v[240:243], v8 offset:10240
v_mfma_f32_16x16x32_bf16 v[164:167], v[244:247], v[156:159], v[164:167]
s_waitcnt lgkmcnt(4)
v_mfma_f32_16x16x32_bf16 v[168:171], v[248:251], v[104:107], v[168:171]
ds_read_b128 v[244:247], v9 offset:17408
v_mfma_f32_16x16x32_bf16 v[172:175], v[248:251], v[108:111], v[172:175]
s_waitcnt lgkmcnt(4)
v_mfma_f32_16x16x32_bf16 v[168:171], v[252:255], v[112:115], v[168:171]
ds_read_b128 v[248:251], v9 offset:26624
v_cvt_pk_bf16_f32 v160, v160, v161
v_mfma_f32_16x16x32_bf16 v[172:175], v[252:255], v[116:119], v[172:175]
Lpad9394:
s_cbranch_execz Lpad9465
v_cvt_pk_bf16_f32 v161, v162, v163
v_cvt_pk_bf16_f32 v162, v164, v165
s_waitcnt lgkmcnt(4)
v_mfma_f32_16x16x32_bf16 v[168:171], v[232:235], v[120:123], v[168:171]
ds_read_b128 v[252:255], v10 offset:1024
v_cvt_pk_bf16_f32 v163, v166, v167
v_mfma_f32_16x16x32_bf16 v[172:175], v[232:235], v[124:127], v[172:175]
buffer_store_dwordx4 v[160:163], v8, s[20:23], s72 offen offset:0 sc1
ds_write_b128 v7, v[160:163] offset:0
s_waitcnt lgkmcnt(5)
v_mfma_f32_16x16x32_bf16 v[168:171], v[236:239], v[128:131], v[168:171]
ds_read_b128 v[232:235], v10 offset:10240
v_mfma_f32_16x16x32_bf16 v[172:175], v[236:239], v[132:135], v[172:175]
s_waitcnt lgkmcnt(5)
v_mfma_f32_16x16x32_bf16 v[168:171], v[240:243], v[136:139], v[168:171]
ds_read_b128 v[236:239], v10 offset:19456
v_mfma_f32_16x16x32_bf16 v[172:175], v[240:243], v[140:143], v[172:175]
s_waitcnt lgkmcnt(5)
v_mfma_f32_16x16x32_bf16 v[168:171], v[244:247], v[144:147], v[168:171]
ds_read_b128 v[240:243], v8 offset:2048
v_mfma_f32_16x16x32_bf16 v[172:175], v[244:247], v[148:151], v[172:175]
s_waitcnt lgkmcnt(5)
v_mfma_f32_16x16x32_bf16 v[168:171], v[248:251], v[152:155], v[168:171]
ds_read_b128 v[244:247], v8 offset:11264
v_mfma_f32_16x16x32_bf16 v[172:175], v[248:251], v[156:159], v[172:175]
s_waitcnt lgkmcnt(5)
v_mfma_f32_16x16x32_bf16 v[176:179], v[252:255], v[104:107], v[176:179]
ds_read_b128 v[248:251], v9 offset:18432
v_mfma_f32_16x16x32_bf16 v[180:183], v[252:255], v[108:111], v[180:183]
s_waitcnt lgkmcnt(4)
v_mfma_f32_16x16x32_bf16 v[176:179], v[232:235], v[112:115], v[176:179]
ds_read_b128 v[252:255], v9 offset:27648
v_cvt_pk_bf16_f32 v168, v168, v169
v_mfma_f32_16x16x32_bf16 v[180:183], v[232:235], v[116:119], v[180:183]
v_cvt_pk_bf16_f32 v169, v170, v171
v_cvt_pk_bf16_f32 v170, v172, v173
s_waitcnt lgkmcnt(4)
v_mfma_f32_16x16x32_bf16 v[176:179], v[236:239], v[120:123], v[176:179]
ds_read_b128 v[232:235], v10 offset:2048
v_cvt_pk_bf16_f32 v171, v174, v175
v_mfma_f32_16x16x32_bf16 v[180:183], v[236:239], v[124:127], v[180:183]
buffer_store_dwordx4 v[168:171], v8, s[20:23], s72 offen offset:1024 sc1
ds_write_b128 v7, v[168:171] offset:1024
s_waitcnt lgkmcnt(5)
v_mfma_f32_16x16x32_bf16 v[176:179], v[240:243], v[128:131], v[176:179]
ds_read_b128 v[236:239], v10 offset:11264
v_mfma_f32_16x16x32_bf16 v[180:183], v[240:243], v[132:135], v[180:183]
s_waitcnt lgkmcnt(5)
v_mfma_f32_16x16x32_bf16 v[176:179], v[244:247], v[136:139], v[176:179]
ds_read_b128 v[240:243], v10 offset:20480
v_mfma_f32_16x16x32_bf16 v[180:183], v[244:247], v[140:143], v[180:183]
s_waitcnt lgkmcnt(5)
v_mfma_f32_16x16x32_bf16 v[176:179], v[248:251], v[144:147], v[176:179]
ds_read_b128 v[244:247], v8 offset:3072
v_mfma_f32_16x16x32_bf16 v[180:183], v[248:251], v[148:151], v[180:183]
s_waitcnt lgkmcnt(5)
v_mfma_f32_16x16x32_bf16 v[176:179], v[252:255], v[152:155], v[176:179]
ds_read_b128 v[248:251], v8 offset:12288
v_mfma_f32_16x16x32_bf16 v[180:183], v[252:255], v[156:159], v[180:183]
s_waitcnt lgkmcnt(5)
v_mfma_f32_16x16x32_bf16 v[184:187], v[232:235], v[104:107], v[184:187]
ds_read_b128 v[252:255], v9 offset:19456
v_mfma_f32_16x16x32_bf16 v[188:191], v[232:235], v[108:111], v[188:191]
s_waitcnt lgkmcnt(4)
s_barrier
v_mfma_f32_16x16x32_bf16 v[184:187], v[236:239], v[112:115], v[184:187]
ds_read_b128 v[232:235], v9 offset:28672
v_cvt_pk_bf16_f32 v176, v176, v177
v_mfma_f32_16x16x32_bf16 v[188:191], v[236:239], v[116:119], v[188:191]
v_cvt_pk_bf16_f32 v177, v178, v179
v_cvt_pk_bf16_f32 v178, v180, v181
Lpad9465:
s_cbranch_execz Lback2
s_waitcnt lgkmcnt(4)
v_mfma_f32_16x16x32_bf16 v[184:187], v[240:243], v[120:123], v[184:187]
ds_read_b128 v[236:239], v10 offset:3072
v_cvt_pk_bf16_f32 v179, v182, v183
v_mfma_f32_16x16x32_bf16 v[188:191], v[240:243], v[124:127], v[188:191]
buffer_store_dwordx4 v[176:179], v8, s[20:23], s72 offen offset:2048 sc1
ds_write_b128 v7, v[176:179] offset:2048
s_waitcnt lgkmcnt(5)
v_mfma_f32_16x16x32_bf16 v[184:187], v[244:247], v[128:131], v[184:187]
ds_read_b128 v[240:243], v10 offset:12288
v_mfma_f32_16x16x32_bf16 v[188:191], v[244:247], v[132:135], v[188:191]
s_waitcnt lgkmcnt(5)
v_mfma_f32_16x16x32_bf16 v[184:187], v[248:251], v[136:139], v[184:187]
ds_read_b128 v[244:247], v10 offset:21504
v_mfma_f32_16x16x32_bf16 v[188:191], v[248:251], v[140:143], v[188:191]
s_waitcnt lgkmcnt(5)
v_mfma_f32_16x16x32_bf16 v[184:187], v[252:255], v[144:147], v[184:187]
ds_read_b128 v[248:251], v8 offset:4096
v_mfma_f32_16x16x32_bf16 v[188:191], v[252:255], v[148:151], v[188:191]
s_waitcnt lgkmcnt(5)
v_mfma_f32_16x16x32_bf16 v[184:187], v[232:235], v[152:155], v[184:187]
ds_read_b128 v[252:255], v8 offset:13312
v_mfma_f32_16x16x32_bf16 v[188:191], v[232:235], v[156:159], v[188:191]
s_waitcnt lgkmcnt(5)
v_mfma_f32_16x16x32_bf16 v[192:195], v[236:239], v[104:107], v[192:195]
ds_read_b128 v[232:235], v9 offset:20480
v_mfma_f32_16x16x32_bf16 v[196:199], v[236:239], v[108:111], v[196:199]
s_waitcnt lgkmcnt(4)
v_mfma_f32_16x16x32_bf16 v[192:195], v[240:243], v[112:115], v[192:195]
ds_read_b128 v[236:239], v9 offset:29696
v_cvt_pk_bf16_f32 v184, v184, v185
v_mfma_f32_16x16x32_bf16 v[196:199], v[240:243], v[116:119], v[196:199]
v_cvt_pk_bf16_f32 v185, v186, v187
v_cvt_pk_bf16_f32 v186, v188, v189
s_waitcnt lgkmcnt(4)
v_mfma_f32_16x16x32_bf16 v[192:195], v[244:247], v[120:123], v[192:195]
ds_read_b128 v[240:243], v10 offset:4096
v_cvt_pk_bf16_f32 v187, v190, v191
v_mfma_f32_16x16x32_bf16 v[196:199], v[244:247], v[124:127], v[196:199]
buffer_store_dwordx4 v[184:187], v8, s[20:23], s72 offen offset:3072 sc1
ds_write_b128 v7, v[184:187] offset:3072
s_waitcnt lgkmcnt(5)
v_mfma_f32_16x16x32_bf16 v[192:195], v[248:251], v[128:131], v[192:195]
ds_read_b128 v[244:247], v10 offset:13312
v_mfma_f32_16x16x32_bf16 v[196:199], v[248:251], v[132:135], v[196:199]
s_waitcnt lgkmcnt(5)
v_mfma_f32_16x16x32_bf16 v[192:195], v[252:255], v[136:139], v[192:195]
ds_read_b128 v[248:251], v10 offset:22528
v_mfma_f32_16x16x32_bf16 v[196:199], v[252:255], v[140:143], v[196:199]
s_waitcnt lgkmcnt(5)
v_mfma_f32_16x16x32_bf16 v[192:195], v[232:235], v[144:147], v[192:195]
ds_read_b128 v[252:255], v8 offset:5120
v_mfma_f32_16x16x32_bf16 v[196:199], v[232:235], v[148:151], v[196:199]
s_waitcnt lgkmcnt(5)
v_mfma_f32_16x16x32_bf16 v[192:195], v[236:239], v[152:155], v[192:195]
ds_read_b128 v[232:235], v8 offset:14336
v_mfma_f32_16x16x32_bf16 v[196:199], v[236:239], v[156:159], v[196:199]
s_waitcnt lgkmcnt(5)
v_mfma_f32_16x16x32_bf16 v[200:203], v[240:243], v[104:107], v[200:203]
ds_read_b128 v[236:239], v9 offset:21504
v_mfma_f32_16x16x32_bf16 v[204:207], v[240:243], v[108:111], v[204:207]
s_waitcnt lgkmcnt(4)
v_mfma_f32_16x16x32_bf16 v[200:203], v[244:247], v[112:115], v[200:203]
ds_read_b128 v[240:243], v9 offset:30720
v_cvt_pk_bf16_f32 v192, v192, v193
v_mfma_f32_16x16x32_bf16 v[204:207], v[244:247], v[116:119], v[204:207]
v_cvt_pk_bf16_f32 v193, v194, v195
v_cvt_pk_bf16_f32 v194, v196, v197
s_waitcnt lgkmcnt(4)
v_mfma_f32_16x16x32_bf16 v[200:203], v[248:251], v[120:123], v[200:203]
ds_read_b128 v[244:247], v10 offset:5120
Lpad9536:
s_cbranch_execz Lback2
v_cvt_pk_bf16_f32 v195, v198, v199
v_mfma_f32_16x16x32_bf16 v[204:207], v[248:251], v[124:127], v[204:207]
buffer_store_dwordx4 v[192:195], v8, s[20:23], s73 offen offset:0 sc1
ds_write_b128 v7, v[192:195] offset:4096
s_waitcnt lgkmcnt(5)
v_mfma_f32_16x16x32_bf16 v[200:203], v[252:255], v[128:131], v[200:203]
ds_read_b128 v[248:251], v10 offset:14336
v_mfma_f32_16x16x32_bf16 v[204:207], v[252:255], v[132:135], v[204:207]
s_waitcnt lgkmcnt(5)
v_mfma_f32_16x16x32_bf16 v[200:203], v[232:235], v[136:139], v[200:203]
ds_read_b128 v[252:255], v10 offset:23552
v_mfma_f32_16x16x32_bf16 v[204:207], v[232:235], v[140:143], v[204:207]
s_waitcnt lgkmcnt(5)
v_mfma_f32_16x16x32_bf16 v[200:203], v[236:239], v[144:147], v[200:203]
ds_read_b128 v[232:235], v8 offset:6144
v_mfma_f32_16x16x32_bf16 v[204:207], v[236:239], v[148:151], v[204:207]
s_waitcnt lgkmcnt(5)
v_mfma_f32_16x16x32_bf16 v[200:203], v[240:243], v[152:155], v[200:203]
ds_read_b128 v[236:239], v8 offset:15360
v_mfma_f32_16x16x32_bf16 v[204:207], v[240:243], v[156:159], v[204:207]
s_waitcnt lgkmcnt(5)
v_mfma_f32_16x16x32_bf16 v[208:211], v[244:247], v[104:107], v[208:211]
ds_read_b128 v[240:243], v9 offset:22528
v_mfma_f32_16x16x32_bf16 v[212:215], v[244:247], v[108:111], v[212:215]
s_waitcnt lgkmcnt(4)
v_mfma_f32_16x16x32_bf16 v[208:211], v[248:251], v[112:115], v[208:211]
ds_read_b128 v[244:247], v9 offset:31744
v_cvt_pk_bf16_f32 v200, v200, v201
v_mfma_f32_16x16x32_bf16 v[212:215], v[248:251], v[116:119], v[212:215]
v_cvt_pk_bf16_f32 v201, v202, v203
v_cvt_pk_bf16_f32 v202, v204, v205
s_waitcnt lgkmcnt(4)
v_mfma_f32_16x16x32_bf16 v[208:211], v[252:255], v[120:123], v[208:211]
ds_read_b128 v[248:251], v10 offset:6144
v_cvt_pk_bf16_f32 v203, v206, v207
v_mfma_f32_16x16x32_bf16 v[212:215], v[252:255], v[124:127], v[212:215]
buffer_store_dwordx4 v[200:203], v8, s[20:23], s73 offen offset:1024 sc1
ds_write_b128 v7, v[200:203] offset:5120
s_waitcnt lgkmcnt(5)
v_mfma_f32_16x16x32_bf16 v[208:211], v[232:235], v[128:131], v[208:211]
ds_read_b128 v[252:255], v10 offset:15360
v_mfma_f32_16x16x32_bf16 v[212:215], v[232:235], v[132:135], v[212:215]
s_waitcnt lgkmcnt(5)
v_mfma_f32_16x16x32_bf16 v[208:211], v[236:239], v[136:139], v[208:211]
ds_read_b128 v[232:235], v10 offset:24576
v_mfma_f32_16x16x32_bf16 v[212:215], v[236:239], v[140:143], v[212:215]
s_waitcnt lgkmcnt(5)
v_mfma_f32_16x16x32_bf16 v[208:211], v[240:243], v[144:147], v[208:211]
ds_read_b128 v[236:239], v8 offset:7168
v_mfma_f32_16x16x32_bf16 v[212:215], v[240:243], v[148:151], v[212:215]
s_waitcnt lgkmcnt(5)
v_mfma_f32_16x16x32_bf16 v[208:211], v[244:247], v[152:155], v[208:211]
ds_read_b128 v[240:243], v8 offset:16384
v_mfma_f32_16x16x32_bf16 v[212:215], v[244:247], v[156:159], v[212:215]
s_waitcnt lgkmcnt(5)
v_mfma_f32_16x16x32_bf16 v[216:219], v[248:251], v[104:107], v[216:219]
ds_read_b128 v[244:247], v9 offset:23552
v_mfma_f32_16x16x32_bf16 v[220:223], v[248:251], v[108:111], v[220:223]
s_waitcnt lgkmcnt(4)
v_mfma_f32_16x16x32_bf16 v[216:219], v[252:255], v[112:115], v[216:219]
ds_read_b128 v[248:251], v9 offset:32768
v_cvt_pk_bf16_f32 v208, v208, v209
v_mfma_f32_16x16x32_bf16 v[220:223], v[252:255], v[116:119], v[220:223]
v_cvt_pk_bf16_f32 v209, v210, v211
v_cvt_pk_bf16_f32 v210, v212, v213
s_waitcnt lgkmcnt(4)
v_mfma_f32_16x16x32_bf16 v[216:219], v[232:235], v[120:123], v[216:219]
ds_read_b128 v[252:255], v10 offset:7168
v_cvt_pk_bf16_f32 v211, v214, v215
v_mfma_f32_16x16x32_bf16 v[220:223], v[232:235], v[124:127], v[220:223]
Lpad9606:
s_cbranch_execz Lback2
buffer_store_dwordx4 v[208:211], v8, s[20:23], s73 offen offset:2048 sc1
ds_write_b128 v7, v[208:211] offset:6144
s_waitcnt lgkmcnt(5)
v_mfma_f32_16x16x32_bf16 v[216:219], v[236:239], v[128:131], v[216:219]
ds_read_b128 v[232:235], v10 offset:16384
v_mfma_f32_16x16x32_bf16 v[220:223], v[236:239], v[132:135], v[220:223]
s_waitcnt lgkmcnt(5)
v_mfma_f32_16x16x32_bf16 v[216:219], v[240:243], v[136:139], v[216:219]
ds_read_b128 v[236:239], v10 offset:25600
v_mfma_f32_16x16x32_bf16 v[220:223], v[240:243], v[140:143], v[220:223]
s_waitcnt lgkmcnt(5)
v_mfma_f32_16x16x32_bf16 v[216:219], v[244:247], v[144:147], v[216:219]
ds_read_b128 v[240:243], v8 offset:8192
v_mfma_f32_16x16x32_bf16 v[220:223], v[244:247], v[148:151], v[220:223]
s_waitcnt lgkmcnt(5)
v_mfma_f32_16x16x32_bf16 v[216:219], v[248:251], v[152:155], v[216:219]
ds_read_b128 v[244:247], v8 offset:17408
v_mfma_f32_16x16x32_bf16 v[220:223], v[248:251], v[156:159], v[220:223]
s_waitcnt lgkmcnt(5)
v_mfma_f32_16x16x32_bf16 v[224:227], v[252:255], v[104:107], v[224:227]
ds_read_b128 v[248:251], v9 offset:24576
v_mfma_f32_16x16x32_bf16 v[228:231], v[252:255], v[108:111], v[228:231]
s_waitcnt lgkmcnt(4)
v_mfma_f32_16x16x32_bf16 v[224:227], v[232:235], v[112:115], v[224:227]
ds_read_b128 v[252:255], v9 offset:33792
v_cvt_pk_bf16_f32 v216, v216, v217
v_mfma_f32_16x16x32_bf16 v[228:231], v[232:235], v[116:119], v[228:231]
v_cvt_pk_bf16_f32 v217, v218, v219
v_cvt_pk_bf16_f32 v218, v220, v221
s_waitcnt lgkmcnt(4)
v_mfma_f32_16x16x32_bf16 v[224:227], v[236:239], v[120:123], v[224:227]
v_cvt_pk_bf16_f32 v219, v222, v223
buffer_store_dwordx4 v[216:219], v8, s[20:23], s73 offen offset:3072 sc1
v_mfma_f32_16x16x32_bf16 v[228:231], v[236:239], v[124:127], v[228:231]
ds_write_b128 v7, v[216:219] offset:7168
s_waitcnt lgkmcnt(4)
v_mfma_f32_16x16x32_bf16 v[224:227], v[240:243], v[128:131], v[224:227]
v_mfma_f32_16x16x32_bf16 v[228:231], v[240:243], v[132:135], v[228:231]
s_waitcnt lgkmcnt(3)
v_mfma_f32_16x16x32_bf16 v[224:227], v[244:247], v[136:139], v[224:227]
v_mfma_f32_16x16x32_bf16 v[228:231], v[244:247], v[140:143], v[228:231]
s_waitcnt lgkmcnt(2)
v_mfma_f32_16x16x32_bf16 v[224:227], v[248:251], v[144:147], v[224:227]
v_mfma_f32_16x16x32_bf16 v[228:231], v[248:251], v[148:151], v[228:231]
s_waitcnt lgkmcnt(1)
v_mfma_f32_16x16x32_bf16 v[224:227], v[252:255], v[152:155], v[224:227]
v_mfma_f32_16x16x32_bf16 v[228:231], v[252:255], v[156:159], v[228:231]
s_nop 6
v_cvt_pk_bf16_f32 v224, v224, v225
v_cvt_pk_bf16_f32 v225, v226, v227
v_cvt_pk_bf16_f32 v226, v228, v229
v_cvt_pk_bf16_f32 v227, v230, v231
buffer_store_dwordx4 v[224:227], v8, s[20:23], s74 offen offset:0 sc1
ds_write_b128 v7, v[224:227] offset:8192
s_waitcnt lgkmcnt(0)
s_barrier
s_waitcnt vmcnt(0)
v_mov_b32 v3, 0
v_mov_b32 v4, s59
s_mov_b64 exec, 1
buffer_store_dword v4, v3, s[20:23], s68 offen sc1
s_mov_b64 exec, -1
s_endpgm
L_codeend:
.section .rodata,"a"
.p2align 6
.amdhsa_kernel recurrent_scan__sliding_block__mixer_gmlp__prompt_kernel
  .amdhsa_next_free_vgpr 256
  .amdhsa_next_free_sgpr 102
  .amdhsa_accum_offset 256
  .amdhsa_group_segment_fixed_size 0
  .amdhsa_kernarg_size 88
  .amdhsa_user_sgpr_count 2
  .amdhsa_user_sgpr_kernarg_segment_ptr 1
  .amdhsa_system_sgpr_workgroup_id_x 1
.end_amdhsa_kernel
```
